```python
import torch

def _softmax(x, axis=-1):
    return torch.softmax(x, dim=axis)
def _gelu(x):
    return torch.nn.functional.gelu(x, approximate="tanh")
def _silu(x):
    return torch.nn.functional.silu(x)
def _sigmoid(x):
    return torch.sigmoid(x)
def _layernorm(x, axis=-1, eps=1e-5):
    m = x.mean(dim=axis, keepdim=True)
    v = x.var(dim=axis, keepdim=True, unbiased=False)
    return (x - m) / torch.sqrt(v + eps)
def _scatter_add(tgt, idx, src, axis=0):
    return tgt.clone().index_add_(axis, idx, src)
def _segment_sum(src, seg, n):
    out = torch.zeros((n,) + src.shape[1:], dtype=src.dtype)
    return out.index_add_(0, seg, src)
def _pad(x, pw):
    flat = tuple(v for pair in reversed(pw) for v in pair)
    return torch.nn.functional.pad(x, flat)

kernel_name = 'recurrent_scan__linear_kernel_hedgehog__swiglu_ffn__prompt'

def setup_inputs():

    _w = (lambda a: (lambda t: t.to(torch.bfloat16) if t.is_floating_point() else t)(torch.as_tensor(a)))
    def _A_setup():
        B, S, D, H = 1, 2048, 576, 32
        Dh = D // H
        return {
            "x": _w((lambda *s: torch.randn(*s, dtype=torch.bfloat16) * 0.05)(B, S, D)),
            "wqkv": _w((lambda *s: torch.randn(*s, dtype=torch.bfloat16) * 0.2)(D, 3 * D)),
            "w_phi": _w((lambda *s: torch.randn(*s, dtype=torch.bfloat16) * 0.2)(H, Dh, Dh) * (Dh ** -0.5)),
            "wo": _w((lambda *s: torch.randn(*s, dtype=torch.bfloat16) * 0.05)(D, D)),
        }
    _A_in = _A_setup()

    def _B_setup():
        B, S, D, F = 1, 2048, 576, 4608
        return {
            "x": _w((lambda *s: torch.randn(*s, dtype=torch.bfloat16) * 0.05)(B, S, D)),
            "w_gate": _w((lambda *s: torch.randn(*s, dtype=torch.bfloat16) * 0.05)(D, F)),
            "w_up": _w((lambda *s: torch.randn(*s, dtype=torch.bfloat16) * 0.05)(D, F)),
            "w_down": _w((lambda *s: torch.randn(*s, dtype=torch.bfloat16) * 0.05)(F, D)),
        }
    _B_in = _B_setup()

    return {
        "A_x": _A_in["x"],
        "A_wqkv": _A_in["wqkv"],
        "A_w_phi": _A_in["w_phi"],
        "A_wo": _A_in["wo"],
        "B_x": _B_in["x"],
        "B_w_gate": _B_in["w_gate"],
        "B_w_up": _B_in["w_up"],
        "B_w_down": _B_in["w_down"],
    }

def reference(A_x, A_wqkv, A_w_phi, A_wo, B_x, B_w_gate, B_w_up, B_w_down):
    def _A_ref(x, wqkv, w_phi, wo):
        B, S, D = x.shape
        H = 32; Dh = D // H
        qkv = (lambda x, *d: x.permute(*d))((x @ wqkv).reshape(B, S, 3, H, Dh), 2, 0, 3, 1, 4)
        q, k, v = qkv[0], qkv[1], qkv[2]
        pq = torch.einsum("bhsd,hdf->bhsf", q, w_phi)
        pk = torch.einsum("bhsd,hdf->bhsf", k, w_phi)
        phi_q = torch.concatenate([_softmax(pq, axis=-1), _softmax(-pq, axis=-1)], axis=-1)
        phi_k = torch.concatenate([_softmax(pk, axis=-1), _softmax(-pk, axis=-1)], axis=-1)
        kv = torch.einsum("bhsf,bhsd->bhfd", phi_k, v)
        z  = torch.einsum("bhsf->bhf", phi_k)
        num = torch.einsum("bhqf,bhfd->bhqd", phi_q, kv)
        den = torch.einsum("bhqf,bhf->bhq", phi_q, z)[..., None] + 1e-6
        o = num / den
        return (lambda x, *d: x.permute(*d))(o, 0, 2, 1, 3).reshape(B, S, D) @ wo

    def _B_ref(x, w_gate, w_up, w_down):
        g = _silu(x @ w_gate)
        u = x @ w_up
        return (g * u) @ w_down

    x = A_x
    xn = _layernorm(x, axis=-1)
    s = _A_ref(xn, A_wqkv, A_w_phi, A_wo)
    g = _silu(_B_ref(xn, B_w_gate, B_w_up, B_w_down))
    return x + s * g
```

```asm
; @launch grid=(256,1,1) block=(256,1,1) lds=163840
.amdgcn_target "amdgcn-amd-amdhsa--gfx950"
.text
.globl recurrent_scan__linear_kernel_hedgehog__swiglu_ffn__prompt_kernel
.p2align 8
.type recurrent_scan__linear_kernel_hedgehog__swiglu_ffn__prompt_kernel,@function
recurrent_scan__linear_kernel_hedgehog__swiglu_ffn__prompt_kernel:
    s_cmp_ge_u32 s2, 256
    s_cbranch_scc1 LM_end
    s_load_dwordx8 s[44:51], s[0:1], 0
    s_load_dwordx4 s[8:11], s[0:1], 40
    s_load_dwordx2 s[52:53], s[0:1], 56
    s_load_dwordx4 s[56:59], s[0:1], 72
    v_lshrrev_b32 v1, 6, v0
    v_and_b32 v0, 63, v0
    v_readfirstlane_b32 s3, v1
    s_and_b32 s38, s2, 7
    s_lshr_b32 s66, s2, 3
    s_and_b32 s24, s38, 1
    s_lshl_b32 s24, s24, 2
    s_and_b32 s39, s66, 3
    s_add_u32 s24, s24, s39
    s_lshr_b32 s65, s38, 1
    s_lshl_b32 s25, s65, 3
    s_lshr_b32 s39, s66, 2
    s_add_u32 s25, s25, s39
    s_getpc_b64 s[14:15]
L_pc:
    s_lshl_b32 s39, s25, 5
    s_add_u32 s39, s39, L_postab-L_pc
    s_add_u32 s12, s14, s39
    s_addc_u32 s13, s15, 0
    s_load_dwordx8 s[16:23], s[12:13], 0
    s_max_u32 s39, s2, 18
    s_min_u32 s39, s39, 161
    s_lshl_b32 s39, s39, 2
    s_add_u32 s39, s39, L_kkhtab-L_pc-72
    s_add_u32 s12, s14, s39
    s_addc_u32 s13, s15, 0
    s_load_dword s61, s[12:13], 0
    s_lshl_b32 s26, s3, 11
    s_lshl_b32 s28, s24, 3
    s_lshl_b32 s39, s3, 1
    s_add_u32 s28, s28, s39
    s_mul_i32 s28, s28, 36864
    s_add_u32 s28, s28, 0
    s_add_u32 s29, s28, 36864
    s_mul_i32 s30, s25, 73728
    s_add_u32 s30, s30, s26
    s_add_u32 s30, s30, 2359296
    s_mul_i32 s31, s25, 40960
    s_add_u32 s31, s31, s26
    s_add_u32 s31, s31, 4718592
    v_lshlrev_b32 v1, 4, v0
    s_mov_b32 s6, 268435456
    s_mov_b32 s7, 0x20000
    v_bfe_u32 v15, v0, 4, 1
    v_lshrrev_b32 v14, 5, v0
    v_lshlrev_b32 v5, 12, v15
    v_lshl_add_u32 v5, v14, 9, v5
    v_bfe_u32 v6, v0, 2, 2
    v_lshl_add_u32 v5, v6, 6, v5
    v_and_b32 v6, 3, v0
    v_lshl_add_u32 v5, v6, 3, v5
    v_xor_b32 v6, 1, v15
    v_lshl_add_u32 v6, v6, 5, v5
    v_lshl_add_u32 v5, v15, 5, v5
    v_add_u32 v7, 0x10000, v5
    v_add_u32 v8, 0x10000, v6
    v_add_u32 v9, 0x20000, v5
    v_add_u32 v10, 0x20000, v6
    v_mov_b32 v201, 0
    v_mov_b32 v183, 0
    v_mov_b32 v163, 2147483632
    v_lshlrev_b32 v96, 5, v0
    v_cmp_gt_u32 vcc, 36, v0
    v_min_u32 v164, 36, v0
    v_lshlrev_b32 v164, 8, v164
    v_cndmask_b32 v96, v163, v96, vcc
    s_lshl_b32 s39, s3, 5
    s_add_u32 s39, s39, 106496
    v_add_u32 v164, s39, v164
    v_lshrrev_b32 v160, 3, v0
    v_bfe_u32 v161, v0, 2, 1
    v_bfe_u32 v162, v0, 1, 1
    v_xor_b32 v162, v162, v161
    v_and_b32 v166, 1, v0
    v_mul_u32_u24 v97, 3456, v160
    s_mul_i32 s39, s25, 36
    v_add_u32 v97, s39, v97
    v_add_u32 v98, 32, v97
    v_lshl_add_u32 v97, v166, 4, v97
    v_add_u32 v167, 1, v162
    v_mul_u32_u24 v167, 1152, v167
    v_mad_u32_u24 v97, v167, v161, v97
    v_cmp_lt_u32 vcc, v161, v162
    v_lshl_add_u32 v167, v162, 1, v166
    v_lshl_add_u32 v167, v161, 2, v167
    v_cndmask_b32 v97, v97, v163, vcc
    v_cmp_eq_u32 vcc, 2, v167
    v_lshlrev_b32 v165, 6, v160
    v_lshl_add_u32 v165, v161, 12, v165
    v_cndmask_b32 v98, v163, v98, vcc
    v_and_b32 v167, 3, v0
    v_lshl_add_u32 v165, v167, 4, v165
    s_and_b32 s39, s3, 1
    s_lshl_b32 s39, s39, 1
    v_add_u32 v160, s39, v14
    s_lshr_b32 s40, s3, 1
    v_bfe_u32 v161, v0, 1, 1
    v_xor_b32 v161, s40, v161
    v_lshl_add_u32 v161, v160, 1, v161
    v_bfe_u32 v162, v0, 2, 3
    v_lshl_add_u32 v161, v161, 6, v162
    s_movk_i32 s40, 9216
    v_mul_lo_u32 v99, v161, s40
    v_lshl_add_u32 v99, v166, 4, v99
    v_lshlrev_b32 v166, 13, v160
    v_lshl_add_u32 v166, v162, 6, v166
    v_lshl_add_u32 v166, v167, 4, v166
    v_cmp_eq_u32 vcc, 0, v160
    s_nop 1
    v_cndmask_b32 v167, v163, v166, vcc
    s_lshl_b32 s41, s24, 8
    s_lshl_b32 s42, s25, 3
    s_add_u32 s41, s41, s42
    s_lshl_b32 s42, s3, 1
    s_add_u32 s41, s41, s42
    s_mul_i32 s41, s41, 1152
    s_mul_i32 s42, s3, 192
    s_lshl_b32 s43, s24, 3
    s_add_u32 s42, s42, s43
    s_mul_i32 s42, s42, 3456
    s_mul_i32 s43, s24, 73728
    s_lshl_b32 s39, s25, 5
    s_add_u32 s43, s43, s39
    s_add_u32 s43, s43, 8192
    s_waitcnt lgkmcnt(0)
    s_mov_b32 s4, s58
    s_mov_b32 s5, s59
    s_mov_b32 s68, s44
    s_mov_b32 s69, s45
    s_mov_b32 s70, 2359296
    s_mov_b32 s71, 0x20000
    s_mov_b32 s54, 0
    s_mov_b32 s55, 0x20000
    buffer_load_dwordx4 v[100:103], v96, s[68:71], s41 offen
    buffer_load_dwordx4 v[104:107], v96, s[68:71], s41 offen offset:16
    buffer_load_dwordx4 v[132:135], v96, s[68:71], s41 offen offset:1152
    buffer_load_dwordx4 v[136:139], v96, s[68:71], s41 offen offset:1168
    s_cmp_eq_u32 s3, 3
    s_cbranch_scc1 LS_w3a
    s_mov_b32 s72, s46
    s_mov_b32 s73, s47
    s_mov_b32 s74, 1990656
    s_mov_b32 s75, 0x20000
    buffer_load_dwordx4 v[168:171], v97, s[72:75], s42 offen
    buffer_load_dword v172, v98, s[72:75], s42 offen
    buffer_load_dword v173, v98, s[72:75], s42 offen offset:1152
    buffer_load_dword v174, v98, s[72:75], s42 offen offset:2304
    s_add_u32 s42, s42, 221184
    buffer_load_dwordx4 v[176:179], v97, s[72:75], s42 offen
    buffer_load_dword v180, v98, s[72:75], s42 offen
    buffer_load_dword v181, v98, s[72:75], s42 offen offset:1152
    buffer_load_dword v182, v98, s[72:75], s42 offen offset:2304
    s_add_u32 s42, s42, 221184
    buffer_load_dwordx4 v[184:187], v97, s[72:75], s42 offen
    buffer_load_dword v188, v98, s[72:75], s42 offen
    buffer_load_dword v189, v98, s[72:75], s42 offen offset:1152
    buffer_load_dword v190, v98, s[72:75], s42 offen offset:2304
    s_cmp_ge_u32 s3, 2
    s_cselect_b32 s8, s10, s8
    s_cselect_b32 s9, s11, s9
    s_mov_b32 s10, 5308416
    s_mov_b32 s11, 0x20000
    buffer_load_dwordx4 v[192:195], v99, s[8:11], s43 offen
    s_cselect_b32 s42, 2359296, 0
    s_add_u32 s42, s42, s43
    buffer_load_dwordx4 v[196:199], v99, s[8:11], s42 offen
    s_add_u32 s42, s43, 4718592
    buffer_load_dwordx4 v[232:235], v99, s[8:11], s42 offen
    s_or_b32 s42, s2, s3
    s_cmp_lg_u32 s42, 0
    s_cbranch_scc1 LS_nonce
    s_memrealtime s[42:43]
    s_waitcnt lgkmcnt(0)
    s_waitcnt lgkmcnt(0)
    s_lshl_b32 s42, s42, 4
    s_max_u32 s42, s42, 16
    v_mov_b32 v200, s42
    global_store_dword v201, v200, s[56:57] sc1
LS_nonce:
    s_cmp_lg_u32 s3, 1
    s_cbranch_scc1 LS_nophi
    s_cmp_ge_u32 s24, 6
    s_cbranch_scc1 LS_nophi
    s_mov_b32 s76, s48
    s_mov_b32 s77, s49
    s_mov_b32 s78, 20736
    s_mov_b32 s79, 0x20000
    s_cmp_ge_u32 s24, 3
    s_cselect_b32 s42, 1, 0
    s_mul_i32 s43, s42, 3
    s_sub_u32 s43, s24, s43
    v_and_b32 v203, 31, v0
    v_lshrrev_b32 v204, 5, v0
    v_bfe_u32 v205, v203, 2, 1
    v_lshrrev_b32 v206, 3, v203
    v_lshlrev_b32 v206, 2, v206
    v_and_b32 v207, 3, v203
    v_add_u32 v206, v206, v207
    s_lshl_b32 s42, s42, 4
    v_add_u32 v206, s42, v206
    s_mul_i32 s42, s25, 648
    v_lshlrev_b32 v207, 1, v206
    v_add_u32 v207, s42, v207
    v_cmp_gt_u32 vcc, 18, v206
    v_mov_b32 v228, 0
    v_mov_b32 v229, 0
    v_cndmask_b32 v207, v163, v207, vcc
    v_mov_b32 v230, 0
    v_mov_b32 v231, 0
    s_cmp_eq_u32 s43, 2
    s_cbranch_scc1 LS_p2
    v_cmp_eq_u32 vcc, s43, v205
    v_mul_u32_u24 v208, 144, v204
    s_nop 0
    v_cndmask_b32 v207, v163, v207, vcc
    v_add_u32 v207, v207, v208
    buffer_load_ushort v224, v207, s[76:79], 0 offen offset:0
    buffer_load_ushort v225, v207, s[76:79], 0 offen offset:36
    buffer_load_ushort v226, v207, s[76:79], 0 offen offset:72
    buffer_load_ushort v227, v207, s[76:79], 0 offen offset:108
    buffer_load_ushort v228, v207, s[76:79], 0 offen offset:288
    buffer_load_ushort v229, v207, s[76:79], 0 offen offset:324
    buffer_load_ushort v230, v207, s[76:79], 0 offen offset:360
    buffer_load_ushort v231, v207, s[76:79], 0 offen offset:396
    s_branch LS_nophi
LS_p2:
    v_cmp_eq_u32 vcc, 0, v204
    s_nop 1
    v_cndmask_b32 v207, v163, v207, vcc
    v_cmp_eq_u32 vcc, 0, v205
    s_nop 1
    v_cndmask_b32 v208, v163, v207, vcc
    v_cndmask_b32 v209, v207, v163, vcc
    buffer_load_ushort v224, v208, s[76:79], 0 offen offset:576
    buffer_load_ushort v225, v208, s[76:79], 0 offen offset:612
    buffer_load_ushort v226, v209, s[76:79], 0 offen offset:576
    buffer_load_ushort v227, v209, s[76:79], 0 offen offset:612
LS_nophi:
    s_waitcnt vmcnt(15)
    s_branch LS_ln
LS_w3a:
    s_mov_b32 s72, s8
    s_mov_b32 s73, s9
    s_mov_b32 s74, 5308416
    s_mov_b32 s75, 0x20000
    s_mov_b32 s8, s10
    s_mov_b32 s9, s11
    s_mov_b32 s10, 5308416
    s_mov_b32 s11, 0x20000
    s_mul_i32 s41, s66, 3072
    v_lshlrev_b32 v97, 7, v0
    v_add_u32 v97, s41, v97
    v_min_u32 v97, L_code_end-L_pc, v97
    s_mov_b64 exec, 0xffffff
    global_load_dword v168, v97, s[14:15]
    s_mov_b64 exec, -1
    s_and_b32 s62, s24, 3
    s_mul_i32 s62, s62, 1327104
    s_lshl_b32 s43, s25, 8
    s_add_u32 s62, s62, s43
    s_add_u32 s63, s62, 589824
    s_add_u32 s64, s62, 1179648
    v_mul_u32_u24 v165, 9216, v0
    s_lshl_b32 s48, s61, 5
    s_mul_i32 s49, s2, 36
    s_cmp_lt_u32 s2, 18
    s_cselect_b32 s52, s50, s52
    s_cselect_b32 s53, s51, s53
    s_mov_b32 s54, 5308416
    s_cselect_b32 s54, 663552, s54
    s_mov_b32 s44, 2
    s_mov_b32 s45, 8
    s_mov_b32 s46, 4
    s_cselect_b32 s47, 18, 16
    s_cselect_b32 s48, s49, s48
    s_sub_u32 s49, s2, 16
    s_mul_i32 s43, s49, 288
    s_add_u32 s43, s43, 16
    s_cmp_lt_u32 s49, 2
    s_cselect_b32 s48, s43, s48
    s_cselect_b32 s44, 18, s44
    s_cselect_b32 s45, 36, s45
    s_cselect_b32 s46, 72, s46
    s_cselect_b32 s47, 144, s47
    s_mul_i32 s48, s48, 1152
    s_mul_i32 s46, s46, 1152
    s_mul_i32 s47, s47, 1152
    s_movk_i32 s51, 1152
    v_add_u32 v176, 0, v0
    v_mul_u32_u24 v97, 911, v176
    v_lshrrev_b32 v97, 16, v97
    v_mul_u32_u24 v98, 72, v97
    v_sub_u32 v176, v176, v98
    v_and_b32 v98, 1, v97
    v_bfe_u32 v99, v97, 1, 1
    v_mad_u32_u24 v98, v99, s44, v98
    v_lshrrev_b32 v99, 2, v97
    v_mad_u32_u24 v98, v99, s45, v98
    v_mul_u32_u24 v98, s51, v98
    v_lshl_add_u32 v176, v176, 4, v98
    v_add_u32 v177, 64, v0
    v_mul_u32_u24 v97, 911, v177
    v_lshrrev_b32 v97, 16, v97
    v_mul_u32_u24 v98, 72, v97
    v_sub_u32 v177, v177, v98
    v_and_b32 v98, 1, v97
    v_bfe_u32 v99, v97, 1, 1
    v_mad_u32_u24 v98, v99, s44, v98
    v_lshrrev_b32 v99, 2, v97
    v_mad_u32_u24 v98, v99, s45, v98
    v_mul_u32_u24 v98, s51, v98
    v_lshl_add_u32 v177, v177, 4, v98
    v_add_u32 v178, 128, v0
    v_mul_u32_u24 v97, 911, v178
    v_lshrrev_b32 v97, 16, v97
    v_mul_u32_u24 v98, 72, v97
    v_sub_u32 v178, v178, v98
    v_and_b32 v98, 1, v97
    v_bfe_u32 v99, v97, 1, 1
    v_mad_u32_u24 v98, v99, s44, v98
    v_lshrrev_b32 v99, 2, v97
    v_mad_u32_u24 v98, v99, s45, v98
    v_mul_u32_u24 v98, s51, v98
    v_lshl_add_u32 v178, v178, 4, v98
    v_add_u32 v179, 192, v0
    v_mul_u32_u24 v97, 911, v179
    v_lshrrev_b32 v97, 16, v97
    v_mul_u32_u24 v98, 72, v97
    v_sub_u32 v179, v179, v98
    v_and_b32 v98, 1, v97
    v_bfe_u32 v99, v97, 1, 1
    v_mad_u32_u24 v98, v99, s44, v98
    v_lshrrev_b32 v99, 2, v97
    v_mad_u32_u24 v98, v99, s45, v98
    v_mul_u32_u24 v98, s51, v98
    v_lshl_add_u32 v179, v179, 4, v98
    v_add_u32 v180, 256, v0
    v_mul_u32_u24 v97, 911, v180
    v_lshrrev_b32 v97, 16, v97
    v_mul_u32_u24 v98, 72, v97
    v_sub_u32 v180, v180, v98
    v_and_b32 v98, 1, v97
    v_bfe_u32 v99, v97, 1, 1
    v_mad_u32_u24 v98, v99, s44, v98
    v_lshrrev_b32 v99, 2, v97
    v_mad_u32_u24 v98, v99, s45, v98
    v_mul_u32_u24 v98, s51, v98
    v_lshl_add_u32 v180, v180, 4, v98
    v_add_u32 v181, 320, v0
    v_mul_u32_u24 v97, 911, v181
    v_lshrrev_b32 v97, 16, v97
    v_mul_u32_u24 v98, 72, v97
    v_sub_u32 v181, v181, v98
    v_and_b32 v98, 1, v97
    v_bfe_u32 v99, v97, 1, 1
    v_mad_u32_u24 v98, v99, s44, v98
    v_lshrrev_b32 v99, 2, v97
    v_mad_u32_u24 v98, v99, s45, v98
    v_mul_u32_u24 v98, s51, v98
    v_lshl_add_u32 v181, v181, 4, v98
    v_add_u32 v182, 384, v0
    v_mul_u32_u24 v97, 911, v182
    v_lshrrev_b32 v97, 16, v97
    v_mul_u32_u24 v98, 72, v97
    v_sub_u32 v182, v182, v98
    v_and_b32 v98, 1, v97
    v_bfe_u32 v99, v97, 1, 1
    v_mad_u32_u24 v98, v99, s44, v98
    v_lshrrev_b32 v99, 2, v97
    v_mad_u32_u24 v98, v99, s45, v98
    v_mul_u32_u24 v98, s51, v98
    v_lshl_add_u32 v182, v182, 4, v98
    v_add_u32 v183, 448, v0
    v_mul_u32_u24 v97, 911, v183
    v_lshrrev_b32 v97, 16, v97
    v_mul_u32_u24 v98, 72, v97
    v_sub_u32 v183, v183, v98
    v_and_b32 v98, 1, v97
    v_bfe_u32 v99, v97, 1, 1
    v_mad_u32_u24 v98, v99, s44, v98
    v_lshrrev_b32 v99, 2, v97
    v_mad_u32_u24 v98, v99, s45, v98
    v_mul_u32_u24 v98, s51, v98
    v_lshl_add_u32 v183, v183, 4, v98
    v_add_u32 v184, 512, v0
    v_mul_u32_u24 v97, 911, v184
    v_lshrrev_b32 v97, 16, v97
    v_mul_u32_u24 v98, 72, v97
    v_sub_u32 v184, v184, v98
    v_and_b32 v98, 1, v97
    v_bfe_u32 v99, v97, 1, 1
    v_mad_u32_u24 v98, v99, s44, v98
    v_lshrrev_b32 v99, 2, v97
    v_mad_u32_u24 v98, v99, s45, v98
    v_mul_u32_u24 v98, s51, v98
    v_lshl_add_u32 v184, v184, 4, v98
    s_waitcnt vmcnt(1)
LS_ln:
    v_cmp_gt_u32 vcc, 36, v0
    v_lshlrev_b32 v108, 16, v100
    v_lshlrev_b32 v140, 16, v132
    v_and_b32 v109, 0xffff0000, v100
    v_and_b32 v141, 0xffff0000, v132
    v_lshlrev_b32 v110, 16, v101
    v_lshlrev_b32 v142, 16, v133
    v_and_b32 v111, 0xffff0000, v101
    v_and_b32 v143, 0xffff0000, v133
    v_lshlrev_b32 v112, 16, v102
    v_lshlrev_b32 v144, 16, v134
    v_and_b32 v113, 0xffff0000, v102
    v_and_b32 v145, 0xffff0000, v134
    v_lshlrev_b32 v114, 16, v103
    v_lshlrev_b32 v146, 16, v135
    v_and_b32 v115, 0xffff0000, v103
    v_and_b32 v147, 0xffff0000, v135
    v_lshlrev_b32 v116, 16, v104
    v_lshlrev_b32 v148, 16, v136
    v_and_b32 v117, 0xffff0000, v104
    v_and_b32 v149, 0xffff0000, v136
    v_lshlrev_b32 v118, 16, v105
    v_lshlrev_b32 v150, 16, v137
    v_and_b32 v119, 0xffff0000, v105
    v_and_b32 v151, 0xffff0000, v137
    v_lshlrev_b32 v120, 16, v106
    v_lshlrev_b32 v152, 16, v138
    v_and_b32 v121, 0xffff0000, v106
    v_and_b32 v153, 0xffff0000, v138
    v_lshlrev_b32 v122, 16, v107
    v_lshlrev_b32 v154, 16, v139
    v_and_b32 v123, 0xffff0000, v107
    v_and_b32 v155, 0xffff0000, v139
    v_add_f32 v124, v108, v109
    v_add_f32 v156, v140, v141
    v_add_f32 v124, v124, v110
    v_add_f32 v156, v156, v142
    v_add_f32 v124, v124, v111
    v_add_f32 v156, v156, v143
    v_add_f32 v124, v124, v112
    v_add_f32 v156, v156, v144
    v_add_f32 v124, v124, v113
    v_add_f32 v156, v156, v145
    global_load_dword v202, v201, s[56:57] sc1
    v_add_f32 v124, v124, v114
    v_add_f32 v156, v156, v146
    v_add_f32 v124, v124, v115
    v_add_f32 v156, v156, v147
    v_add_f32 v124, v124, v116
    v_add_f32 v156, v156, v148
    v_add_f32 v124, v124, v117
    v_add_f32 v156, v156, v149
    v_add_f32 v124, v124, v118
    v_add_f32 v156, v156, v150
    v_add_f32 v124, v124, v119
    v_add_f32 v156, v156, v151
    v_add_f32 v124, v124, v120
    v_add_f32 v156, v156, v152
    v_add_f32 v124, v124, v121
    v_add_f32 v156, v156, v153
    v_add_f32 v124, v124, v122
    v_add_f32 v156, v156, v154
    v_add_f32 v124, v124, v123
    v_add_f32 v156, v156, v155
    s_nop 0
    v_add_f32_dpp v124, v124, v124 row_shr:1 row_mask:0xf bank_mask:0xf bound_ctrl:0
    v_add_f32_dpp v156, v156, v156 row_shr:1 row_mask:0xf bank_mask:0xf bound_ctrl:0
    s_nop 0
    v_add_f32_dpp v124, v124, v124 row_shr:2 row_mask:0xf bank_mask:0xf bound_ctrl:0
    v_add_f32_dpp v156, v156, v156 row_shr:2 row_mask:0xf bank_mask:0xf bound_ctrl:0
    s_nop 0
    v_add_f32_dpp v124, v124, v124 row_shr:4 row_mask:0xf bank_mask:0xf bound_ctrl:0
    v_add_f32_dpp v156, v156, v156 row_shr:4 row_mask:0xf bank_mask:0xf bound_ctrl:0
    s_nop 0
    v_add_f32_dpp v124, v124, v124 row_shr:8 row_mask:0xf bank_mask:0xf bound_ctrl:0
    v_add_f32_dpp v156, v156, v156 row_shr:8 row_mask:0xf bank_mask:0xf bound_ctrl:0
    s_nop 0
    v_add_f32_dpp v124, v124, v124 row_bcast:15 row_mask:0xa bank_mask:0xf
    v_add_f32_dpp v156, v156, v156 row_bcast:15 row_mask:0xa bank_mask:0xf
    s_nop 0
    v_add_f32_dpp v124, v124, v124 row_bcast:31 row_mask:0xc bank_mask:0xf
    v_add_f32_dpp v156, v156, v156 row_bcast:31 row_mask:0xc bank_mask:0xf
    v_readlane_b32 s41, v124, 63
    v_readlane_b32 s42, v156, 63
    v_mov_b32 v125, 0x3ae38e39
    v_mov_b32 v157, 0x3ae38e39
    v_mul_f32 v125, s41, v125
    v_mul_f32 v157, s42, v157
    v_sub_f32 v126, v108, v125
    v_sub_f32 v158, v140, v157
    v_mul_f32 v124, v126, v126
    v_mul_f32 v156, v158, v158
    v_sub_f32 v126, v109, v125
    v_sub_f32 v158, v141, v157
    v_fmac_f32 v124, v126, v126
    v_fmac_f32 v156, v158, v158
    v_sub_f32 v126, v110, v125
    v_sub_f32 v158, v142, v157
    v_fmac_f32 v124, v126, v126
    v_fmac_f32 v156, v158, v158
    v_sub_f32 v126, v111, v125
    v_sub_f32 v158, v143, v157
    v_fmac_f32 v124, v126, v126
    v_fmac_f32 v156, v158, v158
    v_sub_f32 v126, v112, v125
    v_sub_f32 v158, v144, v157
    v_fmac_f32 v124, v126, v126
    v_fmac_f32 v156, v158, v158
    v_sub_f32 v126, v113, v125
    v_sub_f32 v158, v145, v157
    v_fmac_f32 v124, v126, v126
    v_fmac_f32 v156, v158, v158
    v_sub_f32 v126, v114, v125
    v_sub_f32 v158, v146, v157
    v_fmac_f32 v124, v126, v126
    v_fmac_f32 v156, v158, v158
    v_sub_f32 v126, v115, v125
    v_sub_f32 v158, v147, v157
    v_fmac_f32 v124, v126, v126
    v_fmac_f32 v156, v158, v158
    v_sub_f32 v126, v116, v125
    v_sub_f32 v158, v148, v157
    v_fmac_f32 v124, v126, v126
    v_fmac_f32 v156, v158, v158
    v_sub_f32 v126, v117, v125
    v_sub_f32 v158, v149, v157
    v_fmac_f32 v124, v126, v126
    v_fmac_f32 v156, v158, v158
    v_sub_f32 v126, v118, v125
    v_sub_f32 v158, v150, v157
    v_fmac_f32 v124, v126, v126
    v_fmac_f32 v156, v158, v158
    v_sub_f32 v126, v119, v125
    v_sub_f32 v158, v151, v157
    v_fmac_f32 v124, v126, v126
    v_fmac_f32 v156, v158, v158
    v_sub_f32 v126, v120, v125
    v_sub_f32 v158, v152, v157
    v_fmac_f32 v124, v126, v126
    v_fmac_f32 v156, v158, v158
    v_sub_f32 v126, v121, v125
    v_sub_f32 v158, v153, v157
    v_fmac_f32 v124, v126, v126
    v_fmac_f32 v156, v158, v158
    v_sub_f32 v126, v122, v125
    v_sub_f32 v158, v154, v157
    v_fmac_f32 v124, v126, v126
    v_fmac_f32 v156, v158, v158
    v_sub_f32 v126, v123, v125
    v_sub_f32 v158, v155, v157
    v_fmac_f32 v124, v126, v126
    v_fmac_f32 v156, v158, v158
    v_cndmask_b32 v124, 0, v124, vcc
    v_cndmask_b32 v156, 0, v156, vcc
    s_nop 0
    v_add_f32_dpp v124, v124, v124 row_shr:1 row_mask:0xf bank_mask:0xf bound_ctrl:0
    v_add_f32_dpp v156, v156, v156 row_shr:1 row_mask:0xf bank_mask:0xf bound_ctrl:0
    s_nop 0
    v_add_f32_dpp v124, v124, v124 row_shr:2 row_mask:0xf bank_mask:0xf bound_ctrl:0
    v_add_f32_dpp v156, v156, v156 row_shr:2 row_mask:0xf bank_mask:0xf bound_ctrl:0
    s_nop 0
    v_add_f32_dpp v124, v124, v124 row_shr:4 row_mask:0xf bank_mask:0xf bound_ctrl:0
    v_add_f32_dpp v156, v156, v156 row_shr:4 row_mask:0xf bank_mask:0xf bound_ctrl:0
    s_nop 0
    v_add_f32_dpp v124, v124, v124 row_shr:8 row_mask:0xf bank_mask:0xf bound_ctrl:0
    v_add_f32_dpp v156, v156, v156 row_shr:8 row_mask:0xf bank_mask:0xf bound_ctrl:0
    s_nop 0
    v_add_f32_dpp v124, v124, v124 row_bcast:15 row_mask:0xa bank_mask:0xf
    v_add_f32_dpp v156, v156, v156 row_bcast:15 row_mask:0xa bank_mask:0xf
    s_nop 0
    v_add_f32_dpp v124, v124, v124 row_bcast:31 row_mask:0xc bank_mask:0xf
    v_add_f32_dpp v156, v156, v156 row_bcast:31 row_mask:0xc bank_mask:0xf
    v_readlane_b32 s41, v124, 63
    v_readlane_b32 s42, v156, 63
    v_mov_b32 v127, 0x3ae38e39
    v_mov_b32 v159, 0x3ae38e39
    v_mul_f32 v127, s41, v127
    v_mul_f32 v159, s42, v159
    v_cvt_pk_bf16_f32 v125, v125, v125
    v_cvt_pk_bf16_f32 v157, v157, v157
    v_lshlrev_b32 v125, 16, v125
    v_lshlrev_b32 v157, 16, v157
    v_cvt_pk_bf16_f32 v127, v127, v127
    v_cvt_pk_bf16_f32 v159, v159, v159
    v_lshlrev_b32 v127, 16, v127
    v_lshlrev_b32 v159, 16, v159
    v_add_f32 v127, 0x3727c5ac, v127
    v_add_f32 v159, 0x3727c5ac, v159
    v_cvt_pk_bf16_f32 v127, v127, v127
    v_cvt_pk_bf16_f32 v159, v159, v159
    v_lshlrev_b32 v127, 16, v127
    v_lshlrev_b32 v159, 16, v159
    v_sqrt_f32 v127, v127
    v_sqrt_f32 v159, v159
    v_cvt_pk_bf16_f32 v127, v127, v127
    v_cvt_pk_bf16_f32 v159, v159, v159
    v_lshlrev_b32 v127, 16, v127
    v_lshlrev_b32 v159, 16, v159
    v_rcp_f32 v127, v127
    v_rcp_f32 v159, v159
    v_sub_f32 v108, v108, v125
    v_sub_f32 v140, v140, v157
    v_sub_f32 v109, v109, v125
    v_sub_f32 v141, v141, v157
    v_sub_f32 v110, v110, v125
    v_sub_f32 v142, v142, v157
    v_sub_f32 v111, v111, v125
    v_sub_f32 v143, v143, v157
    v_sub_f32 v112, v112, v125
    v_sub_f32 v144, v144, v157
    v_sub_f32 v113, v113, v125
    v_sub_f32 v145, v145, v157
    v_sub_f32 v114, v114, v125
    v_sub_f32 v146, v146, v157
    v_sub_f32 v115, v115, v125
    v_sub_f32 v147, v147, v157
    v_sub_f32 v116, v116, v125
    v_sub_f32 v148, v148, v157
    v_sub_f32 v117, v117, v125
    v_sub_f32 v149, v149, v157
    v_sub_f32 v118, v118, v125
    v_sub_f32 v150, v150, v157
    v_sub_f32 v119, v119, v125
    v_sub_f32 v151, v151, v157
    v_sub_f32 v120, v120, v125
    v_sub_f32 v152, v152, v157
    v_sub_f32 v121, v121, v125
    v_sub_f32 v153, v153, v157
    v_sub_f32 v122, v122, v125
    v_sub_f32 v154, v154, v157
    v_sub_f32 v123, v123, v125
    v_sub_f32 v155, v155, v157
    v_cvt_pk_bf16_f32 v100, v108, v109
    v_cvt_pk_bf16_f32 v132, v140, v141
    v_cvt_pk_bf16_f32 v101, v110, v111
    v_cvt_pk_bf16_f32 v133, v142, v143
    v_cvt_pk_bf16_f32 v102, v112, v113
    v_cvt_pk_bf16_f32 v134, v144, v145
    v_cvt_pk_bf16_f32 v103, v114, v115
    v_cvt_pk_bf16_f32 v135, v146, v147
    v_cvt_pk_bf16_f32 v104, v116, v117
    v_cvt_pk_bf16_f32 v136, v148, v149
    v_cvt_pk_bf16_f32 v105, v118, v119
    v_cvt_pk_bf16_f32 v137, v150, v151
    v_cvt_pk_bf16_f32 v106, v120, v121
    v_cvt_pk_bf16_f32 v138, v152, v153
    v_cvt_pk_bf16_f32 v107, v122, v123
    v_cvt_pk_bf16_f32 v139, v154, v155
    v_lshlrev_b32 v108, 16, v100
    v_lshlrev_b32 v140, 16, v132
    v_and_b32 v109, 0xffff0000, v100
    v_and_b32 v141, 0xffff0000, v132
    v_lshlrev_b32 v110, 16, v101
    v_lshlrev_b32 v142, 16, v133
    v_and_b32 v111, 0xffff0000, v101
    v_and_b32 v143, 0xffff0000, v133
    v_lshlrev_b32 v112, 16, v102
    v_lshlrev_b32 v144, 16, v134
    v_and_b32 v113, 0xffff0000, v102
    v_and_b32 v145, 0xffff0000, v134
    v_lshlrev_b32 v114, 16, v103
    v_lshlrev_b32 v146, 16, v135
    v_and_b32 v115, 0xffff0000, v103
    v_and_b32 v147, 0xffff0000, v135
    v_lshlrev_b32 v116, 16, v104
    v_lshlrev_b32 v148, 16, v136
    v_and_b32 v117, 0xffff0000, v104
    v_and_b32 v149, 0xffff0000, v136
    v_lshlrev_b32 v118, 16, v105
    v_lshlrev_b32 v150, 16, v137
    v_and_b32 v119, 0xffff0000, v105
    v_and_b32 v151, 0xffff0000, v137
    v_lshlrev_b32 v120, 16, v106
    v_lshlrev_b32 v152, 16, v138
    v_and_b32 v121, 0xffff0000, v106
    v_and_b32 v153, 0xffff0000, v138
    v_lshlrev_b32 v122, 16, v107
    v_lshlrev_b32 v154, 16, v139
    v_and_b32 v123, 0xffff0000, v107
    v_and_b32 v155, 0xffff0000, v139
    v_mul_f32 v108, v108, v127
    v_mul_f32 v140, v140, v159
    v_mul_f32 v109, v109, v127
    v_mul_f32 v141, v141, v159
    v_mul_f32 v110, v110, v127
    v_mul_f32 v142, v142, v159
    v_mul_f32 v111, v111, v127
    v_mul_f32 v143, v143, v159
    v_mul_f32 v112, v112, v127
    v_mul_f32 v144, v144, v159
    v_mul_f32 v113, v113, v127
    v_mul_f32 v145, v145, v159
    v_mul_f32 v114, v114, v127
    v_mul_f32 v146, v146, v159
    v_mul_f32 v115, v115, v127
    v_mul_f32 v147, v147, v159
    v_mul_f32 v116, v116, v127
    v_mul_f32 v148, v148, v159
    v_mul_f32 v117, v117, v127
    v_mul_f32 v149, v149, v159
    v_mul_f32 v118, v118, v127
    v_mul_f32 v150, v150, v159
    v_mul_f32 v119, v119, v127
    v_mul_f32 v151, v151, v159
    v_mul_f32 v120, v120, v127
    v_mul_f32 v152, v152, v159
    v_mul_f32 v121, v121, v127
    v_mul_f32 v153, v153, v159
    v_mul_f32 v122, v122, v127
    v_mul_f32 v154, v154, v159
    v_mul_f32 v123, v123, v127
    v_mul_f32 v155, v155, v159
    v_cvt_pk_bf16_f32 v100, v108, v109
    v_cvt_pk_bf16_f32 v132, v140, v141
    v_cvt_pk_bf16_f32 v101, v110, v111
    v_cvt_pk_bf16_f32 v133, v142, v143
    v_cvt_pk_bf16_f32 v102, v112, v113
    v_cvt_pk_bf16_f32 v134, v144, v145
    v_cvt_pk_bf16_f32 v103, v114, v115
    v_cvt_pk_bf16_f32 v135, v146, v147
    v_cvt_pk_bf16_f32 v104, v116, v117
    v_cvt_pk_bf16_f32 v136, v148, v149
    v_cvt_pk_bf16_f32 v105, v118, v119
    v_cvt_pk_bf16_f32 v137, v150, v151
    v_cvt_pk_bf16_f32 v106, v120, v121
    v_cvt_pk_bf16_f32 v138, v152, v153
    v_cvt_pk_bf16_f32 v107, v122, v123
    v_cvt_pk_bf16_f32 v139, v154, v155
    ds_write_b128 v164, v[100:103] offset:0
    ds_write_b128 v164, v[132:135] offset:16
    ds_write_b128 v164, v[104:107] offset:128
    ds_write_b128 v164, v[136:139] offset:144
    s_cmp_eq_u32 s3, 3
    s_cbranch_scc1 LS_w3b
    s_mul_i32 s41, s25, 9
    s_mul_i32 s42, s3, 3
    s_add_u32 s41, s41, s42
    s_lshl_b32 s41, s41, 13
    s_lshl_b32 s42, s24, 9
    s_add_u32 s41, s41, s42
    s_add_u32 s41, s41, 2359296
    s_waitcnt vmcnt(0)
    v_or_b32 v168, v168, v172
    v_or_b32 v169, v169, v173
    v_or_b32 v170, v170, v174
    buffer_store_dwordx4 v[168:171], v165, s[4:7], s41 offen sc1
    s_add_u32 s41, s41, 8192
    v_or_b32 v176, v176, v180
    v_or_b32 v177, v177, v181
    v_or_b32 v178, v178, v182
    buffer_store_dwordx4 v[176:179], v165, s[4:7], s41 offen sc1
    s_add_u32 s41, s41, 8192
    v_or_b32 v184, v184, v188
    v_or_b32 v185, v185, v189
    v_or_b32 v186, v186, v190
    buffer_store_dwordx4 v[184:187], v165, s[4:7], s41 offen sc1
    s_mul_i32 s41, s25, 40960
    s_add_u32 s41, s41, s42
    s_lshr_b32 s43, s3, 1
    s_lshl_b32 s43, s43, 12
    s_add_u32 s41, s41, s43
    s_add_u32 s41, s41, 4718592
    buffer_store_dwordx4 v[192:195], v166, s[4:7], s41 offen sc1
    s_add_u32 s42, s41, 16384
    s_cmp_eq_u32 s3, 2
    s_cselect_b32 s42, s42, 2147483632
    buffer_store_dwordx4 v[196:199], v166, s[4:7], s42 offen sc1
    s_add_u32 s41, s41, 32768
    buffer_store_dwordx4 v[232:235], v167, s[4:7], s41 offen sc1
    s_cmp_lg_u32 s3, 1
    s_cbranch_scc1 LS_nophi2
    s_cmp_ge_u32 s24, 6
    s_cbranch_scc1 LS_nophi2
    v_lshl_or_b32 v216, v225, 16, v224
    v_lshl_or_b32 v217, v227, 16, v226
    v_lshl_or_b32 v218, v229, 16, v228
    v_lshl_or_b32 v219, v231, 16, v230
    s_mul_i32 s42, s25, 6
    s_add_u32 s42, s42, s24
    s_lshl_b32 s42, s42, 10
    s_add_u32 s42, s42, 6029312
    buffer_store_dwordx4 v[216:219], v1, s[4:7], s42 offen sc1
LS_nophi2:
    s_lshl_b32 s41, s24, 3
    s_lshr_b32 s42, s25, 2
    s_add_u32 s41, s41, s42
    s_mul_i32 s41, s41, 36864
    s_and_b32 s42, s25, 3
    s_lshl_b32 s42, s42, 7
    s_add_u32 s41, s41, s42
    s_mul_i32 s42, s3, 12288
    s_add_u32 s41, s41, s42
    s_add_u32 s41, s41, 0
    s_add_u32 s42, s41, 0x1000
    s_add_u32 s43, s41, 0x2000
    s_mul_i32 s44, s3, 3072
    s_add_u32 s44, s44, 106496
    v_add_u32 v160, s44, v1
    v_lshrrev_b32 v161, 3, v0
    v_lshlrev_b32 v161, 9, v161
    v_and_b32 v162, 7, v0
    v_lshl_add_u32 v161, v162, 4, v161
    s_waitcnt lgkmcnt(0)
    s_barrier
    ds_read_b128 v[100:103], v160
    ds_read_b128 v[104:107], v160 offset:1024
    ds_read_b128 v[108:111], v160 offset:2048
    s_waitcnt lgkmcnt(2)
    buffer_store_dwordx4 v[100:103], v161, s[4:7], s41 offen sc1
    s_waitcnt lgkmcnt(1)
    buffer_store_dwordx4 v[104:107], v161, s[4:7], s42 offen sc1
    s_waitcnt lgkmcnt(0)
    buffer_store_dwordx4 v[108:111], v161, s[4:7], s43 offen sc1
    s_branch LS_nz
LS_w3b:
    s_waitcnt lgkmcnt(0)
    s_barrier
    s_waitcnt vmcnt(0)
LS_nz:
    s_lshl_b32 s41, s24, 2
    s_add_u32 s41, s41, s3
    s_lshl_b32 s78, s41, 12
    s_add_u32 s78, s78, 45842432
    s_lshl_b32 s41, s25, 7
    s_add_u32 s60, s78, s41
    s_mov_b32 s41, 400000
LS_nw:
    v_readfirstlane_b32 s67, v202
    s_nop 1
    s_cmp_lg_u32 s67, 0
    s_cbranch_scc1 LS_nok
    global_load_dword v202, v201, s[56:57] sc1
    s_waitcnt vmcnt(0)
    s_sub_u32 s41, s41, 1
    s_cmp_lg_u32 s41, 0
    s_cbranch_scc1 LS_nw
LS_nok:
    s_cmp_eq_u32 s3, 3
    s_cbranch_scc1 LS_w3c
    s_add_u32 s44, s67, 1
    v_mov_b32 v200, s44
    v_lshlrev_b32 v96, 7, v0
    s_lshl_b32 s41, s24, 14
    v_add_u32 v96, s41, v96
    v_and_b32 v97, 7, v0
    v_lshlrev_b32 v97, 14, v97
    s_lshl_b32 s43, s25, 7
    v_add_u32 v97, s43, v97
    v_cmp_gt_u32 vcc, 32, v0
    s_mov_b32 s45, 400000
    s_mov_b32 s41, 45842432
    v_cndmask_b32 v96, v97, v96, vcc
    s_waitcnt vmcnt(0)
    s_barrier
    s_cmp_lg_u32 s3, 0
    s_cbranch_scc1 LS_join
    s_mov_b64 exec, 1
    buffer_store_dword v200, off, s[4:7], s60 sc1
    s_mov_b64 exec, -1
    s_sleep 8
LS_pl:
    buffer_load_dword v100, v96, s[4:7], s41 offen sc1
    s_waitcnt vmcnt(0)
    v_subrev_u32 v100, s44, v100
    v_cmp_le_u32 vcc, 8, v100
    s_nop 4
    s_cbranch_vccz LS_join
    s_sub_u32 s45, s45, 1
    s_cmp_lg_u32 s45, 0
    s_cbranch_scc1 LS_pl
    s_branch LS_join
LS_w3c:
    s_barrier
    buffer_load_dword v169, v165, s[72:75], s62 offen
    buffer_load_dword v170, v165, s[8:11], s62 offen
    buffer_load_dword v171, v165, s[72:75], s63 offen
    buffer_load_dword v172, v165, s[8:11], s63 offen
    s_mov_b64 exec, 0xffff
    buffer_load_dword v173, v165, s[72:75], s64 offen
    buffer_load_dword v174, v165, s[8:11], s64 offen
    s_mov_b64 exec, -1
    s_cmp_ge_u32 s2, 162
    s_cbranch_scc1 LS_nowd
    s_mov_b32 m0, 122880
    s_nop 0
    buffer_load_dwordx4 v176, s[52:55], s48 offen lds
    s_mov_b32 m0, 123904
    s_nop 0
    buffer_load_dwordx4 v177, s[52:55], s48 offen lds
    s_mov_b32 m0, 124928
    s_nop 0
    buffer_load_dwordx4 v178, s[52:55], s48 offen lds
    s_mov_b32 m0, 125952
    s_nop 0
    buffer_load_dwordx4 v179, s[52:55], s48 offen lds
    s_mov_b32 m0, 126976
    s_nop 0
    buffer_load_dwordx4 v180, s[52:55], s48 offen lds
    s_mov_b32 m0, 128000
    s_nop 0
    buffer_load_dwordx4 v181, s[52:55], s48 offen lds
    s_mov_b32 m0, 129024
    s_nop 0
    buffer_load_dwordx4 v182, s[52:55], s48 offen lds
    s_mov_b32 m0, 130048
    s_nop 0
    buffer_load_dwordx4 v183, s[52:55], s48 offen lds
    s_mov_b32 m0, 131072
    s_nop 0
    buffer_load_dwordx4 v184, s[52:55], s48 offen lds
    s_add_u32 s49, s48, s46
    s_mov_b32 m0, 132096
    s_nop 0
    buffer_load_dwordx4 v176, s[52:55], s49 offen lds
    s_mov_b32 m0, 133120
    s_nop 0
    buffer_load_dwordx4 v177, s[52:55], s49 offen lds
    s_mov_b32 m0, 134144
    s_nop 0
    buffer_load_dwordx4 v178, s[52:55], s49 offen lds
    s_mov_b32 m0, 135168
    s_nop 0
    buffer_load_dwordx4 v179, s[52:55], s49 offen lds
    s_mov_b32 m0, 136192
    s_nop 0
    buffer_load_dwordx4 v180, s[52:55], s49 offen lds
    s_mov_b32 m0, 137216
    s_nop 0
    buffer_load_dwordx4 v181, s[52:55], s49 offen lds
    s_mov_b32 m0, 138240
    s_nop 0
    buffer_load_dwordx4 v182, s[52:55], s49 offen lds
    s_mov_b32 m0, 139264
    s_nop 0
    buffer_load_dwordx4 v183, s[52:55], s49 offen lds
    s_mov_b32 m0, 140288
    s_nop 0
    buffer_load_dwordx4 v184, s[52:55], s49 offen lds
    s_add_u32 s49, s48, s47
    s_mov_b32 m0, 141312
    s_nop 0
    buffer_load_dwordx4 v176, s[52:55], s49 offen lds
    s_mov_b32 m0, 142336
    s_nop 0
    buffer_load_dwordx4 v177, s[52:55], s49 offen lds
    s_mov_b32 m0, 143360
    s_nop 0
    buffer_load_dwordx4 v178, s[52:55], s49 offen lds
    s_mov_b32 m0, 144384
    s_nop 0
    buffer_load_dwordx4 v179, s[52:55], s49 offen lds
    s_mov_b32 m0, 145408
    s_nop 0
    buffer_load_dwordx4 v180, s[52:55], s49 offen lds
    s_mov_b32 m0, 146432
    s_nop 0
    buffer_load_dwordx4 v181, s[52:55], s49 offen lds
    s_mov_b32 m0, 147456
    s_nop 0
    buffer_load_dwordx4 v182, s[52:55], s49 offen lds
    s_mov_b32 m0, 148480
    s_nop 0
    buffer_load_dwordx4 v183, s[52:55], s49 offen lds
    s_mov_b32 m0, 149504
    s_nop 0
    buffer_load_dwordx4 v184, s[52:55], s49 offen lds
    s_add_u32 s49, s49, s46
    s_mov_b32 m0, 150528
    s_nop 0
    buffer_load_dwordx4 v176, s[52:55], s49 offen lds
    s_mov_b32 m0, 151552
    s_nop 0
    buffer_load_dwordx4 v177, s[52:55], s49 offen lds
    s_mov_b32 m0, 152576
    s_nop 0
    buffer_load_dwordx4 v178, s[52:55], s49 offen lds
    s_mov_b32 m0, 153600
    s_nop 0
    buffer_load_dwordx4 v179, s[52:55], s49 offen lds
    s_mov_b32 m0, 154624
    s_nop 0
    buffer_load_dwordx4 v180, s[52:55], s49 offen lds
    s_mov_b32 m0, 155648
    s_nop 0
    buffer_load_dwordx4 v181, s[52:55], s49 offen lds
    s_mov_b32 m0, 156672
    s_nop 0
    buffer_load_dwordx4 v182, s[52:55], s49 offen lds
    s_mov_b32 m0, 157696
    s_nop 0
    buffer_load_dwordx4 v183, s[52:55], s49 offen lds
    s_mov_b32 m0, 158720
    s_nop 0
    buffer_load_dwordx4 v184, s[52:55], s49 offen lds
LS_nowd:
LS_join:
    s_barrier
    s_add_u32 m0, s26, 0
    s_add_u32 s34, s30, 0
    buffer_load_dwordx4 v1, s[4:7], s34 offen sc1 lds
    s_add_u32 m0, s26, 0
    s_nop 0
    buffer_load_dwordx4 v1, s[4:7], s34 offen offset:1024 sc1 lds
    s_add_u32 m0, s26, 8192
    s_add_u32 s34, s31, 0
    buffer_load_dwordx4 v1, s[4:7], s34 offen sc1 lds
    s_add_u32 m0, s26, 8192
    s_nop 0
    buffer_load_dwordx4 v1, s[4:7], s34 offen offset:1024 sc1 lds
    s_add_u32 s36, s28, 0
    s_add_u32 s37, s29, 0
    buffer_load_dwordx4 a[0:3], v1, s[4:7], s36 offen offset:0 sc1
    buffer_load_dwordx4 a[4:7], v1, s[4:7], s37 offen offset:0 sc1
    buffer_load_dwordx4 a[8:11], v1, s[4:7], s36 offen offset:1024 sc1
    buffer_load_dwordx4 a[12:15], v1, s[4:7], s37 offen offset:1024 sc1
    buffer_load_dwordx4 a[16:19], v1, s[4:7], s36 offen offset:2048 sc1
    buffer_load_dwordx4 a[20:23], v1, s[4:7], s37 offen offset:2048 sc1
    buffer_load_dwordx4 a[24:27], v1, s[4:7], s36 offen offset:3072 sc1
    buffer_load_dwordx4 a[28:31], v1, s[4:7], s37 offen offset:3072 sc1
    s_add_u32 m0, s26, 16384
    s_add_u32 s34, s30, 8192
    buffer_load_dwordx4 v1, s[4:7], s34 offen sc1 lds
    s_add_u32 m0, s26, 16384
    s_nop 0
    buffer_load_dwordx4 v1, s[4:7], s34 offen offset:1024 sc1 lds
    s_add_u32 s36, s28, 4096
    s_add_u32 s37, s29, 4096
    buffer_load_dwordx4 a[32:35], v1, s[4:7], s36 offen offset:0 sc1
    buffer_load_dwordx4 a[36:39], v1, s[4:7], s37 offen offset:0 sc1
    buffer_load_dwordx4 a[40:43], v1, s[4:7], s36 offen offset:1024 sc1
    buffer_load_dwordx4 a[44:47], v1, s[4:7], s37 offen offset:1024 sc1
    buffer_load_dwordx4 a[48:51], v1, s[4:7], s36 offen offset:2048 sc1
    buffer_load_dwordx4 a[52:55], v1, s[4:7], s37 offen offset:2048 sc1
    buffer_load_dwordx4 a[56:59], v1, s[4:7], s36 offen offset:3072 sc1
    buffer_load_dwordx4 a[60:63], v1, s[4:7], s37 offen offset:3072 sc1
    s_waitcnt vmcnt(18)
    s_barrier
    ds_read_b64_tr_b16 v[48:49], v5 offset:0
    ds_read_b64_tr_b16 v[50:51], v5 offset:256
    ds_read_b64_tr_b16 v[52:53], v6 offset:0
    ds_read_b64_tr_b16 v[54:55], v6 offset:256
    ds_read_b64_tr_b16 v[56:57], v5 offset:8192
    ds_read_b64_tr_b16 v[58:59], v5 offset:8448
    ds_read_b64_tr_b16 v[60:61], v5 offset:1024
    ds_read_b64_tr_b16 v[62:63], v5 offset:1280
    ds_read_b64_tr_b16 v[64:65], v6 offset:1024
    ds_read_b64_tr_b16 v[66:67], v6 offset:1280
    s_waitcnt lgkmcnt(6)
    s_waitcnt vmcnt(17)
    v_mfma_f32_32x32x16_bf16 v[96:111], v[48:51], a[0:3], 0
    ds_read_b64_tr_b16 v[68:69], v5 offset:9216
    s_add_u32 m0, s26, 24576
    s_add_u32 s34, s30, 16384
    buffer_load_dwordx4 v1, s[4:7], s34 offen sc1 lds
    s_lshr_b32 s39, s3, 1
    s_waitcnt vmcnt(17)
    v_mfma_f32_32x32x16_bf16 v[128:143], v[48:51], a[4:7], 0
    ds_read_b64_tr_b16 v[70:71], v5 offset:9472
    s_and_b32 s40, s3, 1
    s_lshl_b32 s27, s39, 12
    s_lshl_b32 s38, s40, 11
    s_add_u32 s27, s27, s38
    s_mul_i32 s32, s40, 294912
    v_mfma_f32_32x32x16_bf16 v[112:127], v[52:55], a[0:3], 0
    ds_read_b64_tr_b16 v[48:49], v5 offset:2048
    s_add_u32 m0, s26, 24576
    s_nop 0
    buffer_load_dwordx4 v1, s[4:7], s34 offen offset:1024 sc1 lds
    s_lshl_b32 s38, s25, 8
    v_mfma_f32_32x32x16_bf16 v[144:159], v[52:55], a[4:7], 0
    ds_read_b64_tr_b16 v[50:51], v5 offset:2304
    s_add_u32 s32, s32, s38
    v_lshrrev_b32 v2, 2, v0
    s_movk_i32 s38, 9216
    v_mul_lo_u32 v2, v2, s38
    s_waitcnt lgkmcnt(6)
    v_mfma_f32_32x32x16_bf16 v[160:175], v[56:59], a[0:3], 0
    ds_read_b64_tr_b16 v[52:53], v6 offset:2048
    s_add_u32 m0, s26, 32768
    s_add_u32 s34, s31, 8192
    buffer_load_dwordx4 v1, s[4:7], s34 offen sc1 lds
    v_bfe_u32 v3, v0, 1, 1
    v_mfma_f32_32x32x16_bf16 v[176:191], v[56:59], a[4:7], 0
    ds_read_b64_tr_b16 v[54:55], v6 offset:2304
    v_xor_b32 v3, s39, v3
    v_lshlrev_b32 v3, 5, v3
    v_and_b32 v4, 1, v0
    v_lshlrev_b32 v4, 4, v4
    v_add3_u32 v2, v2, v3, v4
    s_waitcnt vmcnt(18)
    v_mfma_f32_32x32x16_bf16 v[96:111], v[60:63], a[8:11], v[96:111]
    ds_read_b64_tr_b16 v[56:57], v5 offset:10240
    s_add_u32 m0, s26, 32768
    s_nop 0
    buffer_load_dwordx4 v1, s[4:7], s34 offen offset:1024 sc1 lds
    s_add_u32 s36, s28, 8192
    s_waitcnt vmcnt(18)
    v_mfma_f32_32x32x16_bf16 v[128:143], v[60:63], a[12:15], v[128:143]
    ds_read_b64_tr_b16 v[58:59], v5 offset:10496
    s_add_u32 s37, s29, 8192
    s_mul_i32 s33, s25, 6144
    s_add_u32 s33, s33, s26
    s_add_u32 s33, s33, 6029312
    s_waitcnt lgkmcnt(6)
    v_mfma_f32_32x32x16_bf16 v[112:127], v[64:67], a[8:11], v[112:127]
    ds_read_b64_tr_b16 v[60:61], v5 offset:3072
    buffer_load_dwordx4 a[64:67], v1, s[4:7], s36 offen offset:0 sc1
    v_lshrrev_b32 v254, 4, v0
    v_lshlrev_b32 v254, 3, v254
    v_bfe_u32 v255, v0, 2, 2
    v_mfma_f32_32x32x16_bf16 v[144:159], v[64:67], a[12:15], v[144:159]
    ds_read_b64_tr_b16 v[62:63], v5 offset:3328
    v_add_u32 v254, v254, v255
    v_mul_u32_u24 v254, 1152, v254
    v_and_b32 v255, 3, v0
    v_lshl_add_u32 v254, v255, 3, v254
    s_mul_i32 s41, s3, 288
    v_mfma_f32_32x32x16_bf16 v[160:175], v[68:71], a[8:11], v[160:175]
    ds_read_b64_tr_b16 v[64:65], v6 offset:3072
    buffer_load_dwordx4 a[68:71], v1, s[4:7], s37 offen offset:0 sc1
    s_add_u32 s41, s41, 122880
    v_add_u32 v254, s41, v254
    s_sub_u32 s41, s2, 18
    v_mfma_f32_32x32x16_bf16 v[176:191], v[68:71], a[12:15], v[176:191]
    ds_read_b64_tr_b16 v[66:67], v6 offset:3328
    s_mul_i32 s42, s3, 144
    s_add_u32 s42, s42, s41
    s_mul_i32 s44, s42, 5120
    s_add_u32 s44, s44, 7110656
    s_waitcnt lgkmcnt(6)
    s_waitcnt vmcnt(19)
    v_mfma_f32_32x32x16_bf16 v[96:111], v[48:51], a[16:19], v[96:111]
    ds_read_b64_tr_b16 v[68:69], v5 offset:11264
    buffer_load_dwordx4 a[72:75], v1, s[4:7], s36 offen offset:1024 sc1
    s_lshl_b32 s45, s42, 11
    s_add_u32 s46, s45, 11239424
    s_add_u32 s45, s45, 10059776
    s_waitcnt vmcnt(19)
    v_mfma_f32_32x32x16_bf16 v[128:143], v[48:51], a[20:23], v[128:143]
    ds_read_b64_tr_b16 v[70:71], v5 offset:11520
    s_add_u32 s47, s44, 2048
    s_add_u32 s50, s44, 4096
    s_mul_i32 s51, s3, 72
    s_add_u32 s51, s51, s2
    v_mfma_f32_32x32x16_bf16 v[112:127], v[52:55], a[16:19], v[112:127]
    s_waitcnt vmcnt(15)
    s_barrier
    ds_read_b64_tr_b16 v[48:49], v5 offset:16384
    buffer_load_dwordx4 a[76:79], v1, s[4:7], s37 offen offset:1024 sc1
    s_mul_i32 s51, s51, 3072
    v_mfma_f32_32x32x16_bf16 v[144:159], v[52:55], a[20:23], v[144:159]
    ds_read_b64_tr_b16 v[50:51], v5 offset:16640
    s_add_u32 s51, s51, 6225920
    s_waitcnt lgkmcnt(6)
    v_mfma_f32_32x32x16_bf16 v[160:175], v[56:59], a[16:19], v[160:175]
    ds_read_b64_tr_b16 v[52:53], v6 offset:16384
    buffer_load_dwordx4 a[80:83], v1, s[4:7], s36 offen offset:2048 sc1
    v_mfma_f32_32x32x16_bf16 v[176:191], v[56:59], a[20:23], v[176:191]
    ds_read_b64_tr_b16 v[54:55], v6 offset:16640
    s_mov_b32 s43, 0
    s_cmp_ge_u32 s41, 36
    s_cselect_b32 s43, 1, s43
    s_cmp_ge_u32 s41, 72
    s_cselect_b32 s43, 2, s43
    s_cmp_ge_u32 s41, 108
    s_cselect_b32 s43, 3, s43
    v_mfma_f32_32x32x16_bf16 v[96:111], v[60:63], a[24:27], v[96:111]
    ds_read_b64_tr_b16 v[56:57], v6 offset:8192
    buffer_load_dwordx4 a[84:87], v1, s[4:7], s37 offen offset:2048 sc1
    v_mfma_f32_32x32x16_bf16 v[128:143], v[60:63], a[28:31], v[128:143]
    ds_read_b64_tr_b16 v[58:59], v6 offset:8448
    s_sub_u32 s42, 0, s43
    s_and_b32 s42, s42, 3
    s_cmp_eq_u32 s42, 1
    s_cselect_b32 s48, s45, s46
    s_cmp_eq_u32 s42, 2
    s_cselect_b32 s48, s44, s48
    s_cmp_eq_u32 s42, 3
    s_cselect_b32 s48, s47, s48
    s_add_u32 s42, s51, 0
    s_cmp_lt_u32 s2, 18
    s_cselect_b32 s48, s42, s48
    s_cmp_ge_u32 s2, 162
    s_cselect_b32 s48, 2147483632, s48
    v_add_u32 v249, s48, v1
    s_waitcnt lgkmcnt(6)
    v_mfma_f32_32x32x16_bf16 v[112:127], v[64:67], a[24:27], v[112:127]
    ds_read_b64_tr_b16 v[60:61], v5 offset:17408
    buffer_load_dwordx4 a[88:91], v1, s[4:7], s36 offen offset:3072 sc1
    v_mfma_f32_32x32x16_bf16 v[144:159], v[64:67], a[28:31], v[144:159]
    ds_read_b64_tr_b16 v[62:63], v5 offset:17664
    s_sub_u32 s42, 1, s43
    s_and_b32 s42, s42, 3
    s_cmp_eq_u32 s42, 1
    s_cselect_b32 s48, s45, s46
    s_cmp_eq_u32 s42, 2
    s_cselect_b32 s48, s44, s48
    s_cmp_eq_u32 s42, 3
    s_cselect_b32 s48, s47, s48
    s_add_u32 s42, s51, 55296
    s_cmp_lt_u32 s2, 18
    s_cselect_b32 s48, s42, s48
    s_cmp_ge_u32 s2, 162
    s_cselect_b32 s48, 2147483632, s48
    v_add_u32 v250, s48, v1
    v_mfma_f32_32x32x16_bf16 v[160:175], v[68:71], a[24:27], v[160:175]
    ds_read_b64_tr_b16 v[64:65], v6 offset:17408
    buffer_load_dwordx4 a[92:95], v1, s[4:7], s37 offen offset:3072 sc1
    v_mfma_f32_32x32x16_bf16 v[176:191], v[68:71], a[28:31], v[176:191]
    ds_read_b64_tr_b16 v[66:67], v6 offset:17664
    s_sub_u32 s42, 2, s43
    s_and_b32 s42, s42, 3
    s_cmp_eq_u32 s42, 1
    s_cselect_b32 s48, s45, s46
    s_cmp_eq_u32 s42, 2
    s_cselect_b32 s48, s44, s48
    s_cmp_eq_u32 s42, 3
    s_cselect_b32 s48, s47, s48
    s_add_u32 s42, s51, 110592
    s_cmp_lt_u32 s2, 18
    s_cselect_b32 s48, s42, s48
    s_cmp_ge_u32 s2, 162
    s_cselect_b32 s48, 2147483632, s48
    v_add_u32 v251, s48, v1
    s_waitcnt lgkmcnt(6)
    s_waitcnt vmcnt(19)
    v_mfma_f32_32x32x16_bf16 v[96:111], v[48:51], a[32:35], v[96:111]
    ds_read_b64_tr_b16 v[68:69], v6 offset:9216
    s_add_u32 m0, s26, 40960
    s_add_u32 s34, s30, 24576
    buffer_load_dwordx4 v1, s[4:7], s34 offen sc1 lds
    s_waitcnt vmcnt(19)
    v_mfma_f32_32x32x16_bf16 v[128:143], v[48:51], a[36:39], v[128:143]
    ds_read_b64_tr_b16 v[70:71], v6 offset:9472
    s_sub_u32 s42, 3, s43
    s_and_b32 s42, s42, 3
    s_cmp_eq_u32 s42, 1
    s_cselect_b32 s48, s45, s46
    s_cmp_eq_u32 s42, 2
    s_cselect_b32 s48, s44, s48
    s_cmp_eq_u32 s42, 3
    s_cselect_b32 s48, s47, s48
    s_add_u32 s42, s51, 165888
    s_cmp_lt_u32 s2, 18
    s_cselect_b32 s48, s42, s48
    s_cmp_ge_u32 s2, 162
    s_cselect_b32 s48, 2147483632, s48
    v_add_u32 v252, s48, v1
    v_mfma_f32_32x32x16_bf16 v[112:127], v[52:55], a[32:35], v[112:127]
    ds_read_b64_tr_b16 v[48:49], v5 offset:18432
    s_add_u32 m0, s26, 40960
    s_nop 0
    buffer_load_dwordx4 v1, s[4:7], s34 offen offset:1024 sc1 lds
    s_add_u32 s36, s28, 12288
    v_mfma_f32_32x32x16_bf16 v[144:159], v[52:55], a[36:39], v[144:159]
    ds_read_b64_tr_b16 v[50:51], v5 offset:18688
    s_add_u32 s37, s29, 12288
    s_waitcnt lgkmcnt(6)
    v_mfma_f32_32x32x16_bf16 v[160:175], v[56:59], a[32:35], v[160:175]
    ds_read_b64_tr_b16 v[52:53], v6 offset:18432
    buffer_load_dwordx4 a[96:99], v1, s[4:7], s36 offen offset:0 sc1
    v_mfma_f32_32x32x16_bf16 v[176:191], v[56:59], a[36:39], v[176:191]
    ds_read_b64_tr_b16 v[54:55], v6 offset:18688
    s_mov_b32 s48, s50
    s_add_u32 s42, s51, 2048
    s_cmp_lt_u32 s2, 18
    s_cselect_b32 s48, s42, s48
    s_cmp_ge_u32 s2, 162
    s_cselect_b32 s48, 2147483632, s48
    v_add_u32 v253, s48, v1
    s_waitcnt vmcnt(20)
    v_mfma_f32_32x32x16_bf16 v[96:111], v[60:63], a[40:43], v[96:111]
    ds_read_b64_tr_b16 v[56:57], v6 offset:10240
    buffer_load_dwordx4 a[100:103], v1, s[4:7], s37 offen offset:0 sc1
    s_waitcnt vmcnt(20)
    v_mfma_f32_32x32x16_bf16 v[128:143], v[60:63], a[44:47], v[128:143]
    ds_read_b64_tr_b16 v[58:59], v6 offset:10496
    s_add_u32 s42, s51, 57344
    s_cmp_lt_u32 s2, 18
    s_cselect_b32 s48, s42, 2147483632
    v_add_u32 v248, s48, v1
    s_waitcnt lgkmcnt(6)
    v_mfma_f32_32x32x16_bf16 v[112:127], v[64:67], a[40:43], v[112:127]
    ds_read_b64_tr_b16 v[60:61], v5 offset:19456
    buffer_load_dwordx4 a[104:107], v1, s[4:7], s36 offen offset:1024 sc1
    ds_read_b64_tr_b16 v[192:193], v254 offset:0
    ds_read_b64_tr_b16 v[194:195], v254 offset:4608
    ds_read_b64_tr_b16 v[196:197], v254 offset:32
    v_mfma_f32_32x32x16_bf16 v[144:159], v[64:67], a[44:47], v[144:159]
    ds_read_b64_tr_b16 v[62:63], v5 offset:19712
    ds_read_b64_tr_b16 v[198:199], v254 offset:4640
    ds_read_b64_tr_b16 v[200:201], v254 offset:64
    ds_read_b64_tr_b16 v[202:203], v254 offset:4672
    ds_read_b64_tr_b16 v[204:205], v254 offset:96
    v_mfma_f32_32x32x16_bf16 v[160:175], v[68:71], a[40:43], v[160:175]
    ds_read_b64_tr_b16 v[64:65], v6 offset:19456
    buffer_load_dwordx4 a[108:111], v1, s[4:7], s37 offen offset:1024 sc1
    ds_read_b64_tr_b16 v[206:207], v254 offset:4704
    ds_read_b64_tr_b16 v[208:209], v254 offset:128
    ds_read_b64_tr_b16 v[210:211], v254 offset:4736
    v_mfma_f32_32x32x16_bf16 v[176:191], v[68:71], a[44:47], v[176:191]
    ds_read_b64_tr_b16 v[66:67], v6 offset:19712
    ds_read_b64_tr_b16 v[212:213], v254 offset:160
    ds_read_b64_tr_b16 v[214:215], v254 offset:4768
    ds_read_b64_tr_b16 v[216:217], v254 offset:192
    s_waitcnt lgkmcnt(14)
    s_waitcnt vmcnt(21)
    v_mfma_f32_32x32x16_bf16 v[96:111], v[48:51], a[48:51], v[96:111]
    ds_read_b64_tr_b16 v[68:69], v6 offset:11264
    buffer_load_dwordx4 a[112:115], v1, s[4:7], s36 offen offset:2048 sc1
    ds_read_b64_tr_b16 v[218:219], v254 offset:4800
    ds_read_b64_tr_b16 v[220:221], v254 offset:224
    ds_read_b64_tr_b16 v[222:223], v254 offset:4832
    s_waitcnt vmcnt(21)
    v_mfma_f32_32x32x16_bf16 v[128:143], v[48:51], a[52:55], v[128:143]
    ds_read_b64_tr_b16 v[70:71], v6 offset:11520
    ds_read_b64_tr_b16 v[224:225], v254 offset:256
    ds_read_b64_tr_b16 v[226:227], v254 offset:4864
    v_mfma_f32_32x32x16_bf16 v[112:127], v[52:55], a[48:51], v[112:127]
    s_waitcnt vmcnt(15)
    s_barrier
    ds_read_b64_tr_b16 v[48:49], v5 offset:24576
    buffer_load_dwordx4 a[116:119], v1, s[4:7], s37 offen offset:2048 sc1
    v_mfma_f32_32x32x16_bf16 v[144:159], v[52:55], a[52:55], v[144:159]
    ds_read_b64_tr_b16 v[50:51], v5 offset:24832
    buffer_store_dwordx4 v[192:195], v249, s[4:7], 0 offen offset:0 sc1
    s_waitcnt lgkmcnt(14)
    v_mfma_f32_32x32x16_bf16 v[160:175], v[56:59], a[48:51], v[160:175]
    ds_read_b64_tr_b16 v[52:53], v6 offset:24576
    v_mfma_f32_32x32x16_bf16 v[176:191], v[56:59], a[52:55], v[176:191]
    ds_read_b64_tr_b16 v[54:55], v6 offset:24832
    buffer_load_dwordx4 a[120:123], v1, s[4:7], s36 offen offset:3072 sc1
    v_mfma_f32_32x32x16_bf16 v[96:111], v[60:63], a[56:59], v[96:111]
    ds_read_b64_tr_b16 v[56:57], v5 offset:32768
    v_mfma_f32_32x32x16_bf16 v[128:143], v[60:63], a[60:63], v[128:143]
    ds_read_b64_tr_b16 v[58:59], v5 offset:33024
    buffer_load_dwordx4 a[124:127], v1, s[4:7], s37 offen offset:3072 sc1
    s_waitcnt lgkmcnt(8)
    v_mfma_f32_32x32x16_bf16 v[112:127], v[64:67], a[56:59], v[112:127]
    ds_read_b64_tr_b16 v[60:61], v5 offset:25600
    v_mfma_f32_32x32x16_bf16 v[144:159], v[64:67], a[60:63], v[144:159]
    ds_read_b64_tr_b16 v[62:63], v5 offset:25856
    s_add_u32 m0, s26, 49152
    s_add_u32 s34, s30, 32768
    buffer_load_dwordx4 v1, s[4:7], s34 offen sc1 lds
    v_mfma_f32_32x32x16_bf16 v[160:175], v[68:71], a[56:59], v[160:175]
    ds_read_b64_tr_b16 v[64:65], v6 offset:25600
    buffer_store_dwordx4 v[196:199], v249, s[4:7], 0 offen offset:1024 sc1
    v_mfma_f32_32x32x16_bf16 v[176:191], v[68:71], a[60:63], v[176:191]
    ds_read_b64_tr_b16 v[66:67], v6 offset:25856
    s_waitcnt lgkmcnt(6)
    s_waitcnt vmcnt(20)
    v_mfma_f32_32x32x16_bf16 v[96:111], v[48:51], a[64:67], v[96:111]
    ds_read_b64_tr_b16 v[68:69], v5 offset:33792
    s_add_u32 m0, s26, 49152
    s_nop 0
    buffer_load_dwordx4 v1, s[4:7], s34 offen offset:1024 sc1 lds
    s_waitcnt vmcnt(20)
    v_mfma_f32_32x32x16_bf16 v[128:143], v[48:51], a[68:71], v[128:143]
    ds_read_b64_tr_b16 v[70:71], v5 offset:34048
    v_mfma_f32_32x32x16_bf16 v[112:127], v[52:55], a[64:67], v[112:127]
    ds_read_b64_tr_b16 v[48:49], v5 offset:26624
    s_add_u32 m0, s26, 57344
    s_add_u32 s34, s31, 16384
    buffer_load_dwordx4 v1, s[4:7], s34 offen sc1 lds
    v_mfma_f32_32x32x16_bf16 v[144:159], v[52:55], a[68:71], v[144:159]
    ds_read_b64_tr_b16 v[50:51], v5 offset:26880
    s_waitcnt lgkmcnt(6)
    v_mfma_f32_32x32x16_bf16 v[160:175], v[56:59], a[64:67], v[160:175]
    ds_read_b64_tr_b16 v[52:53], v6 offset:26624
    s_add_u32 m0, s26, 57344
    s_nop 0
    buffer_load_dwordx4 v1, s[4:7], s34 offen offset:1024 sc1 lds
    s_add_u32 s36, s28, 16384
    v_mfma_f32_32x32x16_bf16 v[176:191], v[56:59], a[68:71], v[176:191]
    ds_read_b64_tr_b16 v[54:55], v6 offset:26880
    s_add_u32 s37, s29, 16384
    s_waitcnt vmcnt(21)
    v_mfma_f32_32x32x16_bf16 v[96:111], v[60:63], a[72:75], v[96:111]
    ds_read_b64_tr_b16 v[56:57], v5 offset:34816
    buffer_load_dwordx4 a[128:131], v1, s[4:7], s36 offen offset:0 sc1
    s_waitcnt vmcnt(21)
    v_mfma_f32_32x32x16_bf16 v[128:143], v[60:63], a[76:79], v[128:143]
    ds_read_b64_tr_b16 v[58:59], v5 offset:35072
    buffer_store_dwordx4 v[200:203], v250, s[4:7], 0 offen offset:0 sc1
    s_waitcnt lgkmcnt(6)
    v_mfma_f32_32x32x16_bf16 v[112:127], v[64:67], a[72:75], v[112:127]
    ds_read_b64_tr_b16 v[60:61], v5 offset:27648
    v_mfma_f32_32x32x16_bf16 v[144:159], v[64:67], a[76:79], v[144:159]
    ds_read_b64_tr_b16 v[62:63], v5 offset:27904
    buffer_load_dwordx4 a[132:135], v1, s[4:7], s37 offen offset:0 sc1
    v_mfma_f32_32x32x16_bf16 v[160:175], v[68:71], a[72:75], v[160:175]
    ds_read_b64_tr_b16 v[64:65], v6 offset:27648
    v_mfma_f32_32x32x16_bf16 v[176:191], v[68:71], a[76:79], v[176:191]
    ds_read_b64_tr_b16 v[66:67], v6 offset:27904
    buffer_load_dwordx4 a[136:139], v1, s[4:7], s36 offen offset:1024 sc1
    s_waitcnt lgkmcnt(6)
    s_waitcnt vmcnt(23)
    v_mfma_f32_32x32x16_bf16 v[96:111], v[48:51], a[80:83], v[96:111]
    ds_read_b64_tr_b16 v[68:69], v5 offset:35840
    s_waitcnt vmcnt(22)
    v_mfma_f32_32x32x16_bf16 v[128:143], v[48:51], a[84:87], v[128:143]
    ds_read_b64_tr_b16 v[70:71], v5 offset:36096
    buffer_load_dwordx4 a[140:143], v1, s[4:7], s37 offen offset:1024 sc1
    v_mfma_f32_32x32x16_bf16 v[112:127], v[52:55], a[80:83], v[112:127]
    s_waitcnt vmcnt(19)
    s_barrier
    ds_read_b64_tr_b16 v[48:49], v5 offset:40960
    buffer_store_dwordx4 v[204:207], v250, s[4:7], 0 offen offset:1024 sc1
    v_mfma_f32_32x32x16_bf16 v[144:159], v[52:55], a[84:87], v[144:159]
    ds_read_b64_tr_b16 v[50:51], v5 offset:41216
    s_waitcnt lgkmcnt(6)
    v_mfma_f32_32x32x16_bf16 v[160:175], v[56:59], a[80:83], v[160:175]
    ds_read_b64_tr_b16 v[52:53], v6 offset:40960
    buffer_load_dwordx4 a[144:147], v1, s[4:7], s36 offen offset:2048 sc1
    v_mfma_f32_32x32x16_bf16 v[176:191], v[56:59], a[84:87], v[176:191]
    ds_read_b64_tr_b16 v[54:55], v6 offset:41216
    v_mfma_f32_32x32x16_bf16 v[96:111], v[60:63], a[88:91], v[96:111]
    ds_read_b64_tr_b16 v[56:57], v6 offset:32768
    buffer_load_dwordx4 a[148:151], v1, s[4:7], s37 offen offset:2048 sc1
    v_mfma_f32_32x32x16_bf16 v[128:143], v[60:63], a[92:95], v[128:143]
    ds_read_b64_tr_b16 v[58:59], v6 offset:33024
    s_waitcnt lgkmcnt(6)
    v_mfma_f32_32x32x16_bf16 v[112:127], v[64:67], a[88:91], v[112:127]
    ds_read_b64_tr_b16 v[60:61], v5 offset:41984
    buffer_load_dwordx4 a[152:155], v1, s[4:7], s36 offen offset:3072 sc1
    v_mfma_f32_32x32x16_bf16 v[144:159], v[64:67], a[92:95], v[144:159]
    ds_read_b64_tr_b16 v[62:63], v5 offset:42240
    buffer_store_dwordx4 v[208:211], v251, s[4:7], 0 offen offset:0 sc1
    v_mfma_f32_32x32x16_bf16 v[160:175], v[68:71], a[88:91], v[160:175]
    ds_read_b64_tr_b16 v[64:65], v6 offset:41984
    v_mfma_f32_32x32x16_bf16 v[176:191], v[68:71], a[92:95], v[176:191]
    ds_read_b64_tr_b16 v[66:67], v6 offset:42240
    buffer_load_dwordx4 a[156:159], v1, s[4:7], s37 offen offset:3072 sc1
    s_waitcnt lgkmcnt(6)
    s_waitcnt vmcnt(24)
    v_mfma_f32_32x32x16_bf16 v[96:111], v[48:51], a[96:99], v[96:111]
    ds_read_b64_tr_b16 v[68:69], v6 offset:33792
    s_waitcnt vmcnt(23)
    v_mfma_f32_32x32x16_bf16 v[128:143], v[48:51], a[100:103], v[128:143]
    ds_read_b64_tr_b16 v[70:71], v6 offset:34048
    s_add_u32 m0, s26, 65536
    s_add_u32 s34, s30, 40960
    buffer_load_dwordx4 v1, s[4:7], s34 offen sc1 lds
    v_mfma_f32_32x32x16_bf16 v[112:127], v[52:55], a[96:99], v[112:127]
    ds_read_b64_tr_b16 v[48:49], v5 offset:43008
    v_mfma_f32_32x32x16_bf16 v[144:159], v[52:55], a[100:103], v[144:159]
    ds_read_b64_tr_b16 v[50:51], v5 offset:43264
    s_add_u32 m0, s26, 65536
    s_nop 0
    buffer_load_dwordx4 v1, s[4:7], s34 offen offset:1024 sc1 lds
    s_waitcnt lgkmcnt(6)
    v_mfma_f32_32x32x16_bf16 v[160:175], v[56:59], a[96:99], v[160:175]
    ds_read_b64_tr_b16 v[52:53], v6 offset:43008
    s_add_u32 s36, s28, 20480
    s_add_u32 s37, s29, 20480
    v_mfma_f32_32x32x16_bf16 v[176:191], v[56:59], a[100:103], v[176:191]
    ds_read_b64_tr_b16 v[54:55], v6 offset:43264
    buffer_load_dwordx4 a[160:163], v1, s[4:7], s36 offen offset:0 sc1
    s_waitcnt vmcnt(25)
    v_mfma_f32_32x32x16_bf16 v[96:111], v[60:63], a[104:107], v[96:111]
    ds_read_b64_tr_b16 v[56:57], v6 offset:34816
    buffer_store_dwordx4 v[212:215], v251, s[4:7], 0 offen offset:1024 sc1
    s_waitcnt vmcnt(25)
    v_mfma_f32_32x32x16_bf16 v[128:143], v[60:63], a[108:111], v[128:143]
    ds_read_b64_tr_b16 v[58:59], v6 offset:35072
    s_waitcnt lgkmcnt(6)
    v_mfma_f32_32x32x16_bf16 v[112:127], v[64:67], a[104:107], v[112:127]
    ds_read_b64_tr_b16 v[60:61], v5 offset:44032
    buffer_load_dwordx4 a[164:167], v1, s[4:7], s37 offen offset:0 sc1
    v_mfma_f32_32x32x16_bf16 v[144:159], v[64:67], a[108:111], v[144:159]
    ds_read_b64_tr_b16 v[62:63], v5 offset:44288
    v_mfma_f32_32x32x16_bf16 v[160:175], v[68:71], a[104:107], v[160:175]
    ds_read_b64_tr_b16 v[64:65], v6 offset:44032
    buffer_load_dwordx4 a[168:171], v1, s[4:7], s36 offen offset:1024 sc1
    v_mfma_f32_32x32x16_bf16 v[176:191], v[68:71], a[108:111], v[176:191]
    ds_read_b64_tr_b16 v[66:67], v6 offset:44288
    s_waitcnt lgkmcnt(6)
    s_waitcnt vmcnt(26)
    v_mfma_f32_32x32x16_bf16 v[96:111], v[48:51], a[112:115], v[96:111]
    ds_read_b64_tr_b16 v[68:69], v6 offset:35840
    buffer_load_dwordx4 a[172:175], v1, s[4:7], s37 offen offset:1024 sc1
    s_waitcnt vmcnt(26)
    v_mfma_f32_32x32x16_bf16 v[128:143], v[48:51], a[116:119], v[128:143]
    ds_read_b64_tr_b16 v[70:71], v6 offset:36096
    buffer_store_dwordx4 v[216:219], v252, s[4:7], 0 offen offset:0 sc1
    v_mfma_f32_32x32x16_bf16 v[112:127], v[52:55], a[112:115], v[112:127]
    s_waitcnt vmcnt(19)
    s_barrier
    ds_read_b64_tr_b16 v[48:49], v5 offset:49152
    v_mfma_f32_32x32x16_bf16 v[144:159], v[52:55], a[116:119], v[144:159]
    ds_read_b64_tr_b16 v[50:51], v5 offset:49408
    buffer_load_dwordx4 a[176:179], v1, s[4:7], s36 offen offset:2048 sc1
    s_waitcnt lgkmcnt(6)
    v_mfma_f32_32x32x16_bf16 v[160:175], v[56:59], a[112:115], v[160:175]
    ds_read_b64_tr_b16 v[52:53], v6 offset:49152
    v_mfma_f32_32x32x16_bf16 v[176:191], v[56:59], a[116:119], v[176:191]
    ds_read_b64_tr_b16 v[54:55], v6 offset:49408
    buffer_load_dwordx4 a[180:183], v1, s[4:7], s37 offen offset:2048 sc1
    v_mfma_f32_32x32x16_bf16 v[96:111], v[60:63], a[120:123], v[96:111]
    ds_read_b64_tr_b16 v[56:57], v5 offset:57344
    v_mfma_f32_32x32x16_bf16 v[128:143], v[60:63], a[124:127], v[128:143]
    ds_read_b64_tr_b16 v[58:59], v5 offset:57600
    buffer_load_dwordx4 a[184:187], v1, s[4:7], s36 offen offset:3072 sc1
    s_waitcnt lgkmcnt(6)
    v_mfma_f32_32x32x16_bf16 v[112:127], v[64:67], a[120:123], v[112:127]
    ds_read_b64_tr_b16 v[60:61], v5 offset:50176
    buffer_store_dwordx4 v[220:223], v252, s[4:7], 0 offen offset:1024 sc1
    v_mfma_f32_32x32x16_bf16 v[144:159], v[64:67], a[124:127], v[144:159]
    ds_read_b64_tr_b16 v[62:63], v5 offset:50432
    v_mfma_f32_32x32x16_bf16 v[160:175], v[68:71], a[120:123], v[160:175]
    ds_read_b64_tr_b16 v[64:65], v6 offset:50176
    buffer_load_dwordx4 a[188:191], v1, s[4:7], s37 offen offset:3072 sc1
    v_mfma_f32_32x32x16_bf16 v[176:191], v[68:71], a[124:127], v[176:191]
    ds_read_b64_tr_b16 v[66:67], v6 offset:50432
    s_waitcnt lgkmcnt(6)
    s_waitcnt vmcnt(23)
    v_mfma_f32_32x32x16_bf16 v[96:111], v[48:51], a[128:131], v[96:111]
    ds_read_b64_tr_b16 v[68:69], v5 offset:58368
    s_add_u32 m0, s26, 114688
    s_nop 0
    buffer_load_dwordx4 v1, s[4:7], s33 offen sc1 lds
    buffer_load_dwordx4 v1, s[4:7], s33 offen offset:1024 sc1 lds
    s_waitcnt vmcnt(23)
    v_mfma_f32_32x32x16_bf16 v[128:143], v[48:51], a[132:135], v[128:143]
    ds_read_b64_tr_b16 v[70:71], v5 offset:58624
    v_mfma_f32_32x32x16_bf16 v[112:127], v[52:55], a[128:131], v[112:127]
    ds_read_b64_tr_b16 v[48:49], v5 offset:51200
    s_add_u32 m0, s26, 73728
    s_add_u32 s34, s30, 49152
    buffer_load_dwordx4 v1, s[4:7], s34 offen sc1 lds
    v_mfma_f32_32x32x16_bf16 v[144:159], v[52:55], a[132:135], v[144:159]
    ds_read_b64_tr_b16 v[50:51], v5 offset:51456
    buffer_store_dwordx4 v[224:227], v253, s[4:7], 0 offen offset:0 sc1
    s_waitcnt lgkmcnt(6)
    v_mfma_f32_32x32x16_bf16 v[160:175], v[56:59], a[128:131], v[160:175]
    ds_read_b64_tr_b16 v[52:53], v6 offset:51200
    s_mov_b32 s79, 0
    v_mfma_f32_32x32x16_bf16 v[176:191], v[56:59], a[132:135], v[176:191]
    ds_read_b64_tr_b16 v[54:55], v6 offset:51456
    s_add_u32 m0, s26, 73728
    s_nop 0
    buffer_load_dwordx4 v1, s[4:7], s34 offen offset:1024 sc1 lds
    s_waitcnt vmcnt(25)
    v_mfma_f32_32x32x16_bf16 v[96:111], v[60:63], a[136:139], v[96:111]
    ds_read_b64_tr_b16 v[56:57], v5 offset:59392
    s_waitcnt vmcnt(24)
    v_mfma_f32_32x32x16_bf16 v[128:143], v[60:63], a[140:143], v[128:143]
    ds_read_b64_tr_b16 v[58:59], v5 offset:59648
    s_add_u32 m0, s26, 81920
    s_add_u32 s34, s31, 24576
    buffer_load_dwordx4 v1, s[4:7], s34 offen sc1 lds
    s_waitcnt lgkmcnt(6)
    v_mfma_f32_32x32x16_bf16 v[112:127], v[64:67], a[136:139], v[112:127]
    ds_read_b64_tr_b16 v[60:61], v5 offset:52224
    v_mfma_f32_32x32x16_bf16 v[144:159], v[64:67], a[140:143], v[144:159]
    ds_read_b64_tr_b16 v[62:63], v5 offset:52480
    s_add_u32 m0, s26, 81920
    s_nop 0
    buffer_load_dwordx4 v1, s[4:7], s34 offen offset:1024 sc1 lds
    s_add_u32 s36, s28, 24576
    v_mfma_f32_32x32x16_bf16 v[160:175], v[68:71], a[136:139], v[160:175]
    ds_read_b64_tr_b16 v[64:65], v6 offset:52224
    s_add_u32 s37, s29, 24576
    buffer_store_dwordx4 v[224:227], v248, s[4:7], s79 offen sc1
    s_mov_b32 s79, 55296
    v_mfma_f32_32x32x16_bf16 v[176:191], v[68:71], a[140:143], v[176:191]
    ds_read_b64_tr_b16 v[66:67], v6 offset:52480
    s_waitcnt lgkmcnt(6)
    s_waitcnt vmcnt(25)
    v_mfma_f32_32x32x16_bf16 v[96:111], v[48:51], a[144:147], v[96:111]
    ds_read_b64_tr_b16 v[68:69], v5 offset:60416
    buffer_load_dwordx4 a[192:195], v1, s[4:7], s36 offen offset:0 sc1
    s_waitcnt vmcnt(25)
    v_mfma_f32_32x32x16_bf16 v[128:143], v[48:51], a[148:151], v[128:143]
    ds_read_b64_tr_b16 v[70:71], v5 offset:60672
    buffer_store_dwordx4 v[224:227], v248, s[4:7], s79 offen sc1
    s_mov_b32 s79, 110592
    buffer_store_dwordx4 v[224:227], v248, s[4:7], s79 offen sc1
    v_mfma_f32_32x32x16_bf16 v[112:127], v[52:55], a[144:147], v[112:127]
    s_waitcnt vmcnt(9)
    s_barrier
    ds_read_b64_tr_b16 v[48:49], v7 offset:0
    buffer_load_dwordx4 a[196:199], v1, s[4:7], s37 offen offset:0 sc1
    v_bfe_u32 v4, v0, 4, 1
    v_mfma_f32_32x32x16_bf16 v[144:159], v[52:55], a[148:151], v[144:159]
    ds_read_b64_tr_b16 v[50:51], v7 offset:256
    s_mov_b32 s38, 165888
    v_mul_lo_u32 v4, v4, s38
    v_and_b32 v13, 15, v0
    v_lshl_add_u32 v4, v13, 4, v4
    s_waitcnt lgkmcnt(6)
    v_mfma_f32_32x32x16_bf16 v[160:175], v[56:59], a[144:147], v[160:175]
    ds_read_b64_tr_b16 v[52:53], v8 offset:0
    buffer_load_dwordx4 a[200:203], v1, s[4:7], s36 offen offset:1024 sc1
    v_lshl_add_u32 v3, v14, 8, v4
    v_cmp_eq_u32 vcc, 0, v14
    v_mov_b32 v15, 2147483632
    v_mfma_f32_32x32x16_bf16 v[176:191], v[56:59], a[148:151], v[176:191]
    ds_read_b64_tr_b16 v[54:55], v8 offset:256
    s_mul_i32 s63, s3, 10240
    v_cndmask_b32 v4, v15, v4, vcc
    s_add_u32 s63, s63, 122880
    v_and_b32 v11, 31, v0
    v_mul_u32_u24 v11, 160, v11
    v_mfma_f32_32x32x16_bf16 v[96:111], v[60:63], a[152:155], v[96:111]
    ds_read_b64_tr_b16 v[56:57], v6 offset:57344
    buffer_load_dwordx4 a[204:207], v1, s[4:7], s37 offen offset:1024 sc1
    v_add_u32 v11, s63, v11
    v_lshrrev_b32 v12, 2, v0
    v_mul_u32_u24 v12, 160, v12
    v_mfma_f32_32x32x16_bf16 v[128:143], v[60:63], a[156:159], v[128:143]
    ds_read_b64_tr_b16 v[58:59], v6 offset:57600
    v_and_b32 v15, 3, v0
    v_lshl_add_u32 v12, v15, 3, v12
    v_add_u32 v12, s63, v12
    v_and_b32 v15, 31, v0
    s_waitcnt lgkmcnt(6)
    v_mfma_f32_32x32x16_bf16 v[112:127], v[64:67], a[152:155], v[112:127]
    ds_read_b64_tr_b16 v[60:61], v7 offset:1024
    buffer_load_dwordx4 a[208:211], v1, s[4:7], s36 offen offset:2048 sc1
    v_min_u32 v15, 18, v15
    v_lshrrev_b32 v13, 4, v15
    v_mul_u32_u24 v13, 3072, v13
    v_mfma_f32_32x32x16_bf16 v[144:159], v[64:67], a[156:159], v[144:159]
    ds_read_b64_tr_b16 v[62:63], v7 offset:1280
    v_and_b32 v15, 15, v15
    v_lshl_add_u32 v13, v15, 4, v13
    v_lshl_add_u32 v13, v14, 8, v13
    v_lshlrev_b32 v0, 2, v0
    s_lshl_b32 s40, s24, 4
    v_mfma_f32_32x32x16_bf16 v[160:175], v[68:71], a[152:155], v[160:175]
    ds_read_b64_tr_b16 v[64:65], v8 offset:1024
    buffer_load_dwordx4 a[212:215], v1, s[4:7], s37 offen offset:2048 sc1
    s_lshl_b32 s38, s3, 2
    s_add_u32 s40, s40, s38
    s_mul_i32 s40, s40, 165888
    v_mfma_f32_32x32x16_bf16 v[176:191], v[68:71], a[156:159], v[176:191]
    ds_read_b64_tr_b16 v[66:67], v8 offset:1280
    s_add_u32 s40, s40, 12484608
    s_add_u32 s41, s40, s16
    s_add_u32 s43, s40, s17
    s_add_u32 s45, s40, s18
    s_waitcnt lgkmcnt(6)
    v_mfma_f32_32x32x16_bf16 v[96:111], v[48:51], a[160:163], v[96:111]
    ds_read_b64_tr_b16 v[68:69], v6 offset:58368
    buffer_load_dwordx4 a[216:219], v1, s[4:7], s36 offen offset:3072 sc1
    s_add_u32 s47, s40, s19
    s_add_u32 s49, s40, s20
    s_add_u32 s51, s40, s21
    v_mfma_f32_32x32x16_bf16 v[128:143], v[48:51], a[164:167], v[128:143]
    ds_read_b64_tr_b16 v[70:71], v6 offset:58624
    s_add_u32 s53, s40, s22
    s_add_u32 s42, s41, 331776
    s_add_u32 s44, s43, 331776
    s_add_u32 s46, s45, 331776
    v_mfma_f32_32x32x16_bf16 v[112:127], v[52:55], a[160:163], v[112:127]
    ds_read_b64_tr_b16 v[48:49], v7 offset:2048
    buffer_load_dwordx4 a[220:223], v1, s[4:7], s37 offen offset:3072 sc1
    s_add_u32 s48, s47, 331776
    s_add_u32 s50, s49, 331776
    s_add_u32 s52, s51, 331776
    v_mfma_f32_32x32x16_bf16 v[144:159], v[52:55], a[164:167], v[144:159]
    ds_read_b64_tr_b16 v[50:51], v7 offset:2304
    s_add_u32 s54, s53, 331776
    s_lshl_b32 s55, s2, 2
    s_add_u32 s55, s55, s3
    s_mul_i32 s55, s55, 10240
    s_waitcnt lgkmcnt(6)
    v_mfma_f32_32x32x16_bf16 v[160:175], v[56:59], a[160:163], v[160:175]
    ds_read_b64_tr_b16 v[52:53], v8 offset:2048
    s_add_u32 m0, s26, 0
    s_add_u32 s34, s30, 57344
    buffer_load_dwordx4 v1, s[4:7], s34 offen sc1 lds
    s_add_u32 s55, s55, 35356672
    v_mfma_f32_32x32x16_bf16 v[176:191], v[56:59], a[164:167], v[176:191]
    ds_read_b64_tr_b16 v[54:55], v8 offset:2304
    s_mul_i32 s57, s25, 49152
    s_add_u32 s57, s57, 33783808
    s_mul_i32 s56, s24, 6144
    s_add_u32 s56, s56, s57
    v_mfma_f32_32x32x16_bf16 v[96:111], v[60:63], a[168:171], v[96:111]
    ds_read_b64_tr_b16 v[56:57], v6 offset:59392
    s_add_u32 m0, s26, 0
    s_nop 0
    buffer_load_dwordx4 v1, s[4:7], s34 offen offset:1024 sc1 lds
    s_add_u32 s36, s28, 28672
    v_mfma_f32_32x32x16_bf16 v[128:143], v[60:63], a[172:175], v[128:143]
    ds_read_b64_tr_b16 v[58:59], v6 offset:59648
    s_add_u32 s37, s29, 28672
    s_mul_i32 s38, s3, 12288
    s_add_u32 s57, s57, s38
    s_min_u32 s38, s3, 2
    s_waitcnt lgkmcnt(6)
    v_mfma_f32_32x32x16_bf16 v[112:127], v[64:67], a[168:171], v[112:127]
    ds_read_b64_tr_b16 v[60:61], v7 offset:3072
    buffer_load_dwordx4 a[224:227], v1, s[4:7], s36 offen offset:0 sc1
    s_lshl_b32 s38, s38, 10
    s_add_u32 s56, s56, s38
    s_add_u32 s64, s38, 122880
    v_mfma_f32_32x32x16_bf16 v[144:159], v[64:67], a[172:175], v[144:159]
    ds_read_b64_tr_b16 v[62:63], v7 offset:3328
    s_lshl_b32 s58, s25, 12
    s_add_u32 s58, s58, 45973504
    s_lshl_b32 s38, s24, 2
    s_add_u32 s38, s38, s3
    s_lshl_b32 s39, s38, 7
    v_mfma_f32_32x32x16_bf16 v[160:175], v[68:71], a[168:171], v[160:175]
    ds_read_b64_tr_b16 v[64:65], v8 offset:3072
    buffer_load_dwordx4 a[228:231], v1, s[4:7], s37 offen offset:0 sc1
    s_add_u32 s59, s58, s39
    s_mov_b32 s61, 1069066811
    s_mov_b32 s62, 3216550459
    v_mfma_f32_32x32x16_bf16 v[176:191], v[68:71], a[172:175], v[176:191]
    ds_read_b64_tr_b16 v[66:67], v8 offset:3328
    s_mov_b32 s68, 0
    s_mov_b32 s69, -1
    s_mov_b32 s70, -1
    s_mov_b32 s71, 0
    s_waitcnt lgkmcnt(6)
    v_mfma_f32_32x32x16_bf16 v[96:111], v[48:51], a[176:179], v[96:111]
    ds_read_b64_tr_b16 v[68:69], v6 offset:60416
    buffer_load_dwordx4 a[232:235], v1, s[4:7], s36 offen offset:1024 sc1
    v_mfma_f32_32x32x16_bf16 v[128:143], v[48:51], a[180:183], v[128:143]
    ds_read_b64_tr_b16 v[70:71], v6 offset:60672
    v_mfma_f32_32x32x16_bf16 v[112:127], v[52:55], a[176:179], v[112:127]
    s_waitcnt vmcnt(16)
    s_barrier
    ds_read_b64_tr_b16 v[48:49], v7 offset:8192
    buffer_load_dwordx4 a[236:239], v1, s[4:7], s37 offen offset:1024 sc1
    v_mfma_f32_32x32x16_bf16 v[144:159], v[52:55], a[180:183], v[144:159]
    ds_read_b64_tr_b16 v[50:51], v7 offset:8448
    s_waitcnt lgkmcnt(6)
    v_mfma_f32_32x32x16_bf16 v[160:175], v[56:59], a[176:179], v[160:175]
    ds_read_b64_tr_b16 v[52:53], v8 offset:8192
    buffer_load_dwordx4 a[240:243], v1, s[4:7], s36 offen offset:2048 sc1
    v_mfma_f32_32x32x16_bf16 v[176:191], v[56:59], a[180:183], v[176:191]
    ds_read_b64_tr_b16 v[54:55], v8 offset:8448
    v_mfma_f32_32x32x16_bf16 v[96:111], v[60:63], a[184:187], v[96:111]
    ds_read_b64_tr_b16 v[56:57], v7 offset:16384
    buffer_load_dwordx4 a[244:247], v1, s[4:7], s37 offen offset:2048 sc1
    v_mfma_f32_32x32x16_bf16 v[128:143], v[60:63], a[188:191], v[128:143]
    ds_read_b64_tr_b16 v[58:59], v7 offset:16640
    s_waitcnt lgkmcnt(6)
    v_mfma_f32_32x32x16_bf16 v[112:127], v[64:67], a[184:187], v[112:127]
    ds_read_b64_tr_b16 v[60:61], v7 offset:9216
    buffer_load_dwordx4 a[248:251], v1, s[4:7], s36 offen offset:3072 sc1
    v_mfma_f32_32x32x16_bf16 v[144:159], v[64:67], a[188:191], v[144:159]
    ds_read_b64_tr_b16 v[62:63], v7 offset:9472
    v_mfma_f32_32x32x16_bf16 v[160:175], v[68:71], a[184:187], v[160:175]
    ds_read_b64_tr_b16 v[64:65], v8 offset:9216
    buffer_load_dwordx4 a[252:255], v1, s[4:7], s37 offen offset:3072 sc1
    v_mfma_f32_32x32x16_bf16 v[176:191], v[68:71], a[188:191], v[176:191]
    ds_read_b64_tr_b16 v[66:67], v8 offset:9472
    s_waitcnt lgkmcnt(6)
    s_waitcnt vmcnt(19)
    v_mfma_f32_32x32x16_bf16 v[96:111], v[48:51], a[192:195], v[96:111]
    ds_read_b64_tr_b16 v[68:69], v7 offset:17408
    s_add_u32 m0, s26, 8192
    s_add_u32 s34, s30, 65536
    buffer_load_dwordx4 v1, s[4:7], s34 offen sc1 lds
    s_waitcnt vmcnt(17)
    v_mfma_f32_32x32x16_bf16 v[128:143], v[48:51], a[196:199], v[128:143]
    ds_read_b64_tr_b16 v[70:71], v7 offset:17664
    v_mfma_f32_32x32x16_bf16 v[112:127], v[52:55], a[192:195], v[112:127]
    ds_read_b64_tr_b16 v[48:49], v7 offset:10240
    s_add_u32 m0, s26, 8192
    s_nop 0
    buffer_load_dwordx4 v1, s[4:7], s34 offen offset:1024 sc1 lds
    v_mfma_f32_32x32x16_bf16 v[144:159], v[52:55], a[196:199], v[144:159]
    ds_read_b64_tr_b16 v[50:51], v7 offset:10496
    s_waitcnt lgkmcnt(6)
    v_mfma_f32_32x32x16_bf16 v[160:175], v[56:59], a[192:195], v[160:175]
    ds_read_b64_tr_b16 v[52:53], v8 offset:10240
    s_add_u32 m0, s26, 16384
    s_add_u32 s34, s31, 32768
    buffer_load_dwordx4 v1, s[4:7], s34 offen sc1 lds
    v_mfma_f32_32x32x16_bf16 v[176:191], v[56:59], a[196:199], v[176:191]
    ds_read_b64_tr_b16 v[54:55], v8 offset:10496
    s_waitcnt vmcnt(18)
    v_mfma_f32_32x32x16_bf16 v[96:111], v[60:63], a[200:203], v[96:111]
    ds_read_b64_tr_b16 v[56:57], v7 offset:18432
    s_add_u32 m0, s26, 16384
    s_nop 0
    buffer_load_dwordx4 v1, s[4:7], s34 offen offset:1024 sc1 lds
    s_add_u32 s36, s28, 32768
    s_waitcnt vmcnt(18)
    v_mfma_f32_32x32x16_bf16 v[128:143], v[60:63], a[204:207], v[128:143]
    ds_read_b64_tr_b16 v[58:59], v7 offset:18688
    s_add_u32 s37, s29, 32768
    s_waitcnt lgkmcnt(6)
    v_mfma_f32_32x32x16_bf16 v[112:127], v[64:67], a[200:203], v[112:127]
    ds_read_b64_tr_b16 v[60:61], v7 offset:11264
    buffer_load_dwordx4 v[16:19], v1, s[4:7], s36 offen offset:0 sc1
    v_mfma_f32_32x32x16_bf16 v[144:159], v[64:67], a[204:207], v[144:159]
    ds_read_b64_tr_b16 v[62:63], v7 offset:11520
    v_mfma_f32_32x32x16_bf16 v[160:175], v[68:71], a[200:203], v[160:175]
    ds_read_b64_tr_b16 v[64:65], v8 offset:11264
    buffer_load_dwordx4 v[20:23], v1, s[4:7], s37 offen offset:0 sc1
    v_mfma_f32_32x32x16_bf16 v[176:191], v[68:71], a[204:207], v[176:191]
    ds_read_b64_tr_b16 v[66:67], v8 offset:11520
    s_waitcnt lgkmcnt(6)
    s_waitcnt vmcnt(19)
    v_mfma_f32_32x32x16_bf16 v[96:111], v[48:51], a[208:211], v[96:111]
    ds_read_b64_tr_b16 v[68:69], v7 offset:19456
    buffer_load_dwordx4 v[24:27], v1, s[4:7], s36 offen offset:1024 sc1
    s_waitcnt vmcnt(19)
    v_mfma_f32_32x32x16_bf16 v[128:143], v[48:51], a[212:215], v[128:143]
    ds_read_b64_tr_b16 v[70:71], v7 offset:19712
    v_mfma_f32_32x32x16_bf16 v[112:127], v[52:55], a[208:211], v[112:127]
    s_waitcnt vmcnt(15)
    s_barrier
    ds_read_b64_tr_b16 v[48:49], v5 offset:0
    buffer_load_dwordx4 v[28:31], v1, s[4:7], s37 offen offset:1024 sc1
    v_mov_b32 v15, s67
    v_mfma_f32_32x32x16_bf16 v[144:159], v[52:55], a[212:215], v[144:159]
    ds_read_b64_tr_b16 v[50:51], v5 offset:256
    v_add_u32 v15, 2, v15
    s_waitcnt lgkmcnt(6)
    v_mfma_f32_32x32x16_bf16 v[160:175], v[56:59], a[208:211], v[160:175]
    ds_read_b64_tr_b16 v[52:53], v6 offset:0
    buffer_load_dwordx4 v[32:35], v1, s[4:7], s36 offen offset:2048 sc1
    v_mfma_f32_32x32x16_bf16 v[176:191], v[56:59], a[212:215], v[176:191]
    ds_read_b64_tr_b16 v[54:55], v6 offset:256
    s_mov_b64 exec, 1
    buffer_store_dword v15, off, s[4:7], s60 sc1
    s_mov_b64 exec, -1
    v_mfma_f32_32x32x16_bf16 v[96:111], v[60:63], a[216:219], v[96:111]
    ds_read_b64_tr_b16 v[56:57], v8 offset:16384
    v_mfma_f32_32x32x16_bf16 v[128:143], v[60:63], a[220:223], v[128:143]
    ds_read_b64_tr_b16 v[58:59], v8 offset:16640
    buffer_load_dwordx4 v[36:39], v1, s[4:7], s37 offen offset:2048 sc1
    s_waitcnt lgkmcnt(6)
    v_mfma_f32_32x32x16_bf16 v[112:127], v[64:67], a[216:219], v[112:127]
    ds_read_b64_tr_b16 v[60:61], v5 offset:1024
    v_mfma_f32_32x32x16_bf16 v[144:159], v[64:67], a[220:223], v[144:159]
    ds_read_b64_tr_b16 v[62:63], v5 offset:1280
    buffer_load_dwordx4 v[40:43], v1, s[4:7], s36 offen offset:3072 sc1
    v_mfma_f32_32x32x16_bf16 v[160:175], v[68:71], a[216:219], v[160:175]
    ds_read_b64_tr_b16 v[64:65], v6 offset:1024
    v_mfma_f32_32x32x16_bf16 v[176:191], v[68:71], a[220:223], v[176:191]
    ds_read_b64_tr_b16 v[66:67], v6 offset:1280
    buffer_load_dwordx4 v[44:47], v1, s[4:7], s37 offen offset:3072 sc1
    s_waitcnt lgkmcnt(6)
    s_waitcnt vmcnt(20)
    v_mfma_f32_32x32x16_bf16 v[96:111], v[48:51], a[224:227], v[96:111]
    ds_read_b64_tr_b16 v[68:69], v8 offset:17408
    s_waitcnt vmcnt(19)
    v_mfma_f32_32x32x16_bf16 v[128:143], v[48:51], a[228:231], v[128:143]
    ds_read_b64_tr_b16 v[70:71], v8 offset:17664
    s_add_u32 m0, s27, 90112
    s_add_u32 s34, s32, 0
    buffer_load_dwordx4 v2, s[8:11], s34 offen lds
    v_mfma_f32_32x32x16_bf16 v[112:127], v[52:55], a[224:227], v[112:127]
    ds_read_b64_tr_b16 v[48:49], v5 offset:2048
    v_mfma_f32_32x32x16_bf16 v[144:159], v[52:55], a[228:231], v[144:159]
    ds_read_b64_tr_b16 v[50:51], v5 offset:2304
    s_add_u32 m0, s27, 98240
    s_add_u32 s35, s32, 146432
    buffer_load_dwordx4 v2, s[8:11], s34 offen offset:64 lds
    s_waitcnt lgkmcnt(6)
    v_mfma_f32_32x32x16_bf16 v[160:175], v[56:59], a[224:227], v[160:175]
    ds_read_b64_tr_b16 v[52:53], v6 offset:2048
    v_mfma_f32_32x32x16_bf16 v[176:191], v[56:59], a[228:231], v[176:191]
    ds_read_b64_tr_b16 v[54:55], v6 offset:2304
    s_add_u32 m0, s27, 98240
    s_nop 0
    buffer_load_dwordx4 v2, s[8:11], s35 offen offset:1088 lds
    s_waitcnt vmcnt(21)
    v_mfma_f32_32x32x16_bf16 v[96:111], v[60:63], a[232:235], v[96:111]
    ds_read_b64_tr_b16 v[56:57], v8 offset:18432
    s_waitcnt vmcnt(20)
    v_mfma_f32_32x32x16_bf16 v[128:143], v[60:63], a[236:239], v[128:143]
    ds_read_b64_tr_b16 v[58:59], v8 offset:18688
    s_add_u32 m0, s27, 90112
    s_nop 0
    buffer_load_dwordx4 v2, s[8:11], s35 offen offset:1024 lds
    s_waitcnt lgkmcnt(6)
    v_mfma_f32_32x32x16_bf16 v[112:127], v[64:67], a[232:235], v[112:127]
    ds_read_b64_tr_b16 v[60:61], v5 offset:3072
    v_mfma_f32_32x32x16_bf16 v[144:159], v[64:67], a[236:239], v[144:159]
    ds_read_b64_tr_b16 v[62:63], v5 offset:3328
    s_add_u32 m0, s27, 24576
    s_add_u32 s34, s32, 589824
    buffer_load_dwordx4 v2, s[8:11], s34 offen lds
    v_mfma_f32_32x32x16_bf16 v[160:175], v[68:71], a[232:235], v[160:175]
    ds_read_b64_tr_b16 v[64:65], v6 offset:3072
    v_mfma_f32_32x32x16_bf16 v[176:191], v[68:71], a[236:239], v[176:191]
    ds_read_b64_tr_b16 v[66:67], v6 offset:3328
    s_add_u32 m0, s27, 106432
    s_add_u32 s35, s32, 736256
    buffer_load_dwordx4 v2, s[8:11], s34 offen offset:64 lds
    s_waitcnt lgkmcnt(6)
    s_waitcnt vmcnt(22)
    v_mfma_f32_32x32x16_bf16 v[96:111], v[48:51], a[240:243], v[96:111]
    ds_read_b64_tr_b16 v[68:69], v8 offset:19456
    s_waitcnt vmcnt(21)
    v_mfma_f32_32x32x16_bf16 v[128:143], v[48:51], a[244:247], v[128:143]
    ds_read_b64_tr_b16 v[70:71], v8 offset:19712
    s_add_u32 m0, s27, 106432
    s_nop 0
    buffer_load_dwordx4 v2, s[8:11], s35 offen offset:1088 lds
    v_mfma_f32_32x32x16_bf16 v[112:127], v[52:55], a[240:243], v[112:127]
    s_waitcnt vmcnt(16)
    s_barrier
    ds_read_b64_tr_b16 v[48:49], v5 offset:8192
    s_and_b32 s40, s2, 1
    s_lshl_b32 s40, s40, 3
    s_and_b32 s38, s66, 7
    v_mfma_f32_32x32x16_bf16 v[144:159], v[52:55], a[244:247], v[144:159]
    ds_read_b64_tr_b16 v[50:51], v5 offset:8448
    s_add_u32 m0, s27, 24576
    s_nop 0
    buffer_load_dwordx4 v2, s[8:11], s35 offen offset:1024 lds
    s_waitcnt lgkmcnt(6)
    v_mfma_f32_32x32x16_bf16 v[160:175], v[56:59], a[240:243], v[160:175]
    ds_read_b64_tr_b16 v[52:53], v6 offset:8192
    s_add_u32 s40, s40, s38
    s_lshr_b32 s39, s66, 3
    s_lshl_b32 s30, s40, 3
    s_lshl_b32 s38, s3, 1
    s_add_u32 s30, s30, s38
    v_mfma_f32_32x32x16_bf16 v[176:191], v[56:59], a[244:247], v[176:191]
    ds_read_b64_tr_b16 v[54:55], v6 offset:8448
    s_add_u32 m0, s27, 32768
    s_add_u32 s34, s32, 1179648
    buffer_load_dwordx4 v2, s[8:11], s34 offen lds
    s_mul_i32 s30, s30, 165888
    v_mfma_f32_32x32x16_bf16 v[96:111], v[60:63], a[248:251], v[96:111]
    ds_read_b64_tr_b16 v[56:57], v5 offset:16384
    s_add_u32 s30, s30, 12503040
    s_mul_i32 s38, s65, 36
    s_lshl_b32 s20, s38, 10
    s_add_u32 s30, s30, s20
    s_add_u32 s33, s30, 165888
    v_mfma_f32_32x32x16_bf16 v[128:143], v[60:63], a[252:255], v[128:143]
    ds_read_b64_tr_b16 v[58:59], v5 offset:16640
    s_add_u32 m0, s27, 40896
    s_add_u32 s35, s32, 1326080
    buffer_load_dwordx4 v2, s[8:11], s34 offen offset:64 lds
    s_waitcnt lgkmcnt(6)
    v_mfma_f32_32x32x16_bf16 v[112:127], v[64:67], a[248:251], v[112:127]
    ds_read_b64_tr_b16 v[60:61], v5 offset:9216
    s_mul_i32 s20, s39, 144
    s_add_u32 s38, s38, s20
    s_mul_i32 s16, s38, 5120
    s_add_u32 s16, s16, s26
    s_add_u32 s16, s16, 7110656
    v_mfma_f32_32x32x16_bf16 v[144:159], v[64:67], a[252:255], v[144:159]
    ds_read_b64_tr_b16 v[62:63], v5 offset:9472
    s_add_u32 m0, s27, 40896
    s_nop 0
    buffer_load_dwordx4 v2, s[8:11], s35 offen offset:1088 lds
    s_lshl_b32 s19, s38, 11
    v_mfma_f32_32x32x16_bf16 v[160:175], v[68:71], a[248:251], v[160:175]
    ds_read_b64_tr_b16 v[64:65], v6 offset:9216
    s_add_u32 s19, s19, s26
    s_add_u32 s20, s19, 11239424
    s_add_u32 s19, s19, 10059776
    s_lshl_b32 s28, s39, 2
    s_add_u32 s28, s28, s65
    v_mfma_f32_32x32x16_bf16 v[176:191], v[68:71], a[252:255], v[176:191]
    ds_read_b64_tr_b16 v[66:67], v6 offset:9472
    s_add_u32 m0, s27, 32768
    s_nop 0
    buffer_load_dwordx4 v2, s[8:11], s35 offen offset:1024 lds
    s_waitcnt lgkmcnt(6)
    s_waitcnt vmcnt(20)
    v_mfma_f32_32x32x16_bf16 v[96:111], v[48:51], v[16:19], v[96:111]
    ds_read_b64_tr_b16 v[68:69], v5 offset:17408
    s_mul_i32 s28, s28, 55296
    s_add_u32 s28, s28, s26
    s_add_u32 s28, s28, 6225920
    s_lshr_b32 s23, s40, 1
    s_lshl_b32 s23, s23, 2
    s_waitcnt vmcnt(19)
    v_mfma_f32_32x32x16_bf16 v[128:143], v[48:51], v[20:23], v[128:143]
    ds_read_b64_tr_b16 v[70:71], v5 offset:17664
    s_add_u32 m0, s27, 49152
    s_add_u32 s34, s32, 1769472
    buffer_load_dwordx4 v2, s[8:11], s34 offen lds
    s_and_b32 s38, s40, 1
    v_mfma_f32_32x32x16_bf16 v[112:127], v[52:55], v[16:19], v[112:127]
    ds_read_b64_tr_b16 v[48:49], v5 offset:10240
    s_lshl_b32 s38, s38, 1
    s_add_u32 s23, s23, s38
    s_lshr_b32 s38, s3, 1
    s_add_u32 s23, s23, s38
    s_lshl_b32 s23, s23, 12
    v_mfma_f32_32x32x16_bf16 v[144:159], v[52:55], v[20:23], v[144:159]
    ds_read_b64_tr_b16 v[50:51], v5 offset:10496
    s_add_u32 m0, s27, 57280
    s_add_u32 s35, s32, 1915904
    buffer_load_dwordx4 v2, s[8:11], s34 offen offset:64 lds
    s_waitcnt lgkmcnt(6)
    v_mfma_f32_32x32x16_bf16 v[160:175], v[56:59], v[16:19], v[160:175]
    ds_read_b64_tr_b16 v[52:53], v6 offset:10240
    s_add_u32 s23, s23, 45842432
    s_lshl_b32 s40, s40, 2
    s_add_u32 s40, s40, s39
    s_mul_i32 s39, s3, 9216
    s_mul_i32 s22, s40, 147456
    v_mfma_f32_32x32x16_bf16 v[176:191], v[56:59], v[20:23], v[176:191]
    ds_read_b64_tr_b16 v[54:55], v6 offset:10496
    s_add_u32 m0, s27, 57280
    s_nop 0
    buffer_load_dwordx4 v2, s[8:11], s35 offen offset:1088 lds
    s_add_u32 s22, s22, s39
    s_waitcnt vmcnt(21)
    v_mfma_f32_32x32x16_bf16 v[96:111], v[60:63], v[24:27], v[96:111]
    ds_read_b64_tr_b16 v[56:57], v5 offset:18432
    s_add_u32 s22, s22, 46104576
    s_mul_i32 s21, s65, 36864
    s_add_u32 s21, s21, s22
    s_add_u32 s38, s65, 1
    s_and_b32 s38, s38, 3
    s_waitcnt vmcnt(20)
    v_mfma_f32_32x32x16_bf16 v[128:143], v[60:63], v[28:31], v[128:143]
    ds_read_b64_tr_b16 v[58:59], v5 offset:18688
    s_add_u32 m0, s27, 49152
    s_nop 0
    buffer_load_dwordx4 v2, s[8:11], s35 offen offset:1024 lds
    s_waitcnt lgkmcnt(6)
    v_mfma_f32_32x32x16_bf16 v[112:127], v[64:67], v[24:27], v[112:127]
    ds_read_b64_tr_b16 v[60:61], v5 offset:11264
    s_lshl_b32 s38, s38, 11
    s_add_u32 s31, s21, s38
    s_lshl_b32 s38, s65, 3
    s_lshl_b32 s72, 0xff, s38
    s_mov_b32 s73, 0
    v_mfma_f32_32x32x16_bf16 v[144:159], v[64:67], v[28:31], v[144:159]
    ds_read_b64_tr_b16 v[62:63], v5 offset:11520
    s_add_u32 m0, s27, 65536
    s_add_u32 s34, s32, 2359296
    buffer_load_dwordx4 v2, s[8:11], s34 offen lds
    s_lshr_b32 s38, s66, 2
    v_mfma_f32_32x32x16_bf16 v[160:175], v[68:71], v[24:27], v[160:175]
    ds_read_b64_tr_b16 v[64:65], v6 offset:11264
    s_lshl_b32 s76, 0x01010101, s38
    s_mov_b32 s77, 0
    s_and_b32 s40, s3, 1
    s_and_b32 s17, s24, 3
    s_lshl_b32 s17, s17, 1
    v_mfma_f32_32x32x16_bf16 v[176:191], v[68:71], v[28:31], v[176:191]
    ds_read_b64_tr_b16 v[66:67], v6 offset:11520
    s_add_u32 m0, s27, 73664
    s_add_u32 s35, s32, 2505728
    buffer_load_dwordx4 v2, s[8:11], s34 offen offset:64 lds
    s_waitcnt lgkmcnt(6)
    s_waitcnt vmcnt(22)
    v_mfma_f32_32x32x16_bf16 v[96:111], v[48:51], v[32:35], v[96:111]
    ds_read_b64_tr_b16 v[68:69], v5 offset:19456
    s_add_u32 s17, s17, s40
    s_mul_i32 s17, s17, 663552
    s_lshl_b32 s38, s25, 8
    s_add_u32 s17, s17, s38
    v_mov_b32 v84, -1
    s_waitcnt vmcnt(20)
    v_mfma_f32_32x32x16_bf16 v[128:143], v[48:51], v[36:39], v[128:143]
    ds_read_b64_tr_b16 v[70:71], v5 offset:19712
    s_add_u32 m0, s27, 73664
    s_nop 0
    buffer_load_dwordx4 v2, s[8:11], s35 offen offset:1088 lds
    v_mov_b32 v85, -1
    v_mfma_f32_32x32x16_bf16 v[112:127], v[52:55], v[32:35], v[112:127]
    s_waitcnt vmcnt(11)
    s_barrier
    ds_read_b64_tr_b16 v[48:49], v7 offset:24576
    v_mov_b32 v86, -1
    v_mov_b32 v87, -1
    v_mfma_f32_32x32x16_bf16 v[144:159], v[52:55], v[36:39], v[144:159]
    ds_read_b64_tr_b16 v[50:51], v7 offset:24832
    s_add_u32 m0, s27, 65536
    s_nop 0
    buffer_load_dwordx4 v2, s[8:11], s35 offen offset:1024 lds
    s_waitcnt lgkmcnt(6)
    v_mfma_f32_32x32x16_bf16 v[160:175], v[56:59], v[32:35], v[160:175]
    ds_read_b64_tr_b16 v[52:53], v8 offset:24576
    buffer_store_dwordx4 v[84:87], v1, s[4:7], s31 offen offset:0 sc1
    v_mfma_f32_32x32x16_bf16 v[176:191], v[56:59], v[36:39], v[176:191]
    ds_read_b64_tr_b16 v[54:55], v8 offset:24832
    v_mfma_f32_32x32x16_bf16 v[96:111], v[60:63], v[40:43], v[96:111]
    ds_read_b64_tr_b16 v[56:57], v7 offset:25600
    s_add_u32 m0, s27, 0
    s_add_u32 s34, s32, 2949120
    buffer_load_dwordx4 v2, s[8:11], s34 offen lds
    v_mfma_f32_32x32x16_bf16 v[128:143], v[60:63], v[44:47], v[128:143]
    ds_read_b64_tr_b16 v[58:59], v7 offset:25856
    s_waitcnt lgkmcnt(6)
    v_mfma_f32_32x32x16_bf16 v[112:127], v[64:67], v[40:43], v[112:127]
    ds_read_b64_tr_b16 v[60:61], v8 offset:25600
    s_add_u32 m0, s27, 81856
    s_add_u32 s35, s32, 3095552
    buffer_load_dwordx4 v2, s[8:11], s34 offen offset:64 lds
    v_mfma_f32_32x32x16_bf16 v[144:159], v[64:67], v[44:47], v[144:159]
    ds_read_b64_tr_b16 v[62:63], v8 offset:25856
    v_mfma_f32_32x32x16_bf16 v[160:175], v[68:71], v[40:43], v[160:175]
    ds_read_b64_tr_b16 v[64:65], v7 offset:26624
    buffer_load_dwordx4 v2, s[8:11], s35 offen offset:1088 lds
    v_mfma_f32_32x32x16_bf16 v[176:191], v[68:71], v[44:47], v[176:191]
    ds_read_b64_tr_b16 v[66:67], v7 offset:26880
    buffer_store_dwordx4 v[84:87], v1, s[4:7], s31 offen offset:1024 sc1
    s_waitcnt lgkmcnt(6)
    v_mfma_f32_32x32x16_bf16 v[192:207], v[48:51], a[0:3], 0
    ds_read_b64_tr_b16 v[68:69], v8 offset:26624
    v_cvt_pk_bf16_f32 v96, v96, v97
    v_cvt_pk_bf16_f32 v97, v98, v99
    v_cvt_pk_bf16_f32 v98, v100, v101
    v_cvt_pk_bf16_f32 v99, v102, v103
    v_mfma_f32_32x32x16_bf16 v[208:223], v[48:51], a[4:7], 0
    ds_read_b64_tr_b16 v[70:71], v8 offset:26880
    s_add_u32 m0, s27, 0
    s_nop 0
    buffer_load_dwordx4 v2, s[8:11], s35 offen offset:1024 lds
    v_cvt_pk_bf16_f32 v100, v104, v105
    v_mfma_f32_32x32x16_bf16 v[224:239], v[52:55], a[0:3], 0
    ds_read_b64_tr_b16 v[48:49], v7 offset:27648
    v_cvt_pk_bf16_f32 v101, v106, v107
    v_cvt_pk_bf16_f32 v102, v108, v109
    v_cvt_pk_bf16_f32 v103, v110, v111
    v_cvt_pk_bf16_f32 v104, v112, v113
    v_mfma_f32_32x32x16_bf16 v[240:255], v[52:55], a[4:7], 0
    ds_read_b64_tr_b16 v[50:51], v7 offset:27904
    v_cvt_pk_bf16_f32 v105, v114, v115
    v_cvt_pk_bf16_f32 v106, v116, v117
    v_cvt_pk_bf16_f32 v107, v118, v119
    s_waitcnt lgkmcnt(6)
    v_mfma_f32_32x32x16_bf16 v[192:207], v[56:59], a[8:11], v[192:207]
    ds_read_b64_tr_b16 v[52:53], v8 offset:27648
    v_cvt_pk_bf16_f32 v108, v120, v121
    v_cvt_pk_bf16_f32 v109, v122, v123
    v_cvt_pk_bf16_f32 v110, v124, v125
    v_cvt_pk_bf16_f32 v111, v126, v127
    v_mfma_f32_32x32x16_bf16 v[208:223], v[56:59], a[12:15], v[208:223]
    ds_read_b64_tr_b16 v[54:55], v8 offset:27904
    v_cvt_pk_bf16_f32 v128, v128, v129
    v_cvt_pk_bf16_f32 v129, v130, v131
    v_cvt_pk_bf16_f32 v130, v132, v133
    v_cvt_pk_bf16_f32 v131, v134, v135
    v_mfma_f32_32x32x16_bf16 v[224:239], v[60:63], a[8:11], v[224:239]
    ds_read_b64_tr_b16 v[56:57], v5 offset:24576
    v_cvt_pk_bf16_f32 v132, v136, v137
    v_cvt_pk_bf16_f32 v133, v138, v139
    v_cvt_pk_bf16_f32 v134, v140, v141
    v_cvt_pk_bf16_f32 v135, v142, v143
    v_mfma_f32_32x32x16_bf16 v[240:255], v[60:63], a[12:15], v[240:255]
    ds_read_b64_tr_b16 v[58:59], v5 offset:24832
    v_cvt_pk_bf16_f32 v136, v144, v145
    v_cvt_pk_bf16_f32 v137, v146, v147
    v_cvt_pk_bf16_f32 v138, v148, v149
    s_waitcnt lgkmcnt(6)
    v_mfma_f32_32x32x16_bf16 v[192:207], v[64:67], a[16:19], v[192:207]
    ds_read_b64_tr_b16 v[60:61], v6 offset:24576
    v_cvt_pk_bf16_f32 v139, v150, v151
    v_cvt_pk_bf16_f32 v140, v152, v153
    v_cvt_pk_bf16_f32 v141, v154, v155
    v_cvt_pk_bf16_f32 v142, v156, v157
    v_mfma_f32_32x32x16_bf16 v[208:223], v[64:67], a[20:23], v[208:223]
    ds_read_b64_tr_b16 v[62:63], v6 offset:24832
    v_cvt_pk_bf16_f32 v143, v158, v159
    v_mul_f32 v80, s62, v160
    v_mul_f32 v81, s62, v161
    v_mul_f32 v82, s62, v162
    v_mul_f32 v83, s62, v163
    v_mfma_f32_32x32x16_bf16 v[224:239], v[68:71], a[16:19], v[224:239]
    ds_read_b64_tr_b16 v[64:65], v5 offset:25600
    v_exp_f32 v80, v80
    v_mul_f32 v168, v160, v168
    v_exp_f32 v81, v81
    v_mfma_f32_32x32x16_bf16 v[240:255], v[68:71], a[20:23], v[240:255]
    ds_read_b64_tr_b16 v[66:67], v5 offset:25856
    v_mul_f32 v169, v161, v169
    v_exp_f32 v82, v82
    v_mul_f32 v170, v162, v170
    s_waitcnt lgkmcnt(6)
    v_mfma_f32_32x32x16_bf16 v[192:207], v[48:51], a[24:27], v[192:207]
    ds_read_b64_tr_b16 v[68:69], v6 offset:25600
    v_mul_u32_u24 v156, 2304, v0
    s_add_u32 s79, s17, 0
    s_mov_b64 exec, 0x3ffff
    buffer_load_dword v156, v156, s[8:11], s79 offen offset:128
    s_mov_b64 exec, -1
    v_mfma_f32_32x32x16_bf16 v[208:223], v[48:51], a[28:31], v[208:223]
    ds_read_b64_tr_b16 v[70:71], v6 offset:25856
    v_exp_f32 v83, v83
    v_mul_f32 v171, v163, v171
    v_add_f32 v80, 1.0, v80
    v_add_f32 v81, 1.0, v81
    v_mfma_f32_32x32x16_bf16 v[224:239], v[52:55], a[24:27], v[224:239]
    ds_read_b64_tr_b16 v[48:49], v5 offset:26624
    v_add_f32 v82, 1.0, v82
    v_add_f32 v83, 1.0, v83
    v_rcp_f32 v80, v80
    v_mfma_f32_32x32x16_bf16 v[240:255], v[52:55], a[28:31], v[240:255]
    ds_read_b64_tr_b16 v[50:51], v5 offset:26880
    v_rcp_f32 v81, v81
    v_rcp_f32 v82, v82
    s_waitcnt lgkmcnt(6)
    v_mfma_f32_32x32x16_bf16 v[192:207], v[56:59], a[32:35], v[192:207]
    ds_read_b64_tr_b16 v[52:53], v6 offset:26624
    v_rcp_f32 v83, v83
    v_mul_f32 v168, v168, v80
    v_mul_f32 v169, v169, v81
    v_mul_f32 v170, v170, v82
    v_mfma_f32_32x32x16_bf16 v[208:223], v[56:59], a[36:39], v[208:223]
    ds_read_b64_tr_b16 v[54:55], v6 offset:26880
    v_mul_f32 v171, v171, v83
    v_cvt_pk_bf16_f32 v76, v168, v169
    v_cvt_pk_bf16_f32 v77, v170, v171
    v_mul_f32 v80, s62, v164
    v_mul_f32 v81, s62, v165
    v_mfma_f32_32x32x16_bf16 v[224:239], v[60:63], a[32:35], v[224:239]
    ds_read_b64_tr_b16 v[56:57], v5 offset:27648
    v_mul_f32 v82, s62, v166
    v_mul_f32 v83, s62, v167
    v_exp_f32 v80, v80
    v_mul_f32 v172, v164, v172
    v_mfma_f32_32x32x16_bf16 v[240:255], v[60:63], a[36:39], v[240:255]
    ds_read_b64_tr_b16 v[58:59], v5 offset:27904
    v_exp_f32 v81, v81
    v_mul_f32 v173, v165, v173
    s_waitcnt lgkmcnt(6)
    v_mfma_f32_32x32x16_bf16 v[192:207], v[64:67], a[40:43], v[192:207]
    ds_read_b64_tr_b16 v[60:61], v6 offset:27648
    v_exp_f32 v82, v82
    v_mul_f32 v174, v166, v174
    v_exp_f32 v83, v83
    v_mfma_f32_32x32x16_bf16 v[208:223], v[64:67], a[44:47], v[208:223]
    ds_read_b64_tr_b16 v[62:63], v6 offset:27904
    v_mul_f32 v175, v167, v175
    v_add_f32 v80, 1.0, v80
    v_add_f32 v81, 1.0, v81
    v_add_f32 v82, 1.0, v82
    v_add_f32 v83, 1.0, v83
    v_mfma_f32_32x32x16_bf16 v[224:239], v[68:71], a[40:43], v[224:239]
    s_waitcnt vmcnt(11)
    s_barrier
    ds_read_b64_tr_b16 v[64:65], v5 offset:32768
    s_add_u32 m0, s27, 8192
    s_add_u32 s34, s32, 3538944
    buffer_load_dwordx4 v2, s[8:11], s34 offen lds
    v_mfma_f32_32x32x16_bf16 v[240:255], v[68:71], a[44:47], v[240:255]
    ds_read_b64_tr_b16 v[66:67], v5 offset:33024
    v_rcp_f32 v80, v80
    v_rcp_f32 v81, v81
    s_waitcnt lgkmcnt(6)
    v_mfma_f32_32x32x16_bf16 v[192:207], v[48:51], a[48:51], v[192:207]
    ds_read_b64_tr_b16 v[68:69], v6 offset:32768
    s_add_u32 m0, s27, 16320
    s_add_u32 s35, s32, 3685376
    buffer_load_dwordx4 v2, s[8:11], s34 offen offset:64 lds
    v_mfma_f32_32x32x16_bf16 v[208:223], v[48:51], a[52:55], v[208:223]
    ds_read_b64_tr_b16 v[70:71], v6 offset:33024
    v_rcp_f32 v82, v82
    v_rcp_f32 v83, v83
    v_mul_f32 v172, v172, v80
    v_mfma_f32_32x32x16_bf16 v[224:239], v[52:55], a[48:51], v[224:239]
    ds_read_b64_tr_b16 v[48:49], v5 offset:33792
    buffer_load_dwordx4 v2, s[8:11], s35 offen offset:1088 lds
    v_mul_f32 v173, v173, v81
    v_mul_f32 v174, v174, v82
    v_mul_f32 v175, v175, v83
    v_mfma_f32_32x32x16_bf16 v[240:255], v[52:55], a[52:55], v[240:255]
    ds_read_b64_tr_b16 v[50:51], v5 offset:34048
    v_cvt_pk_bf16_f32 v78, v172, v173
    v_cvt_pk_bf16_f32 v79, v174, v175
    s_waitcnt lgkmcnt(6)
    v_mfma_f32_32x32x16_bf16 v[192:207], v[56:59], a[56:59], v[192:207]
    ds_read_b64_tr_b16 v[52:53], v6 offset:33792
    s_add_u32 m0, s27, 8192
    s_nop 0
    buffer_load_dwordx4 v2, s[8:11], s35 offen offset:1024 lds
    v_mfma_f32_32x32x16_bf16 v[208:223], v[56:59], a[60:63], v[208:223]
    ds_read_b64_tr_b16 v[54:55], v6 offset:34048
    buffer_store_dwordx4 v[76:79], v3, s[4:7], s41 offen offset:0 sc1
    v_mfma_f32_32x32x16_bf16 v[224:239], v[60:63], a[56:59], v[224:239]
    ds_read_b64_tr_b16 v[56:57], v5 offset:34816
    v_mul_f32 v80, s62, v176
    v_mul_f32 v81, s62, v177
    v_mul_f32 v82, s62, v178
    v_mul_f32 v83, s62, v179
    v_mfma_f32_32x32x16_bf16 v[240:255], v[60:63], a[60:63], v[240:255]
    ds_read_b64_tr_b16 v[58:59], v5 offset:35072
    v_exp_f32 v80, v80
    v_mul_f32 v184, v176, v184
    s_waitcnt lgkmcnt(6)
    v_mfma_f32_32x32x16_bf16 v[192:207], v[64:67], a[64:67], v[192:207]
    ds_read_b64_tr_b16 v[60:61], v6 offset:34816
    v_exp_f32 v81, v81
    v_mul_f32 v185, v177, v185
    v_exp_f32 v82, v82
    v_mfma_f32_32x32x16_bf16 v[208:223], v[64:67], a[68:71], v[208:223]
    ds_read_b64_tr_b16 v[62:63], v6 offset:35072
    v_mul_f32 v186, v178, v186
    v_exp_f32 v83, v83
    v_mul_f32 v187, v179, v187
    v_add_f32 v80, 1.0, v80
    v_mfma_f32_32x32x16_bf16 v[224:239], v[68:71], a[64:67], v[224:239]
    ds_read_b64_tr_b16 v[64:65], v5 offset:35840
    v_add_f32 v81, 1.0, v81
    v_add_f32 v82, 1.0, v82
    v_add_f32 v83, 1.0, v83
    v_rcp_f32 v80, v80
    v_mfma_f32_32x32x16_bf16 v[240:255], v[68:71], a[68:71], v[240:255]
    ds_read_b64_tr_b16 v[66:67], v5 offset:36096
    v_rcp_f32 v81, v81
    v_rcp_f32 v82, v82
    s_waitcnt lgkmcnt(6)
    v_mfma_f32_32x32x16_bf16 v[192:207], v[48:51], a[72:75], v[192:207]
    ds_read_b64_tr_b16 v[68:69], v6 offset:35840
    v_mul_u32_u24 v157, 2304, v0
    s_add_u32 s79, s17, 165888
    s_mov_b64 exec, 0x3ffff
    buffer_load_dword v157, v157, s[8:11], s79 offen offset:128
    s_mov_b64 exec, -1
    v_mfma_f32_32x32x16_bf16 v[208:223], v[48:51], a[76:79], v[208:223]
    ds_read_b64_tr_b16 v[70:71], v6 offset:36096
    v_rcp_f32 v83, v83
    v_mul_f32 v184, v184, v80
    v_mul_f32 v185, v185, v81
    v_mul_f32 v186, v186, v82
    v_mfma_f32_32x32x16_bf16 v[224:239], v[52:55], a[72:75], v[224:239]
    ds_read_b64_tr_b16 v[48:49], v5 offset:49152
    v_mul_f32 v187, v187, v83
    v_cvt_pk_bf16_f32 v72, v184, v185
    v_cvt_pk_bf16_f32 v73, v186, v187
    v_mul_f32 v80, s62, v180
    v_mul_f32 v81, s62, v181
    v_mfma_f32_32x32x16_bf16 v[240:255], v[52:55], a[76:79], v[240:255]
    ds_read_b64_tr_b16 v[50:51], v5 offset:49408
    v_mul_f32 v82, s62, v182
    v_mul_f32 v83, s62, v183
    v_exp_f32 v80, v80
    s_waitcnt lgkmcnt(6)
    v_mfma_f32_32x32x16_bf16 v[192:207], v[56:59], a[80:83], v[192:207]
    ds_read_b64_tr_b16 v[52:53], v6 offset:49152
    v_mul_f32 v188, v180, v188
    v_exp_f32 v81, v81
    v_mul_f32 v189, v181, v189
    v_mfma_f32_32x32x16_bf16 v[208:223], v[56:59], a[84:87], v[208:223]
    ds_read_b64_tr_b16 v[54:55], v6 offset:49408
    v_exp_f32 v82, v82
    v_mul_f32 v190, v182, v190
    v_exp_f32 v83, v83
    v_mfma_f32_32x32x16_bf16 v[224:239], v[60:63], a[80:83], v[224:239]
    ds_read_b64_tr_b16 v[56:57], v5 offset:50176
    v_mul_f32 v191, v183, v191
    v_add_f32 v80, 1.0, v80
    v_add_f32 v81, 1.0, v81
    v_add_f32 v82, 1.0, v82
    v_add_f32 v83, 1.0, v83
    v_mfma_f32_32x32x16_bf16 v[240:255], v[60:63], a[84:87], v[240:255]
    ds_read_b64_tr_b16 v[58:59], v5 offset:50432
    v_rcp_f32 v80, v80
    v_rcp_f32 v81, v81
    s_waitcnt lgkmcnt(6)
    v_mfma_f32_32x32x16_bf16 v[192:207], v[64:67], a[88:91], v[192:207]
    ds_read_b64_tr_b16 v[60:61], v6 offset:50176
    v_rcp_f32 v82, v82
    v_rcp_f32 v83, v83
    v_mul_f32 v188, v188, v80
    v_mfma_f32_32x32x16_bf16 v[208:223], v[64:67], a[92:95], v[208:223]
    ds_read_b64_tr_b16 v[62:63], v6 offset:50432
    v_mul_f32 v189, v189, v81
    v_mul_f32 v190, v190, v82
    v_mul_f32 v191, v191, v83
    v_cvt_pk_bf16_f32 v74, v188, v189
    v_cvt_pk_bf16_f32 v75, v190, v191
    v_mfma_f32_32x32x16_bf16 v[224:239], v[68:71], a[88:91], v[224:239]
    ds_read_b64_tr_b16 v[64:65], v5 offset:51200
    buffer_store_dwordx4 v[72:75], v3, s[4:7], s42 offen offset:0 sc1
    v_mfma_f32_32x32x16_bf16 v[240:255], v[68:71], a[92:95], v[240:255]
    ds_read_b64_tr_b16 v[66:67], v5 offset:51456
    v_mov_b32 v15, 0x3f80
    v_add_u32 v14, 114688, v1
    ds_read_b128 v[72:75], v14 offset:0
    s_waitcnt lgkmcnt(7)
    v_mfma_f32_32x32x16_bf16 v[192:207], v[48:51], a[96:99], v[192:207]
    ds_read_b64_tr_b16 v[68:69], v6 offset:51200
    ds_read_b128 v[76:79], v14 offset:1024
    ds_read_b128 v[80:83], v14 offset:2048
    ds_read_b128 v[84:87], v14 offset:3072
    ds_read_b128 v[88:91], v14 offset:4096
    v_mfma_f32_32x32x16_bf16 v[208:223], v[48:51], a[100:103], v[208:223]
    ds_read_b64_tr_b16 v[70:71], v6 offset:51456
    ds_read_b128 v[92:95], v14 offset:5120
    v_lshrrev_b32 v176, 7, v0
    v_lshl_add_u32 v176, v176, 3, v11
    ds_write2_b64 v176, v[108:109], v[110:111] offset0:12 offset1:14
    v_mfma_f32_32x32x16_bf16 v[224:239], v[52:55], a[96:99], v[224:239]
    ds_read_b64_tr_b16 v[48:49], v5 offset:52224
    s_mov_b64 exec, s[68:69]
    ds_write_b32 v11, v104 offset:128
    ds_write_b32 v11, v15 offset:132
    s_mov_b64 exec, -1
    v_mfma_f32_32x32x16_bf16 v[240:255], v[52:55], a[100:103], v[240:255]
    ds_read_b64_tr_b16 v[50:51], v5 offset:52480
    s_waitcnt lgkmcnt(14)
    v_mfma_f32_32x32x16_bf16 v[192:207], v[56:59], a[104:107], v[192:207]
    ds_read_b64_tr_b16 v[52:53], v6 offset:52224
    s_waitcnt lgkmcnt(13)
    v_mfma_f32_32x32x16_bf16 v[160:175], v[72:75], v[96:99], 0
    s_waitcnt lgkmcnt(11)
    v_mfma_f32_32x32x16_bf16 v[160:175], v[76:79], v[100:103], v[160:175]
    s_waitcnt lgkmcnt(10)
    v_mfma_f32_32x32x16_bf16 v[160:175], v[80:83], v[104:107], v[160:175]
    s_waitcnt lgkmcnt(9)
    v_mfma_f32_32x32x16_bf16 v[176:191], v[84:87], v[96:99], 0
    s_waitcnt lgkmcnt(8)
    v_mfma_f32_32x32x16_bf16 v[176:191], v[88:91], v[100:103], v[176:191]
    s_waitcnt lgkmcnt(6)
    v_mfma_f32_32x32x16_bf16 v[176:191], v[92:95], v[104:107], v[176:191]
    v_mfma_f32_32x32x16_bf16 v[208:223], v[56:59], a[108:111], v[208:223]
    ds_read_b64_tr_b16 v[54:55], v6 offset:52480
    v_mfma_f32_32x32x16_bf16 v[224:239], v[60:63], a[104:107], v[224:239]
    s_waitcnt vmcnt(8)
    s_barrier
    ds_read_b64_tr_b16 v[56:57], v7 offset:0
    s_add_u32 m0, s27, 24576
    s_add_u32 s34, s32, 4128768
    buffer_load_dwordx4 v2, s[8:11], s34 offen lds
    v_mfma_f32_32x32x16_bf16 v[240:255], v[60:63], a[108:111], v[240:255]
    ds_read_b64_tr_b16 v[58:59], v7 offset:256
    s_nop 0
    v_max3_f32 v178, v160, v161, v162
    v_min3_f32 v179, v160, v161, v162
    v_max3_f32 v178, v178, v163, v164
    v_mfma_f32_32x32x16_bf16 v[192:207], v[64:67], a[112:115], v[192:207]
    ds_read_b64_tr_b16 v[60:61], v8 offset:0
    s_add_u32 m0, s27, 32704
    s_add_u32 s35, s32, 4275200
    buffer_load_dwordx4 v2, s[8:11], s34 offen offset:64 lds
    v_min3_f32 v179, v179, v163, v164
    v_mfma_f32_32x32x16_bf16 v[208:223], v[64:67], a[116:119], v[208:223]
    ds_read_b64_tr_b16 v[62:63], v8 offset:256
    v_max3_f32 v178, v178, v165, v166
    v_min3_f32 v179, v179, v165, v166
    v_max3_f32 v178, v178, v167, v168
    v_min3_f32 v179, v179, v167, v168
    v_mfma_f32_32x32x16_bf16 v[224:239], v[68:71], a[112:115], v[224:239]
    ds_read_b64_tr_b16 v[64:65], v7 offset:1024
    buffer_load_dwordx4 v2, s[8:11], s35 offen offset:1088 lds
    v_max3_f32 v178, v178, v169, v170
    v_min3_f32 v179, v179, v169, v170
    v_max3_f32 v178, v178, v171, v172
    v_mfma_f32_32x32x16_bf16 v[240:255], v[68:71], a[116:119], v[240:255]
    ds_read_b64_tr_b16 v[66:67], v7 offset:1280
    v_min3_f32 v179, v179, v171, v172
    v_max3_f32 v178, v178, v173, v174
    v_min3_f32 v179, v179, v173, v174
    s_waitcnt lgkmcnt(6)
    v_mfma_f32_32x32x16_bf16 v[192:207], v[48:51], a[120:123], v[192:207]
    ds_read_b64_tr_b16 v[68:69], v8 offset:1024
    v_mul_u32_u24 v158, 2304, v0
    s_add_u32 s79, s17, 331776
    s_mov_b64 exec, 0x3ffff
    buffer_load_dword v158, v158, s[8:11], s79 offen offset:128
    s_mov_b64 exec, -1
    v_mfma_f32_32x32x16_bf16 v[208:223], v[48:51], a[124:127], v[208:223]
    ds_read_b64_tr_b16 v[70:71], v8 offset:1280
    s_add_u32 m0, s27, 24576
    s_nop 0
    buffer_load_dwordx4 v2, s[8:11], s35 offen offset:1024 lds
    v_max3_f32 v178, v178, v175, v176
    v_mfma_f32_32x32x16_bf16 v[224:239], v[52:55], a[120:123], v[224:239]
    ds_read_b64_tr_b16 v[48:49], v7 offset:2048
    v_min3_f32 v179, v179, v175, v176
    v_max_f32 v178, v178, v177
    v_min_f32 v179, v179, v177
    v_mul_f32 v180, s62, v178
    v_mul_f32 v181, s61, v179
    v_mfma_f32_32x32x16_bf16 v[240:255], v[52:55], a[124:127], v[240:255]
    ds_read_b64_tr_b16 v[50:51], v7 offset:2304
    v_fma_f32 v72, v160, s61, v180
    v_fma_f32 v160, v160, s62, v181
    v_exp_f32 v72, v72
    s_waitcnt lgkmcnt(6)
    v_mfma_f32_32x32x16_bf16 v[192:207], v[56:59], a[128:131], v[192:207]
    ds_read_b64_tr_b16 v[52:53], v8 offset:2048
    v_exp_f32 v160, v160
    v_fma_f32 v73, v161, s61, v180
    v_fma_f32 v161, v161, s62, v181
    v_mfma_f32_32x32x16_bf16 v[208:223], v[56:59], a[132:135], v[208:223]
    ds_read_b64_tr_b16 v[54:55], v8 offset:2304
    v_exp_f32 v73, v73
    v_exp_f32 v161, v161
    v_fma_f32 v74, v162, s61, v180
    v_mfma_f32_32x32x16_bf16 v[224:239], v[60:63], a[128:131], v[224:239]
    ds_read_b64_tr_b16 v[56:57], v7 offset:3072
    v_fma_f32 v162, v162, s62, v181
    v_exp_f32 v74, v74
    v_exp_f32 v162, v162
    v_mfma_f32_32x32x16_bf16 v[240:255], v[60:63], a[132:135], v[240:255]
    ds_read_b64_tr_b16 v[58:59], v7 offset:3328
    v_add_f32 v182, v72, v73
    v_add_f32 v183, v160, v161
    v_fma_f32 v75, v163, s61, v180
    v_fma_f32 v163, v163, s62, v181
    s_waitcnt lgkmcnt(6)
    v_mfma_f32_32x32x16_bf16 v[192:207], v[64:67], a[136:139], v[192:207]
    ds_read_b64_tr_b16 v[60:61], v8 offset:3072
    v_exp_f32 v75, v75
    v_exp_f32 v163, v163
    v_add_f32 v182, v182, v74
    v_mfma_f32_32x32x16_bf16 v[208:223], v[64:67], a[140:143], v[208:223]
    ds_read_b64_tr_b16 v[62:63], v8 offset:3328
    v_add_f32 v183, v183, v162
    v_fma_f32 v76, v164, s61, v180
    v_fma_f32 v164, v164, s62, v181
    v_exp_f32 v76, v76
    v_mfma_f32_32x32x16_bf16 v[224:239], v[68:71], a[136:139], v[224:239]
    ds_read_b64_tr_b16 v[64:65], v5 offset:0
    v_exp_f32 v164, v164
    v_add_f32 v182, v182, v75
    v_add_f32 v183, v183, v163
    v_fma_f32 v77, v165, s61, v180
    v_mfma_f32_32x32x16_bf16 v[240:255], v[68:71], a[140:143], v[240:255]
    ds_read_b64_tr_b16 v[66:67], v5 offset:256
    v_fma_f32 v165, v165, s62, v181
    v_exp_f32 v77, v77
    s_waitcnt lgkmcnt(6)
    v_mfma_f32_32x32x16_bf16 v[192:207], v[48:51], a[144:147], v[192:207]
    ds_read_b64_tr_b16 v[68:69], v6 offset:0
    v_exp_f32 v165, v165
    v_add_f32 v182, v182, v76
    v_add_f32 v183, v183, v164
    v_fma_f32 v78, v166, s61, v180
    v_mfma_f32_32x32x16_bf16 v[208:223], v[48:51], a[148:151], v[208:223]
    ds_read_b64_tr_b16 v[70:71], v6 offset:256
    v_fma_f32 v166, v166, s62, v181
    v_exp_f32 v78, v78
    v_exp_f32 v166, v166
    v_mfma_f32_32x32x16_bf16 v[224:239], v[52:55], a[144:147], v[224:239]
    ds_read_b64_tr_b16 v[48:49], v5 offset:1024
    v_add_f32 v182, v182, v77
    v_add_f32 v183, v183, v165
    v_fma_f32 v79, v167, s61, v180
    v_fma_f32 v167, v167, s62, v181
    v_mfma_f32_32x32x16_bf16 v[240:255], v[52:55], a[148:151], v[240:255]
    ds_read_b64_tr_b16 v[50:51], v5 offset:1280
    v_exp_f32 v79, v79
    v_exp_f32 v167, v167
    s_waitcnt lgkmcnt(6)
    v_mfma_f32_32x32x16_bf16 v[192:207], v[56:59], a[152:155], v[192:207]
    ds_read_b64_tr_b16 v[52:53], v6 offset:1024
    v_add_f32 v182, v182, v78
    v_add_f32 v183, v183, v166
    v_fma_f32 v80, v168, s61, v180
    v_fma_f32 v168, v168, s62, v181
    v_mfma_f32_32x32x16_bf16 v[208:223], v[56:59], a[156:159], v[208:223]
    ds_read_b64_tr_b16 v[54:55], v6 offset:1280
    v_exp_f32 v80, v80
    v_exp_f32 v168, v168
    v_add_f32 v182, v182, v79
    v_mfma_f32_32x32x16_bf16 v[224:239], v[60:63], a[152:155], v[224:239]
    ds_read_b64_tr_b16 v[56:57], v5 offset:2048
    v_add_f32 v183, v183, v167
    v_fma_f32 v81, v169, s61, v180
    v_fma_f32 v169, v169, s62, v181
    v_exp_f32 v81, v81
    v_mfma_f32_32x32x16_bf16 v[240:255], v[60:63], a[156:159], v[240:255]
    ds_read_b64_tr_b16 v[58:59], v5 offset:2304
    v_exp_f32 v169, v169
    v_add_f32 v182, v182, v80
    v_add_f32 v183, v183, v168
    s_waitcnt lgkmcnt(6)
    v_mfma_f32_32x32x16_bf16 v[192:207], v[64:67], a[160:163], v[192:207]
    ds_read_b64_tr_b16 v[60:61], v6 offset:2048
    v_fma_f32 v82, v170, s61, v180
    v_fma_f32 v170, v170, s62, v181
    v_exp_f32 v82, v82
    v_mfma_f32_32x32x16_bf16 v[208:223], v[64:67], a[164:167], v[208:223]
    ds_read_b64_tr_b16 v[62:63], v6 offset:2304
    v_exp_f32 v170, v170
    v_add_f32 v182, v182, v81
    v_add_f32 v183, v183, v169
    v_fma_f32 v83, v171, s61, v180
    v_mfma_f32_32x32x16_bf16 v[224:239], v[68:71], a[160:163], v[224:239]
    ds_read_b64_tr_b16 v[64:65], v5 offset:3072
    v_fma_f32 v171, v171, s62, v181
    v_exp_f32 v83, v83
    v_exp_f32 v171, v171
    v_mfma_f32_32x32x16_bf16 v[240:255], v[68:71], a[164:167], v[240:255]
    ds_read_b64_tr_b16 v[66:67], v5 offset:3328
    v_add_f32 v182, v182, v82
    v_add_f32 v183, v183, v170
    v_fma_f32 v84, v172, s61, v180
    v_fma_f32 v172, v172, s62, v181
    s_waitcnt lgkmcnt(6)
    v_mfma_f32_32x32x16_bf16 v[192:207], v[48:51], a[168:171], v[192:207]
    ds_read_b64_tr_b16 v[68:69], v6 offset:3072
    v_mul_u32_u24 v159, 2304, v0
    s_add_u32 s79, s17, 497664
    s_mov_b64 exec, 0x3ffff
    buffer_load_dword v159, v159, s[8:11], s79 offen offset:128
    s_mov_b64 exec, -1
    v_mfma_f32_32x32x16_bf16 v[208:223], v[48:51], a[172:175], v[208:223]
    ds_read_b64_tr_b16 v[70:71], v6 offset:3328
    v_exp_f32 v84, v84
    v_exp_f32 v172, v172
    v_add_f32 v182, v182, v83
    v_mfma_f32_32x32x16_bf16 v[224:239], v[52:55], a[168:171], v[224:239]
    s_waitcnt vmcnt(1)
    s_barrier
    ds_read_b64_tr_b16 v[48:49], v5 offset:8192
    s_add_u32 m0, s27, 49152
    s_add_u32 s34, s32, 4718592
    buffer_load_dwordx4 v2, s[8:11], s34 offen lds
    v_mfma_f32_32x32x16_bf16 v[240:255], v[52:55], a[172:175], v[240:255]
    ds_read_b64_tr_b16 v[50:51], v5 offset:8448
    v_add_f32 v183, v183, v171
    v_fma_f32 v85, v173, s61, v180
    v_fma_f32 v173, v173, s62, v181
    s_waitcnt lgkmcnt(6)
    v_mfma_f32_32x32x16_bf16 v[192:207], v[56:59], a[176:179], v[192:207]
    ds_read_b64_tr_b16 v[52:53], v6 offset:8192
    s_add_u32 m0, s27, 65472
    s_add_u32 s35, s32, 4865024
    buffer_load_dwordx4 v2, s[8:11], s34 offen offset:64 lds
    v_mfma_f32_32x32x16_bf16 v[208:223], v[56:59], a[180:183], v[208:223]
    ds_read_b64_tr_b16 v[54:55], v6 offset:8448
    v_exp_f32 v85, v85
    v_exp_f32 v173, v173
    v_add_f32 v182, v182, v84
    v_mfma_f32_32x32x16_bf16 v[224:239], v[60:63], a[176:179], v[224:239]
    ds_read_b64_tr_b16 v[56:57], v5 offset:9216
    buffer_load_dwordx4 v2, s[8:11], s35 offen offset:1088 lds
    v_add_f32 v183, v183, v172
    v_fma_f32 v86, v174, s61, v180
    v_fma_f32 v174, v174, s62, v181
    v_mfma_f32_32x32x16_bf16 v[240:255], v[60:63], a[180:183], v[240:255]
    ds_read_b64_tr_b16 v[58:59], v5 offset:9472
    v_exp_f32 v86, v86
    v_exp_f32 v174, v174
    s_waitcnt lgkmcnt(6)
    v_mfma_f32_32x32x16_bf16 v[192:207], v[64:67], a[184:187], v[192:207]
    ds_read_b64_tr_b16 v[60:61], v6 offset:9216
    s_add_u32 m0, s27, 49152
    s_nop 0
    buffer_load_dwordx4 v2, s[8:11], s35 offen offset:1024 lds
    v_add_f32 v182, v182, v85
    v_mfma_f32_32x32x16_bf16 v[208:223], v[64:67], a[188:191], v[208:223]
    ds_read_b64_tr_b16 v[62:63], v6 offset:9472
    v_add_f32 v183, v183, v173
    v_fma_f32 v87, v175, s61, v180
    v_fma_f32 v175, v175, s62, v181
    v_exp_f32 v87, v87
    v_mfma_f32_32x32x16_bf16 v[224:239], v[68:71], a[184:187], v[224:239]
    ds_read_b64_tr_b16 v[64:65], v5 offset:10240
    v_exp_f32 v175, v175
    v_add_f32 v182, v182, v86
    v_add_f32 v183, v183, v174
    v_fma_f32 v88, v176, s61, v180
    v_mfma_f32_32x32x16_bf16 v[240:255], v[68:71], a[188:191], v[240:255]
    ds_read_b64_tr_b16 v[66:67], v5 offset:10496
    v_fma_f32 v176, v176, s62, v181
    v_exp_f32 v88, v88
    s_waitcnt lgkmcnt(6)
    v_mfma_f32_32x32x16_bf16 v[192:207], v[48:51], a[192:195], v[192:207]
    ds_read_b64_tr_b16 v[68:69], v6 offset:10240
    v_exp_f32 v176, v176
    v_add_f32 v182, v182, v87
    v_add_f32 v183, v183, v175
    v_fma_f32 v89, v177, s61, v180
    v_mfma_f32_32x32x16_bf16 v[208:223], v[48:51], a[196:199], v[208:223]
    ds_read_b64_tr_b16 v[70:71], v6 offset:10496
    v_fma_f32 v177, v177, s62, v181
    v_exp_f32 v89, v89
    v_exp_f32 v177, v177
    v_mfma_f32_32x32x16_bf16 v[224:239], v[52:55], a[192:195], v[224:239]
    ds_read_b64_tr_b16 v[48:49], v5 offset:11264
    v_add_f32 v182, v182, v88
    v_add_f32 v183, v183, v176
    v_mov_b32 v90, 0
    v_add_f32 v182, v182, v89
    v_add_f32 v183, v183, v177
    v_mfma_f32_32x32x16_bf16 v[240:255], v[52:55], a[196:199], v[240:255]
    ds_read_b64_tr_b16 v[50:51], v5 offset:11520
    v_rcp_f32 v182, v182
    v_rcp_f32 v183, v183
    s_waitcnt lgkmcnt(6)
    v_mfma_f32_32x32x16_bf16 v[192:207], v[56:59], a[200:203], v[192:207]
    ds_read_b64_tr_b16 v[52:53], v6 offset:11264
    v_mov_b32 v91, 0
    v_mul_f32 v72, v72, v182
    v_mul_f32 v73, v73, v182
    v_cvt_pk_bf16_f32 v72, v72, v73
    v_mul_f32 v74, v74, v182
    v_mfma_f32_32x32x16_bf16 v[208:223], v[56:59], a[204:207], v[208:223]
    ds_read_b64_tr_b16 v[54:55], v6 offset:11520
    v_mul_f32 v75, v75, v182
    v_cvt_pk_bf16_f32 v73, v74, v75
    v_mul_f32 v76, v76, v182
    v_mul_f32 v77, v77, v182
    v_cvt_pk_bf16_f32 v74, v76, v77
    v_mfma_f32_32x32x16_bf16 v[224:239], v[60:63], a[200:203], v[224:239]
    ds_read_b64_tr_b16 v[56:57], v5 offset:24576
    v_mul_f32 v78, v78, v182
    v_mul_f32 v79, v79, v182
    v_cvt_pk_bf16_f32 v75, v78, v79
    v_mul_f32 v80, v80, v182
    v_mul_f32 v81, v81, v182
    v_mfma_f32_32x32x16_bf16 v[240:255], v[60:63], a[204:207], v[240:255]
    ds_read_b64_tr_b16 v[58:59], v5 offset:24832
    v_cvt_pk_bf16_f32 v76, v80, v81
    v_mul_f32 v82, v82, v182
    v_mul_f32 v83, v83, v182
    v_cvt_pk_bf16_f32 v77, v82, v83
    s_waitcnt lgkmcnt(6)
    v_mfma_f32_32x32x16_bf16 v[192:207], v[64:67], a[208:211], v[192:207]
    ds_read_b64_tr_b16 v[60:61], v6 offset:24576
    v_mul_f32 v84, v84, v182
    v_mul_f32 v85, v85, v182
    v_cvt_pk_bf16_f32 v78, v84, v85
    v_mul_f32 v86, v86, v182
    v_mul_f32 v87, v87, v182
    v_mfma_f32_32x32x16_bf16 v[208:223], v[64:67], a[212:215], v[208:223]
    ds_read_b64_tr_b16 v[62:63], v6 offset:24832
    v_cvt_pk_bf16_f32 v79, v86, v87
    v_mul_f32 v88, v88, v182
    v_mul_f32 v89, v89, v182
    v_cvt_pk_bf16_f32 v80, v88, v89
    v_mul_f32 v160, v160, v183
    v_mfma_f32_32x32x16_bf16 v[224:239], v[68:71], a[208:211], v[224:239]
    ds_read_b64_tr_b16 v[64:65], v5 offset:25600
    v_mul_f32 v161, v161, v183
    v_cvt_pk_bf16_f32 v81, v160, v161
    v_mul_f32 v162, v162, v183
    v_mul_f32 v163, v163, v183
    v_cvt_pk_bf16_f32 v82, v162, v163
    v_mfma_f32_32x32x16_bf16 v[240:255], v[68:71], a[212:215], v[240:255]
    ds_read_b64_tr_b16 v[66:67], v5 offset:25856
    v_mul_f32 v164, v164, v183
    v_mul_f32 v165, v165, v183
    v_cvt_pk_bf16_f32 v83, v164, v165
    v_mul_f32 v166, v166, v183
    s_waitcnt lgkmcnt(6)
    v_mfma_f32_32x32x16_bf16 v[192:207], v[48:51], a[216:219], v[192:207]
    ds_read_b64_tr_b16 v[68:69], v6 offset:25600
    v_mul_f32 v167, v167, v183
    v_cvt_pk_bf16_f32 v84, v166, v167
    v_mul_f32 v168, v168, v183
    v_mul_f32 v169, v169, v183
    v_cvt_pk_bf16_f32 v85, v168, v169
    v_mfma_f32_32x32x16_bf16 v[208:223], v[48:51], a[220:223], v[208:223]
    ds_read_b64_tr_b16 v[70:71], v6 offset:25856
    v_mul_f32 v170, v170, v183
    v_mul_f32 v171, v171, v183
    v_cvt_pk_bf16_f32 v86, v170, v171
    v_mul_f32 v172, v172, v183
    v_mul_f32 v173, v173, v183
    v_mfma_f32_32x32x16_bf16 v[224:239], v[52:55], a[216:219], v[224:239]
    ds_read_b64_tr_b16 v[48:49], v5 offset:26624
    v_cvt_pk_bf16_f32 v87, v172, v173
    v_mul_f32 v174, v174, v183
    v_mul_f32 v175, v175, v183
    v_cvt_pk_bf16_f32 v88, v174, v175
    v_mul_f32 v176, v176, v183
    v_mfma_f32_32x32x16_bf16 v[240:255], v[52:55], a[220:223], v[240:255]
    ds_read_b64_tr_b16 v[50:51], v5 offset:26880
    v_mul_f32 v177, v177, v183
    v_cvt_pk_bf16_f32 v89, v176, v177
    s_add_u32 s38, s55, 0
    s_waitcnt lgkmcnt(6)
    v_mfma_f32_32x32x16_bf16 v[192:207], v[56:59], a[224:227], v[192:207]
    ds_read_b64_tr_b16 v[52:53], v6 offset:26624
    buffer_store_dwordx4 v[72:75], v1, s[4:7], s38 offen offset:0
    v_mfma_f32_32x32x16_bf16 v[208:223], v[56:59], a[228:231], v[208:223]
    ds_read_b64_tr_b16 v[54:55], v6 offset:26880
    v_mfma_f32_32x32x16_bf16 v[224:239], v[60:63], a[224:227], v[224:239]
    ds_read_b64_tr_b16 v[56:57], v5 offset:27648
    buffer_store_dwordx4 v[76:79], v1, s[4:7], s38 offen offset:1024
    v_mfma_f32_32x32x16_bf16 v[240:255], v[60:63], a[228:231], v[240:255]
    ds_read_b64_tr_b16 v[58:59], v5 offset:27904
    s_waitcnt lgkmcnt(6)
    v_mfma_f32_32x32x16_bf16 v[192:207], v[64:67], a[232:235], v[192:207]
    ds_read_b64_tr_b16 v[60:61], v6 offset:27648
    buffer_store_dwordx4 v[80:83], v1, s[4:7], s38 offen offset:2048
    v_mfma_f32_32x32x16_bf16 v[208:223], v[64:67], a[236:239], v[208:223]
    ds_read_b64_tr_b16 v[62:63], v6 offset:27904
    v_mfma_f32_32x32x16_bf16 v[224:239], v[68:71], a[232:235], v[224:239]
    s_waitcnt vmcnt(3)
    s_barrier
    ds_read_b64_tr_b16 v[64:65], v5 offset:49152
    s_add_u32 m0, s27, 0
    s_add_u32 s34, s32, 128
    buffer_load_dwordx4 v2, s[8:11], s34 offen lds
    v_mfma_f32_32x32x16_bf16 v[240:255], v[68:71], a[236:239], v[240:255]
    ds_read_b64_tr_b16 v[66:67], v5 offset:49408
    buffer_store_dwordx4 v[84:87], v1, s[4:7], s38 offen offset:3072
    s_waitcnt lgkmcnt(6)
    v_mfma_f32_32x32x16_bf16 v[192:207], v[48:51], a[240:243], v[192:207]
    ds_read_b64_tr_b16 v[68:69], v6 offset:49152
    s_add_u32 s38, s55, 4096
    v_mfma_f32_32x32x16_bf16 v[208:223], v[48:51], a[244:247], v[208:223]
    ds_read_b64_tr_b16 v[70:71], v6 offset:49408
    s_add_u32 m0, s27, 8128
    s_add_u32 s35, s32, 146560
    buffer_load_dwordx4 v2, s[8:11], s34 offen offset:64 lds
    v_mfma_f32_32x32x16_bf16 v[224:239], v[52:55], a[240:243], v[224:239]
    ds_read_b64_tr_b16 v[48:49], v5 offset:50176
    buffer_store_dwordx4 v[88:91], v1, s[4:7], s38 offen offset:0
    v_mfma_f32_32x32x16_bf16 v[240:255], v[52:55], a[244:247], v[240:255]
    ds_read_b64_tr_b16 v[50:51], v5 offset:50432
    s_mov_b64 exec, s[68:69]
    ds_write_b128 v11, v[72:75] offset:0
    ds_write_b128 v11, v[76:79] offset:16
    ds_write_b128 v11, v[80:83] offset:32
    ds_write_b128 v11, v[84:87] offset:48
    ds_write_b64 v11, v[88:89] offset:64
    s_mov_b64 exec, -1
    s_waitcnt lgkmcnt(11)
    v_mfma_f32_32x32x16_bf16 v[192:207], v[56:59], a[248:251], v[192:207]
    ds_read_b64_tr_b16 v[52:53], v6 offset:50176
    buffer_load_dwordx4 v2, s[8:11], s35 offen offset:1088 lds
    ds_read_b128 v[72:75], v14 offset:0
    ds_read_b128 v[76:79], v14 offset:1024
    ds_read_b128 v[80:83], v14 offset:2048
    v_mfma_f32_32x32x16_bf16 v[208:223], v[56:59], a[252:255], v[208:223]
    ds_read_b64_tr_b16 v[54:55], v6 offset:50432
    ds_read_b128 v[84:87], v14 offset:3072
    ds_read_b128 v[88:91], v14 offset:4096
    ds_read_b128 v[92:95], v14 offset:5120
    v_lshrrev_b32 v144, 7, v0
    v_mfma_f32_32x32x16_bf16 v[224:239], v[60:63], a[248:251], v[224:239]
    ds_read_b64_tr_b16 v[56:57], v5 offset:51200
    s_add_u32 m0, s27, 0
    s_nop 0
    buffer_load_dwordx4 v2, s[8:11], s35 offen offset:1024 lds
    v_lshl_add_u32 v144, v144, 3, v11
    v_mfma_f32_32x32x16_bf16 v[240:255], v[60:63], a[252:255], v[240:255]
    ds_read_b64_tr_b16 v[58:59], v5 offset:51456
    v_add_u32 v144, 5120, v144
    ds_write2_b64 v144, v[140:141], v[142:143] offset0:12 offset1:14
    s_waitcnt lgkmcnt(14)
    v_mfma_f32_32x32x16_bf16 v[192:207], v[64:67], v[16:19], v[192:207]
    ds_read_b64_tr_b16 v[60:61], v6 offset:51200
    s_mov_b64 exec, s[68:69]
    ds_write_b32 v11, v136 offset:5248
    ds_write_b32 v11, v15 offset:5252
    s_mov_b64 exec, -1
    v_mfma_f32_32x32x16_bf16 v[208:223], v[64:67], v[20:23], v[208:223]
    ds_read_b64_tr_b16 v[62:63], v6 offset:51456
    v_mfma_f32_32x32x16_bf16 v[224:239], v[68:71], v[16:19], v[224:239]
    ds_read_b64_tr_b16 v[64:65], v5 offset:52224
    s_waitcnt lgkmcnt(14)
    v_mfma_f32_32x32x16_bf16 v[112:127], v[72:75], v[128:131], 0
    s_waitcnt lgkmcnt(13)
    v_mfma_f32_32x32x16_bf16 v[112:127], v[76:79], v[132:135], v[112:127]
    s_waitcnt lgkmcnt(12)
    v_mfma_f32_32x32x16_bf16 v[112:127], v[80:83], v[136:139], v[112:127]
    s_waitcnt lgkmcnt(10)
    v_mfma_f32_32x32x16_bf16 v[144:159], v[84:87], v[128:131], 0
    s_waitcnt lgkmcnt(9)
    v_mfma_f32_32x32x16_bf16 v[144:159], v[88:91], v[132:135], v[144:159]
    s_waitcnt lgkmcnt(8)
    v_mfma_f32_32x32x16_bf16 v[144:159], v[92:95], v[136:139], v[144:159]
    v_mfma_f32_32x32x16_bf16 v[240:255], v[68:71], v[20:23], v[240:255]
    ds_read_b64_tr_b16 v[66:67], v5 offset:52480
    v_mfma_f32_32x32x16_bf16 v[192:207], v[48:51], v[24:27], v[192:207]
    ds_read_b64_tr_b16 v[68:69], v6 offset:52224
    s_nop 7
    v_max3_f32 v146, v112, v113, v114
    v_min3_f32 v147, v112, v113, v114
    v_max3_f32 v146, v146, v115, v116
    v_min3_f32 v147, v147, v115, v116
    v_mfma_f32_32x32x16_bf16 v[208:223], v[48:51], v[28:31], v[208:223]
    ds_read_b64_tr_b16 v[70:71], v6 offset:52480
    v_max3_f32 v146, v146, v117, v118
    v_min3_f32 v147, v147, v117, v118
    v_max3_f32 v146, v146, v119, v120
    v_min3_f32 v147, v147, v119, v120
    v_mfma_f32_32x32x16_bf16 v[224:239], v[52:55], v[24:27], v[224:239]
    ds_read_b64_tr_b16 v[48:49], v7 offset:32768
    v_max3_f32 v146, v146, v121, v122
    v_min3_f32 v147, v147, v121, v122
    v_max3_f32 v146, v146, v123, v124
    v_min3_f32 v147, v147, v123, v124
    v_mfma_f32_32x32x16_bf16 v[240:255], v[52:55], v[28:31], v[240:255]
    ds_read_b64_tr_b16 v[50:51], v7 offset:33024
    v_max3_f32 v146, v146, v125, v126
    v_min3_f32 v147, v147, v125, v126
    v_max3_f32 v146, v146, v127, v144
    s_waitcnt lgkmcnt(6)
    v_mfma_f32_32x32x16_bf16 v[192:207], v[56:59], v[32:35], v[192:207]
    ds_read_b64_tr_b16 v[52:53], v8 offset:32768
    v_min3_f32 v147, v147, v127, v144
    v_max_f32 v146, v146, v145
    v_min_f32 v147, v147, v145
    v_mul_f32 v148, s62, v146
    v_mul_f32 v149, s61, v147
    v_mfma_f32_32x32x16_bf16 v[208:223], v[56:59], v[36:39], v[208:223]
    ds_read_b64_tr_b16 v[54:55], v8 offset:33024
    v_fma_f32 v72, v112, s61, v148
    v_fma_f32 v112, v112, s62, v149
    v_exp_f32 v72, v72
    v_mfma_f32_32x32x16_bf16 v[224:239], v[60:63], v[32:35], v[224:239]
    ds_read_b64_tr_b16 v[56:57], v7 offset:33792
    v_exp_f32 v112, v112
    v_fma_f32 v73, v113, s61, v148
    v_fma_f32 v113, v113, s62, v149
    v_mfma_f32_32x32x16_bf16 v[240:255], v[60:63], v[36:39], v[240:255]
    ds_read_b64_tr_b16 v[58:59], v7 offset:34048
    v_exp_f32 v73, v73
    v_exp_f32 v113, v113
    s_waitcnt lgkmcnt(6)
    v_mfma_f32_32x32x16_bf16 v[192:207], v[64:67], v[40:43], v[192:207]
    ds_read_b64_tr_b16 v[60:61], v8 offset:33792
    v_fma_f32 v74, v114, s61, v148
    v_fma_f32 v114, v114, s62, v149
    v_exp_f32 v74, v74
    v_mfma_f32_32x32x16_bf16 v[208:223], v[64:67], v[44:47], v[208:223]
    ds_read_b64_tr_b16 v[62:63], v8 offset:34048
    v_exp_f32 v114, v114
    v_add_f32 v150, v72, v73
    v_add_f32 v151, v112, v113
    v_fma_f32 v75, v115, s61, v148
    v_mfma_f32_32x32x16_bf16 v[224:239], v[68:71], v[40:43], v[224:239]
    ds_read_b64_tr_b16 v[64:65], v7 offset:34816
    v_fma_f32 v115, v115, s62, v149
    v_exp_f32 v75, v75
    v_exp_f32 v115, v115
    v_mfma_f32_32x32x16_bf16 v[240:255], v[68:71], v[44:47], v[240:255]
    ds_read_b64_tr_b16 v[66:67], v7 offset:35072
    v_add_f32 v150, v150, v74
    v_add_f32 v151, v151, v114
    v_fma_f32 v76, v116, s61, v148
    v_fma_f32 v116, v116, s62, v149
    s_waitcnt lgkmcnt(6)
    v_mfma_f32_32x32x16_bf16 v[96:111], v[48:51], a[0:3], 0
    ds_read_b64_tr_b16 v[68:69], v8 offset:34816
    v_exp_f32 v76, v76
    v_exp_f32 v116, v116
    v_add_f32 v150, v150, v75
    v_mfma_f32_32x32x16_bf16 v[128:143], v[48:51], a[4:7], 0
    ds_read_b64_tr_b16 v[70:71], v8 offset:35072
    v_add_f32 v151, v151, v115
    v_fma_f32 v77, v117, s61, v148
    v_fma_f32 v117, v117, s62, v149
    v_exp_f32 v77, v77
    v_mfma_f32_32x32x16_bf16 v[160:175], v[52:55], a[0:3], 0
    ds_read_b64_tr_b16 v[48:49], v7 offset:35840
    v_exp_f32 v117, v117
    v_add_f32 v150, v150, v76
    v_add_f32 v151, v151, v116
    v_fma_f32 v78, v118, s61, v148
    v_mfma_f32_32x32x16_bf16 v[176:191], v[52:55], a[4:7], 0
    ds_read_b64_tr_b16 v[50:51], v7 offset:36096
    v_fma_f32 v118, v118, s62, v149
    v_exp_f32 v78, v78
    s_waitcnt lgkmcnt(6)
    v_mfma_f32_32x32x16_bf16 v[96:111], v[56:59], a[8:11], v[96:111]
    ds_read_b64_tr_b16 v[52:53], v8 offset:35840
    v_exp_f32 v118, v118
    v_add_f32 v150, v150, v77
    v_add_f32 v151, v151, v117
    v_fma_f32 v79, v119, s61, v148
    v_mfma_f32_32x32x16_bf16 v[128:143], v[56:59], a[12:15], v[128:143]
    ds_read_b64_tr_b16 v[54:55], v8 offset:36096
    v_fma_f32 v119, v119, s62, v149
    v_exp_f32 v79, v79
    v_exp_f32 v119, v119
    v_mfma_f32_32x32x16_bf16 v[160:175], v[60:63], a[8:11], v[160:175]
    ds_read_b64_tr_b16 v[56:57], v7 offset:40960
    v_add_f32 v150, v150, v78
    v_add_f32 v151, v151, v118
    v_fma_f32 v80, v120, s61, v148
    v_fma_f32 v120, v120, s62, v149
    v_mfma_f32_32x32x16_bf16 v[176:191], v[60:63], a[12:15], v[176:191]
    ds_read_b64_tr_b16 v[58:59], v7 offset:41216
    v_exp_f32 v80, v80
    v_exp_f32 v120, v120
    s_waitcnt lgkmcnt(6)
    v_mfma_f32_32x32x16_bf16 v[96:111], v[64:67], a[16:19], v[96:111]
    ds_read_b64_tr_b16 v[60:61], v8 offset:40960
    v_add_f32 v150, v150, v79
    v_add_f32 v151, v151, v119
    v_fma_f32 v81, v121, s61, v148
    v_fma_f32 v121, v121, s62, v149
    v_mfma_f32_32x32x16_bf16 v[128:143], v[64:67], a[20:23], v[128:143]
    ds_read_b64_tr_b16 v[62:63], v8 offset:41216
    v_exp_f32 v81, v81
    v_exp_f32 v121, v121
    v_add_f32 v150, v150, v80
    v_mfma_f32_32x32x16_bf16 v[160:175], v[68:71], a[16:19], v[160:175]
    ds_read_b64_tr_b16 v[64:65], v7 offset:41984
    v_add_f32 v151, v151, v120
    v_fma_f32 v82, v122, s61, v148
    v_fma_f32 v122, v122, s62, v149
    v_exp_f32 v82, v82
    v_mfma_f32_32x32x16_bf16 v[176:191], v[68:71], a[20:23], v[176:191]
    ds_read_b64_tr_b16 v[66:67], v7 offset:42240
    v_exp_f32 v122, v122
    v_add_f32 v150, v150, v81
    v_add_f32 v151, v151, v121
    s_waitcnt lgkmcnt(6)
    v_mfma_f32_32x32x16_bf16 v[96:111], v[48:51], a[24:27], v[96:111]
    ds_read_b64_tr_b16 v[68:69], v8 offset:41984
    v_fma_f32 v83, v123, s61, v148
    v_fma_f32 v123, v123, s62, v149
    v_exp_f32 v83, v83
    v_mfma_f32_32x32x16_bf16 v[128:143], v[48:51], a[28:31], v[128:143]
    ds_read_b64_tr_b16 v[70:71], v8 offset:42240
    v_exp_f32 v123, v123
    v_add_f32 v150, v150, v82
    v_add_f32 v151, v151, v122
    v_fma_f32 v84, v124, s61, v148
    v_mfma_f32_32x32x16_bf16 v[160:175], v[52:55], a[24:27], v[160:175]
    ds_read_b64_tr_b16 v[48:49], v7 offset:43008
    v_fma_f32 v124, v124, s62, v149
    v_exp_f32 v84, v84
    v_exp_f32 v124, v124
    v_mfma_f32_32x32x16_bf16 v[176:191], v[52:55], a[28:31], v[176:191]
    ds_read_b64_tr_b16 v[50:51], v7 offset:43264
    v_add_f32 v150, v150, v83
    v_add_f32 v151, v151, v123
    v_fma_f32 v85, v125, s61, v148
    v_fma_f32 v125, v125, s62, v149
    s_waitcnt lgkmcnt(6)
    v_mfma_f32_32x32x16_bf16 v[96:111], v[56:59], a[32:35], v[96:111]
    ds_read_b64_tr_b16 v[52:53], v8 offset:43008
    v_exp_f32 v85, v85
    v_exp_f32 v125, v125
    v_add_f32 v150, v150, v84
    v_mfma_f32_32x32x16_bf16 v[128:143], v[56:59], a[36:39], v[128:143]
    ds_read_b64_tr_b16 v[54:55], v8 offset:43264
    v_add_f32 v151, v151, v124
    v_fma_f32 v86, v126, s61, v148
    v_fma_f32 v126, v126, s62, v149
    v_exp_f32 v86, v86
    v_mfma_f32_32x32x16_bf16 v[160:175], v[60:63], a[32:35], v[160:175]
    ds_read_b64_tr_b16 v[56:57], v7 offset:44032
    v_exp_f32 v126, v126
    v_add_f32 v150, v150, v85
    v_add_f32 v151, v151, v125
    v_fma_f32 v87, v127, s61, v148
    v_mfma_f32_32x32x16_bf16 v[176:191], v[60:63], a[36:39], v[176:191]
    ds_read_b64_tr_b16 v[58:59], v7 offset:44288
    v_fma_f32 v127, v127, s62, v149
    v_exp_f32 v87, v87
    s_waitcnt lgkmcnt(6)
    v_mfma_f32_32x32x16_bf16 v[96:111], v[64:67], a[40:43], v[96:111]
    ds_read_b64_tr_b16 v[60:61], v8 offset:44032
    v_exp_f32 v127, v127
    v_add_f32 v150, v150, v86
    v_add_f32 v151, v151, v126
    v_fma_f32 v88, v144, s61, v148
    v_mfma_f32_32x32x16_bf16 v[128:143], v[64:67], a[44:47], v[128:143]
    ds_read_b64_tr_b16 v[62:63], v8 offset:44288
    v_fma_f32 v144, v144, s62, v149
    v_exp_f32 v88, v88
    v_exp_f32 v144, v144
    v_mfma_f32_32x32x16_bf16 v[160:175], v[68:71], a[40:43], v[160:175]
    s_barrier
    ds_read_b64_tr_b16 v[64:65], v5 offset:40960
    s_add_u32 m0, s27, 24576
    s_add_u32 s34, s32, 589952
    buffer_load_dwordx4 v2, s[8:11], s34 offen lds
    v_mfma_f32_32x32x16_bf16 v[176:191], v[68:71], a[44:47], v[176:191]
    ds_read_b64_tr_b16 v[66:67], v5 offset:41216
    v_add_f32 v150, v150, v87
    v_add_f32 v151, v151, v127
    v_fma_f32 v89, v145, s61, v148
    v_fma_f32 v145, v145, s62, v149
    s_waitcnt lgkmcnt(6)
    v_mfma_f32_32x32x16_bf16 v[96:111], v[48:51], a[48:51], v[96:111]
    ds_read_b64_tr_b16 v[68:69], v6 offset:40960
    s_add_u32 m0, s27, 49088
    s_add_u32 s35, s32, 736384
    buffer_load_dwordx4 v2, s[8:11], s34 offen offset:64 lds
    v_mfma_f32_32x32x16_bf16 v[128:143], v[48:51], a[52:55], v[128:143]
    ds_read_b64_tr_b16 v[70:71], v6 offset:41216
    v_exp_f32 v89, v89
    v_exp_f32 v145, v145
    v_add_f32 v150, v150, v88
    v_mfma_f32_32x32x16_bf16 v[160:175], v[52:55], a[48:51], v[160:175]
    ds_read_b64_tr_b16 v[48:49], v5 offset:41984
    buffer_load_dwordx4 v2, s[8:11], s35 offen offset:1088 lds
    v_add_f32 v151, v151, v144
    v_mov_b32 v90, 0
    v_add_f32 v150, v150, v89
    v_mfma_f32_32x32x16_bf16 v[176:191], v[52:55], a[52:55], v[176:191]
    ds_read_b64_tr_b16 v[50:51], v5 offset:42240
    v_add_f32 v151, v151, v145
    v_rcp_f32 v150, v150
    s_waitcnt lgkmcnt(6)
    v_mfma_f32_32x32x16_bf16 v[96:111], v[56:59], a[56:59], v[96:111]
    ds_read_b64_tr_b16 v[52:53], v6 offset:41984
    s_add_u32 m0, s27, 24576
    s_nop 0
    buffer_load_dwordx4 v2, s[8:11], s35 offen offset:1024 lds
    v_mfma_f32_32x32x16_bf16 v[128:143], v[56:59], a[60:63], v[128:143]
    ds_read_b64_tr_b16 v[54:55], v6 offset:42240
    v_rcp_f32 v151, v151
    v_mov_b32 v91, 0
    v_mul_f32 v72, v72, v150
    v_mul_f32 v73, v73, v150
    v_mfma_f32_32x32x16_bf16 v[160:175], v[60:63], a[56:59], v[160:175]
    ds_read_b64_tr_b16 v[56:57], v5 offset:43008
    s_add_u32 m0, s27, 90112
    s_add_u32 s34, s32, 1179776
    buffer_load_dwordx4 v2, s[8:11], s34 offen lds
    v_cvt_pk_bf16_f32 v72, v72, v73
    v_mfma_f32_32x32x16_bf16 v[176:191], v[60:63], a[60:63], v[176:191]
    ds_read_b64_tr_b16 v[58:59], v5 offset:43264
    v_mul_f32 v74, v74, v150
    v_mul_f32 v75, v75, v150
    v_cvt_pk_bf16_f32 v73, v74, v75
    v_mul_f32 v76, v76, v150
    s_waitcnt lgkmcnt(6)
    v_mfma_f32_32x32x16_bf16 v[96:111], v[64:67], a[64:67], v[96:111]
    ds_read_b64_tr_b16 v[60:61], v6 offset:43008
    s_add_u32 m0, s27, 98240
    s_add_u32 s35, s32, 1326208
    buffer_load_dwordx4 v2, s[8:11], s34 offen offset:64 lds
    v_mul_f32 v77, v77, v150
    v_mfma_f32_32x32x16_bf16 v[128:143], v[64:67], a[68:71], v[128:143]
    ds_read_b64_tr_b16 v[62:63], v6 offset:43264
    v_cvt_pk_bf16_f32 v74, v76, v77
    v_mul_f32 v78, v78, v150
    v_mul_f32 v79, v79, v150
    v_cvt_pk_bf16_f32 v75, v78, v79
    v_mul_f32 v80, v80, v150
    v_mfma_f32_32x32x16_bf16 v[160:175], v[68:71], a[64:67], v[160:175]
    ds_read_b64_tr_b16 v[64:65], v5 offset:44032
    buffer_load_dwordx4 v2, s[8:11], s35 offen offset:1088 lds
    v_mul_f32 v81, v81, v150
    v_cvt_pk_bf16_f32 v76, v80, v81
    v_mul_f32 v82, v82, v150
    v_mfma_f32_32x32x16_bf16 v[176:191], v[68:71], a[68:71], v[176:191]
    ds_read_b64_tr_b16 v[66:67], v5 offset:44288
    v_mul_f32 v83, v83, v150
    v_cvt_pk_bf16_f32 v77, v82, v83
    v_mul_f32 v84, v84, v150
    v_mul_f32 v85, v85, v150
    s_waitcnt lgkmcnt(6)
    v_mfma_f32_32x32x16_bf16 v[96:111], v[48:51], a[72:75], v[96:111]
    ds_read_b64_tr_b16 v[68:69], v6 offset:44032
    s_add_u32 m0, s27, 90112
    s_nop 0
    buffer_load_dwordx4 v2, s[8:11], s35 offen offset:1024 lds
    v_cvt_pk_bf16_f32 v78, v84, v85
    v_mfma_f32_32x32x16_bf16 v[128:143], v[48:51], a[76:79], v[128:143]
    ds_read_b64_tr_b16 v[70:71], v6 offset:44288
    v_mul_f32 v86, v86, v150
    v_mul_f32 v87, v87, v150
    v_cvt_pk_bf16_f32 v79, v86, v87
    v_mul_f32 v88, v88, v150
    v_mul_f32 v89, v89, v150
    v_mfma_f32_32x32x16_bf16 v[160:175], v[52:55], a[72:75], v[160:175]
    ds_read_b64_tr_b16 v[48:49], v5 offset:57344
    v_cvt_pk_bf16_f32 v80, v88, v89
    v_mul_f32 v112, v112, v151
    v_mul_f32 v113, v113, v151
    v_cvt_pk_bf16_f32 v81, v112, v113
    v_mul_f32 v114, v114, v151
    v_mfma_f32_32x32x16_bf16 v[176:191], v[52:55], a[76:79], v[176:191]
    ds_read_b64_tr_b16 v[50:51], v5 offset:57600
    v_mul_f32 v115, v115, v151
    v_cvt_pk_bf16_f32 v82, v114, v115
    v_mul_f32 v116, v116, v151
    v_mul_f32 v117, v117, v151
    s_waitcnt lgkmcnt(6)
    v_mfma_f32_32x32x16_bf16 v[96:111], v[56:59], a[80:83], v[96:111]
    ds_read_b64_tr_b16 v[52:53], v6 offset:57344
    v_cvt_pk_bf16_f32 v83, v116, v117
    v_mul_f32 v118, v118, v151
    v_mul_f32 v119, v119, v151
    v_cvt_pk_bf16_f32 v84, v118, v119
    v_mul_f32 v120, v120, v151
    v_mfma_f32_32x32x16_bf16 v[128:143], v[56:59], a[84:87], v[128:143]
    ds_read_b64_tr_b16 v[54:55], v6 offset:57600
    v_mul_f32 v121, v121, v151
    v_cvt_pk_bf16_f32 v85, v120, v121
    v_mul_f32 v122, v122, v151
    v_mul_f32 v123, v123, v151
    v_cvt_pk_bf16_f32 v86, v122, v123
    v_mfma_f32_32x32x16_bf16 v[160:175], v[60:63], a[80:83], v[160:175]
    ds_read_b64_tr_b16 v[56:57], v5 offset:58368
    v_mul_f32 v124, v124, v151
    v_mul_f32 v125, v125, v151
    v_cvt_pk_bf16_f32 v87, v124, v125
    v_mul_f32 v126, v126, v151
    v_mul_f32 v127, v127, v151
    v_mfma_f32_32x32x16_bf16 v[176:191], v[60:63], a[84:87], v[176:191]
    ds_read_b64_tr_b16 v[58:59], v5 offset:58624
    v_cvt_pk_bf16_f32 v88, v126, v127
    v_mul_f32 v144, v144, v151
    v_mul_f32 v145, v145, v151
    v_cvt_pk_bf16_f32 v89, v144, v145
    s_waitcnt lgkmcnt(6)
    v_mfma_f32_32x32x16_bf16 v[96:111], v[64:67], a[88:91], v[96:111]
    ds_read_b64_tr_b16 v[60:61], v6 offset:58368
    buffer_store_dwordx4 v[72:75], v1, s[4:7], s38 offen offset:1024
    v_mfma_f32_32x32x16_bf16 v[128:143], v[64:67], a[92:95], v[128:143]
    ds_read_b64_tr_b16 v[62:63], v6 offset:58624
    v_mfma_f32_32x32x16_bf16 v[160:175], v[68:71], a[88:91], v[160:175]
    ds_read_b64_tr_b16 v[64:65], v5 offset:59392
    buffer_store_dwordx4 v[76:79], v1, s[4:7], s38 offen offset:2048
    v_mfma_f32_32x32x16_bf16 v[176:191], v[68:71], a[92:95], v[176:191]
    ds_read_b64_tr_b16 v[66:67], v5 offset:59648
    s_waitcnt lgkmcnt(6)
    v_mfma_f32_32x32x16_bf16 v[96:111], v[48:51], a[96:99], v[96:111]
    ds_read_b64_tr_b16 v[68:69], v6 offset:59392
    buffer_store_dwordx4 v[80:83], v1, s[4:7], s38 offen offset:3072
    v_mfma_f32_32x32x16_bf16 v[128:143], v[48:51], a[100:103], v[128:143]
    ds_read_b64_tr_b16 v[70:71], v6 offset:59648
    s_add_u32 s38, s55, 8192
    v_mfma_f32_32x32x16_bf16 v[160:175], v[52:55], a[96:99], v[160:175]
    ds_read_b64_tr_b16 v[48:49], v5 offset:60416
    buffer_store_dwordx4 v[84:87], v1, s[4:7], s38 offen offset:0
    v_mfma_f32_32x32x16_bf16 v[176:191], v[52:55], a[100:103], v[176:191]
    ds_read_b64_tr_b16 v[50:51], v5 offset:60672
    s_waitcnt lgkmcnt(6)
    v_mfma_f32_32x32x16_bf16 v[96:111], v[56:59], a[104:107], v[96:111]
    ds_read_b64_tr_b16 v[52:53], v6 offset:60416
    buffer_store_dwordx4 v[88:91], v1, s[4:7], s38 offen offset:1024
    v_mfma_f32_32x32x16_bf16 v[128:143], v[56:59], a[108:111], v[128:143]
    ds_read_b64_tr_b16 v[54:55], v6 offset:60672
    s_mov_b64 exec, s[68:69]
    ds_write_b128 v11, v[72:75] offset:5120
    ds_write_b128 v11, v[76:79] offset:5136
    ds_write_b128 v11, v[80:83] offset:5152
    ds_write_b128 v11, v[84:87] offset:5168
    ds_write_b64 v11, v[88:89] offset:5184
    s_mov_b64 exec, -1
    v_mfma_f32_32x32x16_bf16 v[160:175], v[60:63], a[104:107], v[160:175]
    ds_read_b64_tr_b16 v[56:57], v7 offset:8192
    ds_read_b64_tr_b16 v[112:113], v12 offset:0
    ds_read_b64_tr_b16 v[114:115], v12 offset:2560
    ds_read_b64_tr_b16 v[84:85], v12 offset:96
    ds_read_b64_tr_b16 v[86:87], v12 offset:2656
    v_mfma_f32_32x32x16_bf16 v[176:191], v[60:63], a[108:111], v[176:191]
    ds_read_b64_tr_b16 v[58:59], v7 offset:8448
    ds_read_b64_tr_b16 v[88:89], v12 offset:128
    ds_read_b64_tr_b16 v[90:91], v12 offset:2688
    ds_read_b64_tr_b16 v[116:117], v12 offset:32
    s_waitcnt lgkmcnt(14)
    v_mfma_f32_32x32x16_bf16 v[96:111], v[64:67], a[112:115], v[96:111]
    ds_read_b64_tr_b16 v[60:61], v8 offset:8192
    ds_read_b64_tr_b16 v[118:119], v12 offset:2592
    ds_read_b64_tr_b16 v[120:121], v12 offset:64
    ds_read_b64_tr_b16 v[122:123], v12 offset:2624
    v_mul_f32 v80, s62, v192
    v_mul_f32 v81, s62, v193
    v_mfma_f32_32x32x16_bf16 v[128:143], v[64:67], a[116:119], v[128:143]
    ds_read_b64_tr_b16 v[62:63], v8 offset:8448
    v_mul_f32 v82, s62, v194
    v_mul_f32 v83, s62, v195
    v_exp_f32 v80, v80
    v_mul_f32 v200, v192, v200
    v_mfma_f32_32x32x16_bf16 v[160:175], v[68:71], a[112:115], v[160:175]
    ds_read_b64_tr_b16 v[64:65], v7 offset:9216
    v_exp_f32 v81, v81
    v_mul_f32 v201, v193, v201
    v_exp_f32 v82, v82
    v_mfma_f32_32x32x16_bf16 v[176:191], v[68:71], a[116:119], v[176:191]
    ds_read_b64_tr_b16 v[66:67], v7 offset:9472
    v_mul_f32 v202, v194, v202
    v_exp_f32 v83, v83
    v_mul_f32 v203, v195, v203
    v_mfma_f32_32x32x16_bf16 v[96:111], v[48:51], a[120:123], v[96:111]
    ds_read_b64_tr_b16 v[68:69], v8 offset:9216
    v_add_f32 v80, 1.0, v80
    v_add_f32 v81, 1.0, v81
    v_add_f32 v82, 1.0, v82
    v_add_f32 v83, 1.0, v83
    v_mfma_f32_32x32x16_bf16 v[128:143], v[48:51], a[124:127], v[128:143]
    ds_read_b64_tr_b16 v[70:71], v8 offset:9472
    v_rcp_f32 v80, v80
    v_rcp_f32 v81, v81
    v_mfma_f32_32x32x16_bf16 v[160:175], v[52:55], a[120:123], v[160:175]
    ds_read_b64_tr_b16 v[48:49], v7 offset:10240
    v_rcp_f32 v82, v82
    v_rcp_f32 v83, v83
    v_mul_f32 v200, v200, v80
    v_mfma_f32_32x32x16_bf16 v[176:191], v[52:55], a[124:127], v[176:191]
    ds_read_b64_tr_b16 v[50:51], v7 offset:10496
    v_mul_f32 v201, v201, v81
    v_mul_f32 v202, v202, v82
    v_mul_f32 v203, v203, v83
    v_cvt_pk_bf16_f32 v76, v200, v201
    s_waitcnt lgkmcnt(6)
    v_mfma_f32_32x32x16_bf16 v[96:111], v[56:59], a[128:131], v[96:111]
    ds_read_b64_tr_b16 v[52:53], v8 offset:10240
    v_cvt_pk_bf16_f32 v77, v202, v203
    v_mfma_f32_16x16x32_bf16 v[144:147], v[112:115], v[84:87], 0
    v_mfma_f32_16x16x32_bf16 v[156:159], v[112:115], v[88:91], 0
    v_mfma_f32_16x16x32_bf16 v[148:151], v[116:119], v[84:87], 0
    v_mfma_f32_16x16x32_bf16 v[124:127], v[116:119], v[88:91], 0
    v_mfma_f32_16x16x32_bf16 v[152:155], v[120:123], v[84:87], 0
    v_mfma_f32_16x16x32_bf16 v[92:95], v[120:123], v[88:91], 0
    ds_read_b64_tr_b16 v[112:113], v12 offset:5120
    ds_read_b64_tr_b16 v[114:115], v12 offset:7680
    v_mfma_f32_32x32x16_bf16 v[128:143], v[56:59], a[132:135], v[128:143]
    ds_read_b64_tr_b16 v[54:55], v8 offset:10496
    ds_read_b64_tr_b16 v[84:85], v12 offset:5216
    ds_read_b64_tr_b16 v[86:87], v12 offset:7776
    ds_read_b64_tr_b16 v[88:89], v12 offset:5248
    ds_read_b64_tr_b16 v[90:91], v12 offset:7808
    v_mfma_f32_32x32x16_bf16 v[160:175], v[60:63], a[128:131], v[160:175]
    ds_read_b64_tr_b16 v[56:57], v7 offset:11264
    ds_read_b64_tr_b16 v[116:117], v12 offset:5152
    ds_read_b64_tr_b16 v[118:119], v12 offset:7712
    ds_read_b64_tr_b16 v[120:121], v12 offset:5184
    ds_read_b64_tr_b16 v[122:123], v12 offset:7744
    v_mfma_f32_32x32x16_bf16 v[176:191], v[60:63], a[132:135], v[176:191]
    ds_read_b64_tr_b16 v[58:59], v7 offset:11520
    v_mul_f32 v80, s62, v196
    v_mul_f32 v81, s62, v197
    v_mul_f32 v82, s62, v198
    v_mul_f32 v83, s62, v199
    s_waitcnt lgkmcnt(14)
    v_mfma_f32_32x32x16_bf16 v[96:111], v[64:67], a[136:139], v[96:111]
    ds_read_b64_tr_b16 v[60:61], v8 offset:11264
    v_exp_f32 v80, v80
    v_mul_f32 v204, v196, v204
    v_exp_f32 v81, v81
    v_mfma_f32_32x32x16_bf16 v[128:143], v[64:67], a[140:143], v[128:143]
    ds_read_b64_tr_b16 v[62:63], v8 offset:11520
    v_mul_f32 v205, v197, v205
    v_exp_f32 v82, v82
    v_mul_f32 v206, v198, v206
    v_mfma_f32_32x32x16_bf16 v[160:175], v[68:71], a[136:139], v[160:175]
    s_barrier
    ds_read_b64_tr_b16 v[64:65], v7 offset:16384
    s_add_u32 m0, s27, 40960
    s_add_u32 s34, s32, 1769600
    buffer_load_dwordx4 v2, s[8:11], s34 offen lds
    v_mfma_f32_32x32x16_bf16 v[176:191], v[68:71], a[140:143], v[176:191]
    ds_read_b64_tr_b16 v[66:67], v7 offset:16640
    v_exp_f32 v83, v83
    v_mul_f32 v207, v199, v207
    v_add_f32 v80, 1.0, v80
    s_waitcnt lgkmcnt(14)
    v_mfma_f32_32x32x16_bf16 v[96:111], v[48:51], a[144:147], v[96:111]
    ds_read_b64_tr_b16 v[68:69], v8 offset:16384
    s_add_u32 m0, s27, 57280
    s_add_u32 s35, s32, 1916032
    buffer_load_dwordx4 v2, s[8:11], s34 offen offset:64 lds
    v_add_f32 v81, 1.0, v81
    v_mfma_f32_32x32x16_bf16 v[128:143], v[48:51], a[148:151], v[128:143]
    ds_read_b64_tr_b16 v[70:71], v8 offset:16640
    v_add_f32 v82, 1.0, v82
    v_add_f32 v83, 1.0, v83
    v_rcp_f32 v80, v80
    v_mfma_f32_32x32x16_bf16 v[160:175], v[52:55], a[144:147], v[160:175]
    ds_read_b64_tr_b16 v[48:49], v7 offset:17408
    buffer_load_dwordx4 v2, s[8:11], s35 offen offset:1088 lds
    v_rcp_f32 v81, v81
    v_mfma_f32_32x32x16_bf16 v[176:191], v[52:55], a[148:151], v[176:191]
    ds_read_b64_tr_b16 v[50:51], v7 offset:17664
    v_rcp_f32 v82, v82
    v_rcp_f32 v83, v83
    s_waitcnt lgkmcnt(6)
    v_mfma_f32_32x32x16_bf16 v[96:111], v[56:59], a[152:155], v[96:111]
    ds_read_b64_tr_b16 v[52:53], v8 offset:17408
    s_add_u32 m0, s27, 40960
    s_nop 0
    buffer_load_dwordx4 v2, s[8:11], s35 offen offset:1024 lds
    v_mul_f32 v204, v204, v80
    v_mfma_f32_32x32x16_bf16 v[128:143], v[56:59], a[156:159], v[128:143]
    ds_read_b64_tr_b16 v[54:55], v8 offset:17664
    v_mul_f32 v205, v205, v81
    v_mul_f32 v206, v206, v82
    v_mul_f32 v207, v207, v83
    v_cvt_pk_bf16_f32 v78, v204, v205
    v_cvt_pk_bf16_f32 v79, v206, v207
    v_mfma_f32_32x32x16_bf16 v[160:175], v[60:63], a[152:155], v[160:175]
    ds_read_b64_tr_b16 v[56:57], v7 offset:18432
    s_add_u32 m0, s27, 106496
    s_add_u32 s34, s32, 2359424
    buffer_load_dwordx4 v2, s[8:11], s34 offen lds
    v_mfma_f32_32x32x16_bf16 v[176:191], v[60:63], a[156:159], v[176:191]
    ds_read_b64_tr_b16 v[58:59], v7 offset:18688
    buffer_store_dwordx4 v[76:79], v3, s[4:7], s43 offen offset:0 sc1
    s_waitcnt lgkmcnt(6)
    v_mfma_f32_32x32x16_bf16 v[96:111], v[64:67], a[160:163], v[96:111]
    ds_read_b64_tr_b16 v[60:61], v8 offset:18432
    v_mfma_f32_16x16x32_bf16 v[144:147], v[112:115], v[84:87], v[144:147]
    v_mfma_f32_16x16x32_bf16 v[156:159], v[112:115], v[88:91], v[156:159]
    v_mfma_f32_16x16x32_bf16 v[148:151], v[116:119], v[84:87], v[148:151]
    v_mfma_f32_16x16x32_bf16 v[124:127], v[116:119], v[88:91], v[124:127]
    v_mfma_f32_16x16x32_bf16 v[152:155], v[120:123], v[84:87], v[152:155]
    v_mfma_f32_16x16x32_bf16 v[92:95], v[120:123], v[88:91], v[92:95]
    v_add_u32 v14, s63, v1
    v_mfma_f32_32x32x16_bf16 v[128:143], v[64:67], a[164:167], v[128:143]
    ds_read_b64_tr_b16 v[62:63], v8 offset:18688
    s_add_u32 m0, s27, 114624
    s_add_u32 s35, s32, 2505856
    buffer_load_dwordx4 v2, s[8:11], s34 offen offset:64 lds
    v_mfma_f32_32x32x16_bf16 v[160:175], v[68:71], a[160:163], v[160:175]
    ds_read_b64_tr_b16 v[64:65], v7 offset:19456
    ds_write_b128 v14, v[144:147] offset:0
    v_mfma_f32_32x32x16_bf16 v[176:191], v[68:71], a[164:167], v[176:191]
    ds_read_b64_tr_b16 v[66:67], v7 offset:19712
    buffer_load_dwordx4 v2, s[8:11], s35 offen offset:1088 lds
    s_waitcnt lgkmcnt(7)
    v_mfma_f32_32x32x16_bf16 v[96:111], v[48:51], a[168:171], v[96:111]
    ds_read_b64_tr_b16 v[68:69], v8 offset:19456
    ds_write_b128 v14, v[148:151] offset:1024
    v_mfma_f32_32x32x16_bf16 v[128:143], v[48:51], a[172:175], v[128:143]
    ds_read_b64_tr_b16 v[70:71], v8 offset:19712
    s_add_u32 m0, s27, 106496
    s_nop 0
    buffer_load_dwordx4 v2, s[8:11], s35 offen offset:1024 lds
    v_mfma_f32_32x32x16_bf16 v[160:175], v[52:55], a[168:171], v[160:175]
    ds_read_b64_tr_b16 v[48:49], v5 offset:16384
    ds_write_b128 v14, v[152:155] offset:2048
    v_mfma_f32_32x32x16_bf16 v[176:191], v[52:55], a[172:175], v[176:191]
    ds_read_b64_tr_b16 v[50:51], v5 offset:16640
    ds_write_b128 v14, v[156:159] offset:3072
    s_waitcnt lgkmcnt(10)
    v_mfma_f32_32x32x16_bf16 v[96:111], v[56:59], a[176:179], v[96:111]
    ds_read_b64_tr_b16 v[52:53], v6 offset:16384
    ds_write_b128 v14, v[124:127] offset:4096
    v_mfma_f32_32x32x16_bf16 v[128:143], v[56:59], a[180:183], v[128:143]
    ds_read_b64_tr_b16 v[54:55], v6 offset:16640
    ds_write_b128 v14, v[92:95] offset:5120
    v_mul_f32 v80, s62, v208
    v_mul_f32 v81, s62, v209
    v_mfma_f32_32x32x16_bf16 v[160:175], v[60:63], a[176:179], v[160:175]
    ds_read_b64_tr_b16 v[56:57], v5 offset:17408
    v_mul_f32 v82, s62, v210
    v_mul_f32 v83, s62, v211
    v_exp_f32 v80, v80
    v_mul_f32 v216, v208, v216
    v_mfma_f32_32x32x16_bf16 v[176:191], v[60:63], a[180:183], v[176:191]
    ds_read_b64_tr_b16 v[58:59], v5 offset:17664
    v_exp_f32 v81, v81
    v_mul_f32 v217, v209, v217
    s_waitcnt lgkmcnt(10)
    v_mfma_f32_32x32x16_bf16 v[96:111], v[64:67], a[184:187], v[96:111]
    ds_read_b64_tr_b16 v[60:61], v6 offset:17408
    v_exp_f32 v82, v82
    v_mul_f32 v218, v210, v218
    v_exp_f32 v83, v83
    v_mfma_f32_32x32x16_bf16 v[128:143], v[64:67], a[188:191], v[128:143]
    ds_read_b64_tr_b16 v[62:63], v6 offset:17664
    v_mul_f32 v219, v211, v219
    v_add_f32 v80, 1.0, v80
    v_add_f32 v81, 1.0, v81
    v_add_f32 v82, 1.0, v82
    v_add_f32 v83, 1.0, v83
    v_mfma_f32_32x32x16_bf16 v[160:175], v[68:71], a[184:187], v[160:175]
    ds_read_b64_tr_b16 v[64:65], v5 offset:18432
    v_rcp_f32 v80, v80
    v_rcp_f32 v81, v81
    v_mfma_f32_32x32x16_bf16 v[176:191], v[68:71], a[188:191], v[176:191]
    ds_read_b64_tr_b16 v[66:67], v5 offset:18688
    v_rcp_f32 v82, v82
    v_rcp_f32 v83, v83
    s_waitcnt lgkmcnt(7)
    v_mfma_f32_32x32x16_bf16 v[96:111], v[48:51], a[192:195], v[96:111]
    ds_read_b64_tr_b16 v[68:69], v6 offset:18432
    v_mul_f32 v216, v216, v80
    v_mul_f32 v217, v217, v81
    v_mul_f32 v218, v218, v82
    v_mul_f32 v219, v219, v83
    v_cvt_pk_bf16_f32 v72, v216, v217
    v_mfma_f32_32x32x16_bf16 v[128:143], v[48:51], a[196:199], v[128:143]
    ds_read_b64_tr_b16 v[70:71], v6 offset:18688
    v_cvt_pk_bf16_f32 v73, v218, v219
    v_mul_f32 v80, s62, v212
    v_mul_f32 v81, s62, v213
    v_mul_f32 v82, s62, v214
    v_mul_f32 v83, s62, v215
    v_mfma_f32_32x32x16_bf16 v[160:175], v[52:55], a[192:195], v[160:175]
    ds_read_b64_tr_b16 v[48:49], v5 offset:19456
    v_exp_f32 v80, v80
    v_mul_f32 v220, v212, v220
    v_exp_f32 v81, v81
    v_mfma_f32_32x32x16_bf16 v[176:191], v[52:55], a[196:199], v[176:191]
    ds_read_b64_tr_b16 v[50:51], v5 offset:19712
    v_mul_f32 v221, v213, v221
    v_exp_f32 v82, v82
    v_mul_f32 v222, v214, v222
    s_waitcnt lgkmcnt(6)
    v_mfma_f32_32x32x16_bf16 v[96:111], v[56:59], a[200:203], v[96:111]
    ds_read_b64_tr_b16 v[52:53], v6 offset:19456
    v_exp_f32 v83, v83
    v_mul_f32 v223, v215, v223
    v_add_f32 v80, 1.0, v80
    v_add_f32 v81, 1.0, v81
    v_mfma_f32_32x32x16_bf16 v[128:143], v[56:59], a[204:207], v[128:143]
    ds_read_b64_tr_b16 v[54:55], v6 offset:19712
    v_add_f32 v82, 1.0, v82
    v_add_f32 v83, 1.0, v83
    v_rcp_f32 v80, v80
    v_mfma_f32_32x32x16_bf16 v[160:175], v[60:63], a[200:203], v[160:175]
    ds_read_b64_tr_b16 v[56:57], v5 offset:32768
    v_rcp_f32 v81, v81
    v_rcp_f32 v82, v82
    v_mfma_f32_32x32x16_bf16 v[176:191], v[60:63], a[204:207], v[176:191]
    ds_read_b64_tr_b16 v[58:59], v5 offset:33024
    v_rcp_f32 v83, v83
    v_mul_f32 v220, v220, v80
    v_mul_f32 v221, v221, v81
    s_waitcnt lgkmcnt(6)
    v_mfma_f32_32x32x16_bf16 v[96:111], v[64:67], a[208:211], v[96:111]
    ds_read_b64_tr_b16 v[60:61], v6 offset:32768
    v_mul_f32 v222, v222, v82
    v_mul_f32 v223, v223, v83
    v_cvt_pk_bf16_f32 v74, v220, v221
    v_cvt_pk_bf16_f32 v75, v222, v223
    v_mfma_f32_32x32x16_bf16 v[128:143], v[64:67], a[212:215], v[128:143]
    ds_read_b64_tr_b16 v[62:63], v6 offset:33024
    buffer_store_dwordx4 v[72:75], v3, s[4:7], s44 offen offset:0 sc1
    v_mfma_f32_32x32x16_bf16 v[160:175], v[68:71], a[208:211], v[160:175]
    ds_read_b64_tr_b16 v[64:65], v5 offset:33792
    v_add_u32 v14, s64, v1
    s_barrier
    ds_read_b128 v[112:115], v14 offset:0
    ds_read_b128 v[116:119], v14 offset:10240
    v_mfma_f32_32x32x16_bf16 v[176:191], v[68:71], a[212:215], v[176:191]
    ds_read_b64_tr_b16 v[66:67], v5 offset:34048
    ds_read_b128 v[120:123], v14 offset:20480
    ds_read_b128 v[124:127], v14 offset:30720
    ds_read_b128 v[144:147], v14 offset:3072
    s_waitcnt lgkmcnt(11)
    v_mfma_f32_32x32x16_bf16 v[96:111], v[48:51], a[216:219], v[96:111]
    ds_read_b64_tr_b16 v[68:69], v6 offset:33792
    ds_read_b128 v[148:151], v14 offset:13312
    ds_read_b128 v[152:155], v14 offset:23552
    ds_read_b128 v[156:159], v14 offset:33792
    v_mfma_f32_32x32x16_bf16 v[128:143], v[48:51], a[220:223], v[128:143]
    ds_read_b64_tr_b16 v[70:71], v6 offset:34048
    v_mfma_f32_32x32x16_bf16 v[160:175], v[52:55], a[216:219], v[160:175]
    ds_read_b64_tr_b16 v[48:49], v5 offset:34816
    v_mfma_f32_32x32x16_bf16 v[176:191], v[52:55], a[220:223], v[176:191]
    ds_read_b64_tr_b16 v[50:51], v5 offset:35072
    s_waitcnt lgkmcnt(11)
    v_add_f32 v112, v112, v116
    s_waitcnt lgkmcnt(8)
    v_add_f32 v120, v120, v124
    v_add_f32 v113, v113, v117
    v_add_f32 v121, v121, v125
    v_mfma_f32_32x32x16_bf16 v[96:111], v[56:59], a[224:227], v[96:111]
    ds_read_b64_tr_b16 v[52:53], v6 offset:34816
    v_add_f32 v114, v114, v118
    v_add_f32 v122, v122, v126
    v_add_f32 v115, v115, v119
    v_add_f32 v123, v123, v127
    v_add_f32 v112, v112, v120
    v_mfma_f32_32x32x16_bf16 v[128:143], v[56:59], a[228:231], v[128:143]
    ds_read_b64_tr_b16 v[54:55], v6 offset:35072
    v_add_f32 v113, v113, v121
    v_add_f32 v114, v114, v122
    v_add_f32 v115, v115, v123
    v_mfma_f32_32x32x16_bf16 v[160:175], v[60:63], a[224:227], v[160:175]
    ds_read_b64_tr_b16 v[56:57], v5 offset:35840
    buffer_store_dwordx4 v[112:115], v1, s[4:7], s56 offen offset:0 sc1
    v_mfma_f32_32x32x16_bf16 v[176:191], v[60:63], a[228:231], v[176:191]
    ds_read_b64_tr_b16 v[58:59], v5 offset:36096
    s_waitcnt lgkmcnt(9)
    v_add_f32 v144, v144, v148
    s_waitcnt lgkmcnt(7)
    v_add_f32 v152, v152, v156
    v_add_f32 v145, v145, v149
    v_add_f32 v153, v153, v157
    s_waitcnt lgkmcnt(6)
    v_mfma_f32_32x32x16_bf16 v[96:111], v[64:67], a[232:235], v[96:111]
    ds_read_b64_tr_b16 v[60:61], v6 offset:35840
    v_add_f32 v146, v146, v150
    v_add_f32 v154, v154, v158
    v_add_f32 v147, v147, v151
    v_add_f32 v155, v155, v159
    v_add_f32 v144, v144, v152
    v_mfma_f32_32x32x16_bf16 v[128:143], v[64:67], a[236:239], v[128:143]
    ds_read_b64_tr_b16 v[62:63], v6 offset:36096
    v_add_f32 v145, v145, v153
    v_add_f32 v146, v146, v154
    v_add_f32 v147, v147, v155
    buffer_store_dwordx4 v[144:147], v1, s[4:7], s56 offen offset:3072 sc1
    v_mfma_f32_32x32x16_bf16 v[160:175], v[68:71], a[232:235], v[160:175]
    s_waitcnt vmcnt(21)
    s_barrier
    ds_read_b64_tr_b16 v[64:65], v7 offset:0
    s_add_u32 m0, s27, 147456
    s_add_u32 s34, s32, 2949248
    buffer_load_dwordx4 v2, s[8:11], s34 offen lds
    v_mfma_f32_32x32x16_bf16 v[176:191], v[68:71], a[236:239], v[176:191]
    ds_read_b64_tr_b16 v[66:67], v7 offset:256
    v_mul_f32 v80, s62, v224
    v_mul_f32 v81, s62, v225
    v_mul_f32 v82, s62, v226
    v_mul_f32 v83, s62, v227
    s_waitcnt lgkmcnt(6)
    v_mfma_f32_32x32x16_bf16 v[96:111], v[48:51], a[240:243], v[96:111]
    ds_read_b64_tr_b16 v[68:69], v8 offset:0
    s_add_u32 m0, s27, 155584
    s_add_u32 s35, s32, 3095680
    buffer_load_dwordx4 v2, s[8:11], s34 offen offset:64 lds
    v_mfma_f32_32x32x16_bf16 v[128:143], v[48:51], a[244:247], v[128:143]
    ds_read_b64_tr_b16 v[70:71], v8 offset:256
    v_exp_f32 v80, v80
    v_mul_f32 v232, v224, v232
    v_exp_f32 v81, v81
    v_mfma_f32_32x32x16_bf16 v[160:175], v[52:55], a[240:243], v[160:175]
    ds_read_b64_tr_b16 v[48:49], v7 offset:1024
    buffer_load_dwordx4 v2, s[8:11], s35 offen offset:1088 lds
    v_mul_f32 v233, v225, v233
    v_exp_f32 v82, v82
    v_mfma_f32_32x32x16_bf16 v[176:191], v[52:55], a[244:247], v[176:191]
    ds_read_b64_tr_b16 v[50:51], v7 offset:1280
    v_mul_f32 v234, v226, v234
    v_exp_f32 v83, v83
    v_mul_f32 v235, v227, v235
    s_waitcnt lgkmcnt(6)
    v_mfma_f32_32x32x16_bf16 v[96:111], v[56:59], a[248:251], v[96:111]
    ds_read_b64_tr_b16 v[52:53], v8 offset:1024
    s_add_u32 m0, s27, 147456
    s_nop 0
    buffer_load_dwordx4 v2, s[8:11], s35 offen offset:1024 lds
    v_add_f32 v80, 1.0, v80
    v_mfma_f32_32x32x16_bf16 v[128:143], v[56:59], a[252:255], v[128:143]
    ds_read_b64_tr_b16 v[54:55], v8 offset:1280
    v_add_f32 v81, 1.0, v81
    v_add_f32 v82, 1.0, v82
    v_add_f32 v83, 1.0, v83
    v_rcp_f32 v80, v80
    v_mfma_f32_32x32x16_bf16 v[160:175], v[60:63], a[248:251], v[160:175]
    ds_read_b64_tr_b16 v[56:57], v7 offset:2048
    s_add_u32 m0, s27, 16384
    s_add_u32 s34, s32, 3539072
    buffer_load_dwordx4 v2, s[8:11], s34 offen lds
    v_mfma_f32_32x32x16_bf16 v[176:191], v[60:63], a[252:255], v[176:191]
    ds_read_b64_tr_b16 v[58:59], v7 offset:2304
    v_rcp_f32 v81, v81
    v_rcp_f32 v82, v82
    s_waitcnt lgkmcnt(6)
    v_mfma_f32_32x32x16_bf16 v[96:111], v[64:67], v[16:19], v[96:111]
    ds_read_b64_tr_b16 v[60:61], v8 offset:2048
    s_add_u32 m0, s27, 73664
    s_add_u32 s35, s32, 3685504
    buffer_load_dwordx4 v2, s[8:11], s34 offen offset:64 lds
    v_mfma_f32_32x32x16_bf16 v[128:143], v[64:67], v[20:23], v[128:143]
    ds_read_b64_tr_b16 v[62:63], v8 offset:2304
    v_rcp_f32 v83, v83
    v_mul_f32 v232, v232, v80
    v_mul_f32 v233, v233, v81
    v_mul_f32 v234, v234, v82
    v_mfma_f32_32x32x16_bf16 v[160:175], v[68:71], v[16:19], v[160:175]
    ds_read_b64_tr_b16 v[64:65], v7 offset:3072
    buffer_load_dwordx4 v2, s[8:11], s35 offen offset:1088 lds
    v_mul_f32 v235, v235, v83
    v_cvt_pk_bf16_f32 v76, v232, v233
    v_cvt_pk_bf16_f32 v77, v234, v235
    v_mfma_f32_32x32x16_bf16 v[176:191], v[68:71], v[20:23], v[176:191]
    ds_read_b64_tr_b16 v[66:67], v7 offset:3328
    v_mul_f32 v80, s62, v228
    v_mul_f32 v81, s62, v229
    v_mul_f32 v82, s62, v230
    v_mul_f32 v83, s62, v231
    s_waitcnt lgkmcnt(6)
    v_mfma_f32_32x32x16_bf16 v[96:111], v[48:51], v[24:27], v[96:111]
    ds_read_b64_tr_b16 v[68:69], v8 offset:3072
    s_add_u32 m0, s27, 16384
    s_nop 0
    buffer_load_dwordx4 v2, s[8:11], s35 offen offset:1024 lds
    v_mfma_f32_32x32x16_bf16 v[128:143], v[48:51], v[28:31], v[128:143]
    ds_read_b64_tr_b16 v[70:71], v8 offset:3328
    v_exp_f32 v80, v80
    v_mul_f32 v236, v228, v236
    v_exp_f32 v81, v81
    v_mfma_f32_32x32x16_bf16 v[160:175], v[52:55], v[24:27], v[160:175]
    ds_read_b64_tr_b16 v[48:49], v5 offset:0
    v_mul_f32 v237, v229, v237
    v_exp_f32 v82, v82
    v_mul_f32 v238, v230, v238
    v_mfma_f32_32x32x16_bf16 v[176:191], v[52:55], v[28:31], v[176:191]
    ds_read_b64_tr_b16 v[50:51], v5 offset:256
    v_exp_f32 v83, v83
    v_mul_f32 v239, v231, v239
    v_add_f32 v80, 1.0, v80
    s_waitcnt lgkmcnt(6)
    v_mfma_f32_32x32x16_bf16 v[96:111], v[56:59], v[32:35], v[96:111]
    ds_read_b64_tr_b16 v[52:53], v6 offset:0
    v_add_f32 v81, 1.0, v81
    v_add_f32 v82, 1.0, v82
    v_add_f32 v83, 1.0, v83
    v_rcp_f32 v80, v80
    v_mfma_f32_32x32x16_bf16 v[128:143], v[56:59], v[36:39], v[128:143]
    ds_read_b64_tr_b16 v[54:55], v6 offset:256
    v_rcp_f32 v81, v81
    v_rcp_f32 v82, v82
    v_mfma_f32_32x32x16_bf16 v[160:175], v[60:63], v[32:35], v[160:175]
    ds_read_b64_tr_b16 v[56:57], v5 offset:1024
    v_rcp_f32 v83, v83
    v_mul_f32 v236, v236, v80
    v_mul_f32 v237, v237, v81
    v_mul_f32 v238, v238, v82
    v_mfma_f32_32x32x16_bf16 v[176:191], v[60:63], v[36:39], v[176:191]
    ds_read_b64_tr_b16 v[58:59], v5 offset:1280
    v_mul_f32 v239, v239, v83
    v_cvt_pk_bf16_f32 v78, v236, v237
    v_cvt_pk_bf16_f32 v79, v238, v239
    s_waitcnt lgkmcnt(6)
    v_mfma_f32_32x32x16_bf16 v[96:111], v[64:67], v[40:43], v[96:111]
    ds_read_b64_tr_b16 v[60:61], v6 offset:1024
    buffer_store_dwordx4 v[76:79], v3, s[4:7], s43 offen offset:512 sc1
    v_mfma_f32_32x32x16_bf16 v[128:143], v[64:67], v[44:47], v[128:143]
    ds_read_b64_tr_b16 v[62:63], v6 offset:1280
    v_mul_f32 v80, s62, v240
    v_mul_f32 v81, s62, v241
    v_mul_f32 v82, s62, v242
    v_mul_f32 v83, s62, v243
    v_mfma_f32_32x32x16_bf16 v[160:175], v[68:71], v[40:43], v[160:175]
    ds_read_b64_tr_b16 v[64:65], v5 offset:2048
    v_exp_f32 v80, v80
    v_mul_f32 v248, v240, v248
    v_exp_f32 v81, v81
    v_mfma_f32_32x32x16_bf16 v[176:191], v[68:71], v[44:47], v[176:191]
    ds_read_b64_tr_b16 v[66:67], v5 offset:2304
    v_mul_f32 v249, v241, v249
    v_exp_f32 v82, v82
    v_mul_f32 v250, v242, v250
    v_exp_f32 v83, v83
    v_mul_f32 v251, v243, v251
    v_add_f32 v80, 1.0, v80
    v_add_f32 v81, 1.0, v81
    v_add_f32 v82, 1.0, v82
    v_add_f32 v83, 1.0, v83
    v_rcp_f32 v80, v80
    v_rcp_f32 v81, v81
    v_rcp_f32 v82, v82
    v_rcp_f32 v83, v83
    v_mul_f32 v248, v248, v80
    v_mul_f32 v249, v249, v81
    v_mul_f32 v250, v250, v82
    v_mul_f32 v251, v251, v83
    v_cvt_pk_bf16_f32 v72, v248, v249
    v_cvt_pk_bf16_f32 v73, v250, v251
    v_mul_f32 v80, s62, v244
    v_mul_f32 v81, s62, v245
    v_mul_f32 v82, s62, v246
    v_mul_f32 v83, s62, v247
    v_exp_f32 v80, v80
    v_mul_f32 v252, v244, v252
    v_exp_f32 v81, v81
    v_mul_f32 v253, v245, v253
    v_exp_f32 v82, v82
    v_mul_f32 v254, v246, v254
    v_exp_f32 v83, v83
    v_mul_f32 v255, v247, v255
    v_add_f32 v80, 1.0, v80
    v_add_f32 v81, 1.0, v81
    v_add_f32 v82, 1.0, v82
    v_add_f32 v83, 1.0, v83
    v_rcp_f32 v80, v80
    v_rcp_f32 v81, v81
    v_rcp_f32 v82, v82
    v_rcp_f32 v83, v83
    v_mul_f32 v252, v252, v80
    v_mul_f32 v253, v253, v81
    v_mul_f32 v254, v254, v82
    v_mul_f32 v255, v255, v83
    v_cvt_pk_bf16_f32 v74, v252, v253
    v_cvt_pk_bf16_f32 v75, v254, v255
    buffer_store_dwordx4 v[72:75], v3, s[4:7], s44 offen offset:512 sc1
    s_waitcnt lgkmcnt(6)
    v_mfma_f32_32x32x16_bf16 v[192:207], v[48:51], a[0:3], 0
    ds_read_b64_tr_b16 v[68:69], v6 offset:2048
    v_mov_b32 v84, -1
    v_mov_b32 v85, -1
    v_mov_b32 v86, -1
    v_mov_b32 v87, -1
    v_mov_b32 v15, s67
    v_mfma_f32_32x32x16_bf16 v[208:223], v[48:51], a[4:7], 0
    ds_read_b64_tr_b16 v[70:71], v6 offset:2304
    v_add_u32 v15, 1, v15
    v_mfma_f32_32x32x16_bf16 v[224:239], v[52:55], a[0:3], 0
    ds_read_b64_tr_b16 v[48:49], v5 offset:3072
    s_waitcnt vmcnt(10)
    s_mov_b64 exec, 1
    buffer_store_dword v15, off, s[4:7], s59 sc1
    s_mov_b64 exec, -1
    v_mfma_f32_32x32x16_bf16 v[240:255], v[52:55], a[4:7], 0
    ds_read_b64_tr_b16 v[50:51], v5 offset:3328
    v_mul_f32 v80, s62, v160
    v_mul_f32 v81, s62, v161
    v_mul_f32 v82, s62, v162
    v_mul_f32 v83, s62, v163
    s_waitcnt lgkmcnt(6)
    v_mfma_f32_32x32x16_bf16 v[192:207], v[56:59], a[8:11], v[192:207]
    ds_read_b64_tr_b16 v[52:53], v6 offset:3072
    v_exp_f32 v80, v80
    v_mul_f32 v168, v160, v168
    v_exp_f32 v81, v81
    v_mfma_f32_32x32x16_bf16 v[208:223], v[56:59], a[12:15], v[208:223]
    ds_read_b64_tr_b16 v[54:55], v6 offset:3328
    v_mul_f32 v169, v161, v169
    v_exp_f32 v82, v82
    v_mul_f32 v170, v162, v170
    v_mfma_f32_32x32x16_bf16 v[224:239], v[60:63], a[8:11], v[224:239]
    ds_read_b64_tr_b16 v[56:57], v5 offset:24576
    v_exp_f32 v83, v83
    v_mul_f32 v171, v163, v171
    v_add_f32 v80, 1.0, v80
    v_add_f32 v81, 1.0, v81
    v_mfma_f32_32x32x16_bf16 v[240:255], v[60:63], a[12:15], v[240:255]
    ds_read_b64_tr_b16 v[58:59], v5 offset:24832
    v_add_f32 v82, 1.0, v82
    v_add_f32 v83, 1.0, v83
    v_rcp_f32 v80, v80
    s_waitcnt lgkmcnt(6)
    v_mfma_f32_32x32x16_bf16 v[192:207], v[64:67], a[16:19], v[192:207]
    ds_read_b64_tr_b16 v[60:61], v6 offset:24576
    v_rcp_f32 v81, v81
    v_rcp_f32 v82, v82
    v_mfma_f32_32x32x16_bf16 v[208:223], v[64:67], a[20:23], v[208:223]
    ds_read_b64_tr_b16 v[62:63], v6 offset:24832
    v_rcp_f32 v83, v83
    v_mul_f32 v168, v168, v80
    v_mul_f32 v169, v169, v81
    v_mul_f32 v170, v170, v82
    v_mfma_f32_32x32x16_bf16 v[224:239], v[68:71], a[16:19], v[224:239]
    ds_read_b64_tr_b16 v[64:65], v5 offset:25600
    v_mul_f32 v171, v171, v83
    v_cvt_pk_bf16_f32 v76, v168, v169
    v_cvt_pk_bf16_f32 v77, v170, v171
    v_mul_f32 v80, s62, v164
    v_mul_f32 v81, s62, v165
    v_mfma_f32_32x32x16_bf16 v[240:255], v[68:71], a[20:23], v[240:255]
    ds_read_b64_tr_b16 v[66:67], v5 offset:25856
    v_mul_f32 v82, s62, v166
    v_mul_f32 v83, s62, v167
    v_exp_f32 v80, v80
    s_waitcnt lgkmcnt(6)
    v_mfma_f32_32x32x16_bf16 v[192:207], v[48:51], a[24:27], v[192:207]
    ds_read_b64_tr_b16 v[68:69], v6 offset:25600
    v_mul_f32 v172, v164, v172
    v_exp_f32 v81, v81
    v_mul_f32 v173, v165, v173
    v_mfma_f32_32x32x16_bf16 v[208:223], v[48:51], a[28:31], v[208:223]
    ds_read_b64_tr_b16 v[70:71], v6 offset:25856
    v_exp_f32 v82, v82
    v_mul_f32 v174, v166, v174
    v_exp_f32 v83, v83
    v_mfma_f32_32x32x16_bf16 v[224:239], v[52:55], a[24:27], v[224:239]
    ds_read_b64_tr_b16 v[48:49], v5 offset:26624
    v_mul_f32 v175, v167, v175
    v_add_f32 v80, 1.0, v80
    v_add_f32 v81, 1.0, v81
    v_add_f32 v82, 1.0, v82
    v_add_f32 v83, 1.0, v83
    v_mfma_f32_32x32x16_bf16 v[240:255], v[52:55], a[28:31], v[240:255]
    ds_read_b64_tr_b16 v[50:51], v5 offset:26880
    v_rcp_f32 v80, v80
    v_rcp_f32 v81, v81
    s_waitcnt lgkmcnt(6)
    v_mfma_f32_32x32x16_bf16 v[192:207], v[56:59], a[32:35], v[192:207]
    ds_read_b64_tr_b16 v[52:53], v6 offset:26624
    v_rcp_f32 v82, v82
    v_rcp_f32 v83, v83
    v_mul_f32 v172, v172, v80
    v_mfma_f32_32x32x16_bf16 v[208:223], v[56:59], a[36:39], v[208:223]
    ds_read_b64_tr_b16 v[54:55], v6 offset:26880
    v_mul_f32 v173, v173, v81
    v_mul_f32 v174, v174, v82
    v_mul_f32 v175, v175, v83
    v_cvt_pk_bf16_f32 v78, v172, v173
    v_cvt_pk_bf16_f32 v79, v174, v175
    v_mfma_f32_32x32x16_bf16 v[224:239], v[60:63], a[32:35], v[224:239]
    ds_read_b64_tr_b16 v[56:57], v5 offset:27648
    buffer_store_dwordx4 v[76:79], v3, s[4:7], s45 offen offset:512 sc1
    v_mfma_f32_32x32x16_bf16 v[240:255], v[60:63], a[36:39], v[240:255]
    ds_read_b64_tr_b16 v[58:59], v5 offset:27904
    v_add_u32 v11, 0x10000, v1
    v_add_u32 v12, 0x20000, v1
    s_waitcnt lgkmcnt(6)
    v_mfma_f32_32x32x16_bf16 v[192:207], v[64:67], a[40:43], v[192:207]
    ds_read_b64_tr_b16 v[60:61], v6 offset:27648
    v_mfma_f32_32x32x16_bf16 v[208:223], v[64:67], a[44:47], v[208:223]
    ds_read_b64_tr_b16 v[62:63], v6 offset:27904
    v_mfma_f32_32x32x16_bf16 v[224:239], v[68:71], a[40:43], v[224:239]
    s_barrier
    ds_read_b64_tr_b16 v[64:65], v7 offset:24576
    s_add_u32 m0, s27, 0
    s_add_u32 s34, s32, 4128896
    buffer_load_dwordx4 v2, s[8:11], s34 offen lds
    v_mfma_f32_32x32x16_bf16 v[240:255], v[68:71], a[44:47], v[240:255]
    ds_read_b64_tr_b16 v[66:67], v7 offset:24832
    s_waitcnt lgkmcnt(6)
    v_mfma_f32_32x32x16_bf16 v[192:207], v[48:51], a[48:51], v[192:207]
    ds_read_b64_tr_b16 v[68:69], v8 offset:24576
    s_add_u32 m0, s27, 32704
    s_add_u32 s35, s32, 4275328
    buffer_load_dwordx4 v2, s[8:11], s34 offen offset:64 lds
    v_mov_b32 v15, s67
    v_mfma_f32_32x32x16_bf16 v[208:223], v[48:51], a[52:55], v[208:223]
    ds_read_b64_tr_b16 v[70:71], v8 offset:24832
    v_add_u32 v15, 3, v15
    v_mfma_f32_32x32x16_bf16 v[224:239], v[52:55], a[48:51], v[224:239]
    ds_read_b64_tr_b16 v[48:49], v7 offset:25600
    buffer_load_dwordx4 v2, s[8:11], s35 offen offset:1088 lds
    v_mfma_f32_32x32x16_bf16 v[240:255], v[52:55], a[52:55], v[240:255]
    ds_read_b64_tr_b16 v[50:51], v7 offset:25856
    s_waitcnt vmcnt(5)
    s_mov_b64 exec, 1
    buffer_store_dword v15, off, s[4:7], s60 sc1
    s_mov_b64 exec, -1
    s_waitcnt lgkmcnt(6)
    v_mfma_f32_32x32x16_bf16 v[192:207], v[56:59], a[56:59], v[192:207]
    ds_read_b64_tr_b16 v[52:53], v8 offset:25600
    v_mfma_f32_32x32x16_bf16 v[208:223], v[56:59], a[60:63], v[208:223]
    ds_read_b64_tr_b16 v[54:55], v8 offset:25856
    s_add_u32 m0, s27, 0
    s_nop 0
    buffer_load_dwordx4 v2, s[8:11], s35 offen offset:1024 lds
    v_mfma_f32_32x32x16_bf16 v[224:239], v[60:63], a[56:59], v[224:239]
    ds_read_b64_tr_b16 v[56:57], v7 offset:26624
    v_lshlrev_b32 v15, 5, v0
    s_mov_b64 exec, s[70:71]
    buffer_load_dword v15, v15, s[4:7], s58 offen sc1
    s_mov_b64 exec, -1
    v_mfma_f32_32x32x16_bf16 v[240:255], v[60:63], a[60:63], v[240:255]
    ds_read_b64_tr_b16 v[58:59], v7 offset:26880
    v_mul_f32 v80, s62, v176
    v_mul_f32 v81, s62, v177
    v_mul_f32 v82, s62, v178
    v_mul_f32 v83, s62, v179
    s_waitcnt lgkmcnt(6)
    v_mfma_f32_32x32x16_bf16 v[192:207], v[64:67], a[64:67], v[192:207]
    ds_read_b64_tr_b16 v[60:61], v8 offset:26624
    s_add_u32 m0, s27, 65536
    s_add_u32 s34, s32, 4718720
    buffer_load_dwordx4 v2, s[8:11], s34 offen lds
    v_mfma_f32_32x32x16_bf16 v[208:223], v[64:67], a[68:71], v[208:223]
    ds_read_b64_tr_b16 v[62:63], v8 offset:26880
    v_exp_f32 v80, v80
    v_mul_f32 v184, v176, v184
    v_exp_f32 v81, v81
    v_mfma_f32_32x32x16_bf16 v[224:239], v[68:71], a[64:67], v[224:239]
    ds_read_b64_tr_b16 v[64:65], v7 offset:27648
    s_add_u32 m0, s27, 81856
    s_add_u32 s35, s32, 4865152
    buffer_load_dwordx4 v2, s[8:11], s34 offen offset:64 lds
    v_mul_f32 v185, v177, v185
    v_mfma_f32_32x32x16_bf16 v[240:255], v[68:71], a[68:71], v[240:255]
    ds_read_b64_tr_b16 v[66:67], v7 offset:27904
    v_exp_f32 v82, v82
    v_mul_f32 v186, v178, v186
    s_waitcnt lgkmcnt(6)
    v_mfma_f32_32x32x16_bf16 v[192:207], v[48:51], a[72:75], v[192:207]
    ds_read_b64_tr_b16 v[68:69], v8 offset:27648
    buffer_load_dwordx4 v2, s[8:11], s35 offen offset:1088 lds
    v_exp_f32 v83, v83
    v_mul_f32 v187, v179, v187
    v_mfma_f32_32x32x16_bf16 v[208:223], v[48:51], a[76:79], v[208:223]
    ds_read_b64_tr_b16 v[70:71], v8 offset:27904
    v_add_f32 v80, 1.0, v80
    v_add_f32 v81, 1.0, v81
    v_add_f32 v82, 1.0, v82
    v_add_f32 v83, 1.0, v83
    v_mfma_f32_32x32x16_bf16 v[224:239], v[52:55], a[72:75], v[224:239]
    ds_read_b64_tr_b16 v[48:49], v5 offset:40960
    s_add_u32 m0, s27, 65536
    s_nop 0
    buffer_load_dwordx4 v2, s[8:11], s35 offen offset:1024 lds
    v_mfma_f32_32x32x16_bf16 v[240:255], v[52:55], a[76:79], v[240:255]
    ds_read_b64_tr_b16 v[50:51], v5 offset:41216
    v_rcp_f32 v80, v80
    v_rcp_f32 v81, v81
    s_waitcnt lgkmcnt(6)
    v_mfma_f32_32x32x16_bf16 v[192:207], v[56:59], a[80:83], v[192:207]
    ds_read_b64_tr_b16 v[52:53], v6 offset:40960
    v_rcp_f32 v82, v82
    v_rcp_f32 v83, v83
    v_mul_f32 v184, v184, v80
    v_mfma_f32_32x32x16_bf16 v[208:223], v[56:59], a[84:87], v[208:223]
    ds_read_b64_tr_b16 v[54:55], v6 offset:41216
    v_mul_f32 v185, v185, v81
    v_mul_f32 v186, v186, v82
    v_mul_f32 v187, v187, v83
    v_cvt_pk_bf16_f32 v72, v184, v185
    v_cvt_pk_bf16_f32 v73, v186, v187
    v_mfma_f32_32x32x16_bf16 v[224:239], v[60:63], a[80:83], v[224:239]
    ds_read_b64_tr_b16 v[56:57], v5 offset:41984
    v_mul_f32 v80, s62, v180
    v_mul_f32 v81, s62, v181
    v_mul_f32 v82, s62, v182
    v_mul_f32 v83, s62, v183
    v_mfma_f32_32x32x16_bf16 v[240:255], v[60:63], a[84:87], v[240:255]
    ds_read_b64_tr_b16 v[58:59], v5 offset:42240
    v_exp_f32 v80, v80
    v_mul_f32 v188, v180, v188
    s_waitcnt lgkmcnt(6)
    v_mfma_f32_32x32x16_bf16 v[192:207], v[64:67], a[88:91], v[192:207]
    ds_read_b64_tr_b16 v[60:61], v6 offset:41984
    v_exp_f32 v81, v81
    v_mul_f32 v189, v181, v189
    v_exp_f32 v82, v82
    v_mfma_f32_32x32x16_bf16 v[208:223], v[64:67], a[92:95], v[208:223]
    ds_read_b64_tr_b16 v[62:63], v6 offset:42240
    v_mul_f32 v190, v182, v190
    v_exp_f32 v83, v83
    v_mul_f32 v191, v183, v191
    v_add_f32 v80, 1.0, v80
    v_mfma_f32_32x32x16_bf16 v[224:239], v[68:71], a[88:91], v[224:239]
    ds_read_b64_tr_b16 v[64:65], v5 offset:43008
    v_add_f32 v81, 1.0, v81
    v_add_f32 v82, 1.0, v82
    v_add_f32 v83, 1.0, v83
    v_rcp_f32 v80, v80
    v_mfma_f32_32x32x16_bf16 v[240:255], v[68:71], a[92:95], v[240:255]
    ds_read_b64_tr_b16 v[66:67], v5 offset:43264
    v_rcp_f32 v81, v81
    v_rcp_f32 v82, v82
    s_waitcnt lgkmcnt(6)
    v_mfma_f32_32x32x16_bf16 v[192:207], v[48:51], a[96:99], v[192:207]
    ds_read_b64_tr_b16 v[68:69], v6 offset:43008
    v_rcp_f32 v83, v83
    v_mul_f32 v188, v188, v80
    v_mul_f32 v189, v189, v81
    v_mul_f32 v190, v190, v82
    v_mfma_f32_32x32x16_bf16 v[208:223], v[48:51], a[100:103], v[208:223]
    ds_read_b64_tr_b16 v[70:71], v6 offset:43264
    v_mul_f32 v191, v191, v83
    v_cvt_pk_bf16_f32 v74, v188, v189
    v_cvt_pk_bf16_f32 v75, v190, v191
    v_mfma_f32_32x32x16_bf16 v[224:239], v[52:55], a[96:99], v[224:239]
    ds_read_b64_tr_b16 v[48:49], v5 offset:44032
    buffer_store_dwordx4 v[72:75], v3, s[4:7], s46 offen offset:512 sc1
    v_mfma_f32_32x32x16_bf16 v[240:255], v[52:55], a[100:103], v[240:255]
    ds_read_b64_tr_b16 v[50:51], v5 offset:44288
    s_add_u32 s38, s67, 1
    s_waitcnt vmcnt(5)
    v_subrev_u32 v15, s38, v15
    v_cmp_gt_u32 vcc, 8, v15
    s_nop 1
    s_andn2_b64 vcc, s[70:71], vcc
    s_cbranch_scc1 Lkv_o_spin
Lkv_o_back:
    s_waitcnt lgkmcnt(6)
    v_mfma_f32_32x32x16_bf16 v[192:207], v[56:59], a[104:107], v[192:207]
    ds_read_b64_tr_b16 v[52:53], v6 offset:44032
    buffer_load_dwordx4 v[112:115], v13, s[4:7], s57 offen offset:0 sc1
    v_mul_f32 v80, s62, v96
    v_mul_f32 v81, s62, v97
    v_mul_f32 v82, s62, v98
    v_mfma_f32_32x32x16_bf16 v[208:223], v[56:59], a[108:111], v[208:223]
    ds_read_b64_tr_b16 v[54:55], v6 offset:44288
    v_mul_f32 v83, s62, v99
    v_exp_f32 v80, v80
    v_mul_f32 v104, v96, v104
    v_mfma_f32_32x32x16_bf16 v[224:239], v[60:63], a[104:107], v[224:239]
    ds_read_b64_tr_b16 v[56:57], v7 offset:40960
    v_exp_f32 v81, v81
    v_mul_f32 v105, v97, v105
    buffer_load_dwordx4 v[116:119], v13, s[4:7], s57 offen offset:512 sc1
    v_mfma_f32_32x32x16_bf16 v[240:255], v[60:63], a[108:111], v[240:255]
    ds_read_b64_tr_b16 v[58:59], v7 offset:41216
    v_exp_f32 v82, v82
    v_mul_f32 v106, v98, v106
    s_waitcnt lgkmcnt(6)
    v_mfma_f32_32x32x16_bf16 v[192:207], v[64:67], a[112:115], v[192:207]
    ds_read_b64_tr_b16 v[60:61], v8 offset:40960
    v_exp_f32 v83, v83
    v_mul_f32 v107, v99, v107
    v_add_f32 v80, 1.0, v80
    v_add_f32 v81, 1.0, v81
    v_mfma_f32_32x32x16_bf16 v[208:223], v[64:67], a[116:119], v[208:223]
    ds_read_b64_tr_b16 v[62:63], v8 offset:41216
    v_add_f32 v82, 1.0, v82
    v_add_f32 v83, 1.0, v83
    buffer_load_dwordx4 v[120:123], v13, s[4:7], s57 offen offset:1024 sc1
    v_mfma_f32_32x32x16_bf16 v[224:239], v[68:71], a[112:115], v[224:239]
    ds_read_b64_tr_b16 v[64:65], v7 offset:41984
    v_rcp_f32 v80, v80
    v_rcp_f32 v81, v81
    v_mfma_f32_32x32x16_bf16 v[240:255], v[68:71], a[116:119], v[240:255]
    ds_read_b64_tr_b16 v[66:67], v7 offset:42240
    v_rcp_f32 v82, v82
    v_rcp_f32 v83, v83
    s_waitcnt lgkmcnt(6)
    v_mfma_f32_32x32x16_bf16 v[192:207], v[48:51], a[120:123], v[192:207]
    ds_read_b64_tr_b16 v[68:69], v8 offset:41984
    v_mul_f32 v104, v104, v80
    v_mul_f32 v105, v105, v81
    v_mul_f32 v106, v106, v82
    v_mul_f32 v107, v107, v83
    v_mfma_f32_32x32x16_bf16 v[208:223], v[48:51], a[124:127], v[208:223]
    ds_read_b64_tr_b16 v[70:71], v8 offset:42240
    buffer_load_dwordx4 v[124:127], v13, s[4:7], s57 offen offset:1536 sc1
    v_cvt_pk_bf16_f32 v76, v104, v105
    v_cvt_pk_bf16_f32 v77, v106, v107
    v_mul_f32 v80, s62, v100
    v_mfma_f32_32x32x16_bf16 v[224:239], v[52:55], a[120:123], v[224:239]
    ds_read_b64_tr_b16 v[48:49], v7 offset:43008
    v_mul_f32 v81, s62, v101
    v_mul_f32 v82, s62, v102
    v_mul_f32 v83, s62, v103
    v_exp_f32 v80, v80
    v_mfma_f32_32x32x16_bf16 v[240:255], v[52:55], a[124:127], v[240:255]
    ds_read_b64_tr_b16 v[50:51], v7 offset:43264
    v_mul_f32 v108, v100, v108
    buffer_load_dwordx4 v[144:147], v13, s[4:7], s57 offen offset:2048 sc1
    s_waitcnt lgkmcnt(6)
    v_mfma_f32_32x32x16_bf16 v[192:207], v[56:59], a[128:131], v[192:207]
    ds_read_b64_tr_b16 v[52:53], v8 offset:43008
    v_exp_f32 v81, v81
    v_mul_f32 v109, v101, v109
    v_exp_f32 v82, v82
    v_mfma_f32_32x32x16_bf16 v[208:223], v[56:59], a[132:135], v[208:223]
    ds_read_b64_tr_b16 v[54:55], v8 offset:43264
    v_mul_f32 v110, v102, v110
    v_exp_f32 v83, v83
    v_mul_f32 v111, v103, v111
    v_add_f32 v80, 1.0, v80
    v_mfma_f32_32x32x16_bf16 v[224:239], v[60:63], a[128:131], v[224:239]
    ds_read_b64_tr_b16 v[56:57], v7 offset:44032
    v_add_f32 v81, 1.0, v81
    s_add_u32 s57, s57, 6144
    buffer_load_dwordx4 v[160:163], v13, s[4:7], s57 offen offset:0 sc1
    v_add_f32 v82, 1.0, v82
    v_mfma_f32_32x32x16_bf16 v[240:255], v[60:63], a[132:135], v[240:255]
    ds_read_b64_tr_b16 v[58:59], v7 offset:44288
    v_add_f32 v83, 1.0, v83
    v_rcp_f32 v80, v80
    s_waitcnt lgkmcnt(6)
    v_mfma_f32_32x32x16_bf16 v[192:207], v[64:67], a[136:139], v[192:207]
    ds_read_b64_tr_b16 v[60:61], v8 offset:44032
    v_rcp_f32 v81, v81
    v_rcp_f32 v82, v82
    v_mfma_f32_32x32x16_bf16 v[208:223], v[64:67], a[140:143], v[208:223]
    ds_read_b64_tr_b16 v[62:63], v8 offset:44288
    v_rcp_f32 v83, v83
    v_mul_f32 v108, v108, v80
    v_mul_f32 v109, v109, v81
    v_mfma_f32_32x32x16_bf16 v[224:239], v[68:71], a[136:139], v[224:239]
    s_waitcnt vmcnt(7)
    s_barrier
    ds_read_b64_tr_b16 v[64:65], v9 offset:16384
    buffer_load_dwordx4 v[164:167], v13, s[4:7], s57 offen offset:512 sc1
    v_mul_f32 v110, v110, v82
    v_mfma_f32_32x32x16_bf16 v[240:255], v[68:71], a[140:143], v[240:255]
    ds_read_b64_tr_b16 v[66:67], v9 offset:16640
    v_mul_f32 v111, v111, v83
    v_cvt_pk_bf16_f32 v78, v108, v109
    v_cvt_pk_bf16_f32 v79, v110, v111
    s_waitcnt lgkmcnt(6)
    v_mfma_f32_32x32x16_bf16 v[192:207], v[48:51], a[144:147], v[192:207]
    ds_read_b64_tr_b16 v[68:69], v10 offset:16384
    buffer_store_dwordx4 v[76:79], v3, s[4:7], s45 offen offset:0 sc1
    v_mfma_f32_32x32x16_bf16 v[208:223], v[48:51], a[148:151], v[208:223]
    ds_read_b64_tr_b16 v[70:71], v10 offset:16640
    v_mul_f32 v80, s62, v128
    v_mul_f32 v81, s62, v129
    v_mul_f32 v82, s62, v130
    v_mfma_f32_32x32x16_bf16 v[224:239], v[52:55], a[144:147], v[224:239]
    ds_read_b64_tr_b16 v[48:49], v9 offset:17408
    buffer_load_dwordx4 v[168:171], v13, s[4:7], s57 offen offset:1024 sc1
    v_mul_f32 v83, s62, v131
    v_exp_f32 v80, v80
    v_mfma_f32_32x32x16_bf16 v[240:255], v[52:55], a[148:151], v[240:255]
    ds_read_b64_tr_b16 v[50:51], v9 offset:17664
    v_mul_f32 v136, v128, v136
    v_exp_f32 v81, v81
    v_mul_f32 v137, v129, v137
    s_waitcnt lgkmcnt(6)
    v_mfma_f32_32x32x16_bf16 v[192:207], v[56:59], a[152:155], v[192:207]
    ds_read_b64_tr_b16 v[52:53], v10 offset:17408
    v_exp_f32 v82, v82
    v_mul_f32 v138, v130, v138
    v_exp_f32 v83, v83
    v_mfma_f32_32x32x16_bf16 v[208:223], v[56:59], a[156:159], v[208:223]
    ds_read_b64_tr_b16 v[54:55], v10 offset:17664
    buffer_load_dwordx4 v[172:175], v13, s[4:7], s57 offen offset:1536 sc1
    v_mul_f32 v139, v131, v139
    v_add_f32 v80, 1.0, v80
    v_add_f32 v81, 1.0, v81
    v_mfma_f32_32x32x16_bf16 v[224:239], v[60:63], a[152:155], v[224:239]
    ds_read_b64_tr_b16 v[56:57], v9 offset:18432
    v_add_f32 v82, 1.0, v82
    v_add_f32 v83, 1.0, v83
    v_rcp_f32 v80, v80
    v_mfma_f32_32x32x16_bf16 v[240:255], v[60:63], a[156:159], v[240:255]
    ds_read_b64_tr_b16 v[58:59], v9 offset:18688
    v_rcp_f32 v81, v81
    v_rcp_f32 v82, v82
    s_waitcnt lgkmcnt(6)
    v_mfma_f32_32x32x16_bf16 v[192:207], v[64:67], a[160:163], v[192:207]
    ds_read_b64_tr_b16 v[60:61], v10 offset:18432
    buffer_load_dwordx4 v[148:151], v13, s[4:7], s57 offen offset:2048 sc1
    v_rcp_f32 v83, v83
    v_mul_f32 v136, v136, v80
    v_mfma_f32_32x32x16_bf16 v[208:223], v[64:67], a[164:167], v[208:223]
    ds_read_b64_tr_b16 v[62:63], v10 offset:18688
    v_mul_f32 v137, v137, v81
    v_mul_f32 v138, v138, v82
    v_mul_f32 v139, v139, v83
    v_cvt_pk_bf16_f32 v72, v136, v137
    v_cvt_pk_bf16_f32 v73, v138, v139
    v_mfma_f32_32x32x16_bf16 v[224:239], v[68:71], a[160:163], v[224:239]
    ds_read_b64_tr_b16 v[64:65], v9 offset:19456
    v_mul_f32 v80, s62, v132
    v_mul_f32 v81, s62, v133
    v_mul_f32 v82, s62, v134
    v_mul_f32 v83, s62, v135
    v_mfma_f32_32x32x16_bf16 v[240:255], v[68:71], a[164:167], v[240:255]
    ds_read_b64_tr_b16 v[66:67], v9 offset:19712
    v_exp_f32 v80, v80
    v_mul_f32 v140, v132, v140
    s_waitcnt lgkmcnt(6)
    v_mfma_f32_32x32x16_bf16 v[192:207], v[48:51], a[168:171], v[192:207]
    ds_read_b64_tr_b16 v[68:69], v10 offset:19456
    v_exp_f32 v81, v81
    v_mul_f32 v141, v133, v141
    v_exp_f32 v82, v82
    v_mfma_f32_32x32x16_bf16 v[208:223], v[48:51], a[172:175], v[208:223]
    ds_read_b64_tr_b16 v[70:71], v10 offset:19712
    v_mul_f32 v142, v134, v142
    v_exp_f32 v83, v83
    v_mul_f32 v143, v135, v143
    v_add_f32 v80, 1.0, v80
    v_mfma_f32_32x32x16_bf16 v[224:239], v[52:55], a[168:171], v[224:239]
    ds_read_b64_tr_b16 v[48:49], v5 offset:16384
    v_add_f32 v81, 1.0, v81
    v_add_f32 v82, 1.0, v82
    v_add_f32 v83, 1.0, v83
    v_rcp_f32 v80, v80
    v_mfma_f32_32x32x16_bf16 v[240:255], v[52:55], a[172:175], v[240:255]
    ds_read_b64_tr_b16 v[50:51], v5 offset:16640
    v_rcp_f32 v81, v81
    v_rcp_f32 v82, v82
    s_waitcnt lgkmcnt(6)
    v_mfma_f32_32x32x16_bf16 v[192:207], v[56:59], a[176:179], v[192:207]
    ds_read_b64_tr_b16 v[52:53], v6 offset:16384
    v_rcp_f32 v83, v83
    v_mul_f32 v140, v140, v80
    v_mul_f32 v141, v141, v81
    v_mul_f32 v142, v142, v82
    v_mfma_f32_32x32x16_bf16 v[208:223], v[56:59], a[180:183], v[208:223]
    ds_read_b64_tr_b16 v[54:55], v6 offset:16640
    v_mul_f32 v143, v143, v83
    v_cvt_pk_bf16_f32 v74, v140, v141
    v_cvt_pk_bf16_f32 v75, v142, v143
    v_mfma_f32_32x32x16_bf16 v[224:239], v[60:63], a[176:179], v[224:239]
    ds_read_b64_tr_b16 v[56:57], v5 offset:17408
    s_mov_b32 s12, -1
    s_mov_b32 s13, 4194303
    s_mul_i32 s35, s65, 36
    v_lshrrev_b32 v88, 2, v0
    v_add_u32 v89, s35, v88
    v_mfma_f32_32x32x16_bf16 v[240:255], v[60:63], a[180:183], v[240:255]
    ds_read_b64_tr_b16 v[58:59], v5 offset:17664
    v_cmp_gt_u32 vcc, 18, v88
    s_nop 1
    v_cndmask_b32 v88, v89, v88, vcc
    v_and_b32 v89, 1, v88
    s_waitcnt lgkmcnt(6)
    v_mfma_f32_32x32x16_bf16 v[192:207], v[64:67], a[184:187], v[192:207]
    ds_read_b64_tr_b16 v[60:61], v6 offset:17408
    v_lshlrev_b32 v90, 9, v89
    v_bfe_u32 v89, v88, 3, 2
    v_lshl_add_u32 v90, v89, 7, v90
    v_bfe_u32 v89, v88, 1, 2
    v_mfma_f32_32x32x16_bf16 v[208:223], v[64:67], a[188:191], v[208:223]
    ds_read_b64_tr_b16 v[62:63], v6 offset:17664
    v_lshl_add_u32 v90, v89, 3, v90
    v_lshrrev_b32 v89, 5, v88
    v_add_lshl_u32 v88, v89, v90, 7
    s_lshr_b32 s35, s66, 3
    s_lshl_b32 s35, s35, 12
    v_mfma_f32_32x32x16_bf16 v[224:239], v[68:71], a[184:187], v[224:239]
    ds_read_b64_tr_b16 v[64:65], v5 offset:18432
    s_add_u32 s35, s35, 45842432
    s_mov_b64 exec, s[12:13]
    buffer_load_dword v88, v88, s[4:7], s35 offen sc1
    s_mov_b64 exec, -1
    v_mfma_f32_32x32x16_bf16 v[240:255], v[68:71], a[188:191], v[240:255]
    ds_read_b64_tr_b16 v[66:67], v5 offset:18688
    buffer_store_dwordx4 v[72:75], v3, s[4:7], s46 offen offset:0 sc1
    s_waitcnt lgkmcnt(6)
    v_mfma_f32_32x32x16_bf16 v[192:207], v[48:51], a[192:195], v[192:207]
    ds_read_b64_tr_b16 v[68:69], v6 offset:18432
    s_mul_i32 s38, s3, 5120
    s_add_u32 s38, s38, 122880
    v_add_u32 v14, s38, v1
    s_waitcnt vmcnt(7)
    v_add_f32 v112, v112, v160
    v_add_f32 v113, v113, v161
    v_mfma_f32_32x32x16_bf16 v[208:223], v[48:51], a[196:199], v[208:223]
    ds_read_b64_tr_b16 v[70:71], v6 offset:18688
    v_add_f32 v114, v114, v162
    v_add_f32 v115, v115, v163
    ds_write_b128 v14, v[112:115] offset:0
    v_mfma_f32_32x32x16_bf16 v[224:239], v[52:55], a[192:195], v[224:239]
    ds_read_b64_tr_b16 v[48:49], v5 offset:19456
    s_waitcnt vmcnt(6)
    v_add_f32 v116, v116, v164
    v_add_f32 v117, v117, v165
    v_add_f32 v118, v118, v166
    v_add_f32 v119, v119, v167
    v_mfma_f32_32x32x16_bf16 v[240:255], v[52:55], a[196:199], v[240:255]
    ds_read_b64_tr_b16 v[50:51], v5 offset:19712
    ds_write_b128 v14, v[116:119] offset:1024
    s_waitcnt vmcnt(4)
    v_add_f32 v120, v120, v168
    s_waitcnt lgkmcnt(8)
    v_mfma_f32_32x32x16_bf16 v[192:207], v[56:59], a[200:203], v[192:207]
    ds_read_b64_tr_b16 v[52:53], v6 offset:19456
    v_add_f32 v121, v121, v169
    v_add_f32 v122, v122, v170
    v_add_f32 v123, v123, v171
    v_mfma_f32_32x32x16_bf16 v[208:223], v[56:59], a[204:207], v[208:223]
    ds_read_b64_tr_b16 v[54:55], v6 offset:19712
    ds_write_b128 v14, v[120:123] offset:2048
    s_waitcnt vmcnt(3)
    v_add_f32 v124, v124, v172
    v_add_f32 v125, v125, v173
    v_mfma_f32_32x32x16_bf16 v[224:239], v[60:63], a[200:203], v[224:239]
    ds_read_b64_tr_b16 v[56:57], v5 offset:0
    v_add_f32 v126, v126, v174
    v_add_f32 v127, v127, v175
    ds_write_b128 v14, v[124:127] offset:3072
    v_mfma_f32_32x32x16_bf16 v[240:255], v[60:63], a[204:207], v[240:255]
    ds_read_b64_tr_b16 v[58:59], v5 offset:256
    s_waitcnt vmcnt(2)
    v_add_f32 v144, v144, v148
    v_add_f32 v145, v145, v149
    v_add_f32 v146, v146, v150
    v_add_f32 v147, v147, v151
    s_waitcnt lgkmcnt(10)
    v_mfma_f32_32x32x16_bf16 v[192:207], v[64:67], a[208:211], v[192:207]
    ds_read_b64_tr_b16 v[60:61], v6 offset:0
    v_lshlrev_b32 v92, 5, v0
    s_mov_b64 exec, s[72:73]
    buffer_load_dword v92, v92, s[4:7], s23 offen sc1
    s_mov_b64 exec, -1
    v_mfma_f32_32x32x16_bf16 v[208:223], v[64:67], a[212:215], v[208:223]
    ds_read_b64_tr_b16 v[62:63], v6 offset:256
    ds_write_b128 v14, v[144:147] offset:4096
    v_add_u32 v14, 122880, v1
    v_mfma_f32_32x32x16_bf16 v[224:239], v[68:71], a[208:211], v[224:239]
    ds_read_b64_tr_b16 v[64:65], v5 offset:1024
    v_mfma_f32_32x32x16_bf16 v[240:255], v[68:71], a[212:215], v[240:255]
    ds_read_b64_tr_b16 v[66:67], v5 offset:1280
    s_waitcnt lgkmcnt(2)
    s_barrier
    ds_read_b128 v[112:115], v14 offset:0
    ds_read_b128 v[116:119], v14 offset:1024
    v_mfma_f32_32x32x16_bf16 v[192:207], v[48:51], a[216:219], v[192:207]
    ds_read_b64_tr_b16 v[68:69], v6 offset:1024
    ds_read_b128 v[120:123], v14 offset:2048
    ds_read_b128 v[124:127], v14 offset:3072
    ds_read_b128 v[144:147], v14 offset:4096
    ds_read_b128 v[160:163], v14 offset:5120
    v_mfma_f32_32x32x16_bf16 v[208:223], v[48:51], a[220:223], v[208:223]
    ds_read_b64_tr_b16 v[70:71], v6 offset:1280
    ds_read_b128 v[164:167], v14 offset:6144
    ds_read_b128 v[168:171], v14 offset:7168
    ds_read_b128 v[172:175], v14 offset:8192
    ds_read_b128 v[148:151], v14 offset:9216
    v_mfma_f32_32x32x16_bf16 v[224:239], v[52:55], a[216:219], v[224:239]
    ds_read_b64_tr_b16 v[48:49], v5 offset:2048
    ds_read_b128 v[176:179], v14 offset:10240
    ds_read_b128 v[180:183], v14 offset:11264
    ds_read_b128 v[184:187], v14 offset:12288
    ds_read_b128 v[188:191], v14 offset:13312
    v_mfma_f32_32x32x16_bf16 v[240:255], v[52:55], a[220:223], v[240:255]
    ds_read_b64_tr_b16 v[50:51], v5 offset:2304
    ds_read_b128 v[152:155], v14 offset:14336
    v_mfma_f32_32x32x16_bf16 v[192:207], v[56:59], a[224:227], v[192:207]
    ds_read_b64_tr_b16 v[52:53], v6 offset:2048
    v_mfma_f32_32x32x16_bf16 v[208:223], v[56:59], a[228:231], v[208:223]
    ds_read_b64_tr_b16 v[54:55], v6 offset:2304
    s_waitcnt lgkmcnt(14)
    v_add_f32 v112, v112, v160
    v_add_f32 v113, v113, v161
    v_add_f32 v114, v114, v162
    v_add_f32 v115, v115, v163
    ds_read_b128 v[160:163], v14 offset:15360
    v_mfma_f32_32x32x16_bf16 v[224:239], v[60:63], a[224:227], v[224:239]
    ds_read_b64_tr_b16 v[56:57], v5 offset:3072
    s_waitcnt lgkmcnt(14)
    v_add_f32 v116, v116, v164
    v_add_f32 v117, v117, v165
    v_add_f32 v118, v118, v166
    v_add_f32 v119, v119, v167
    ds_read_b128 v[164:167], v14 offset:16384
    v_mfma_f32_32x32x16_bf16 v[240:255], v[60:63], a[228:231], v[240:255]
    ds_read_b64_tr_b16 v[58:59], v5 offset:3328
    s_waitcnt lgkmcnt(14)
    v_add_f32 v120, v120, v168
    v_add_f32 v121, v121, v169
    v_add_f32 v122, v122, v170
    v_add_f32 v123, v123, v171
    v_mfma_f32_32x32x16_bf16 v[192:207], v[64:67], a[232:235], v[192:207]
    ds_read_b64_tr_b16 v[60:61], v6 offset:3072
    ds_read_b128 v[168:171], v14 offset:17408
    v_add_f32 v124, v124, v172
    v_add_f32 v125, v125, v173
    v_add_f32 v126, v126, v174
    v_add_f32 v127, v127, v175
    v_mfma_f32_32x32x16_bf16 v[208:223], v[64:67], a[236:239], v[208:223]
    ds_read_b64_tr_b16 v[62:63], v6 offset:3328
    ds_read_b128 v[172:175], v14 offset:18432
    s_waitcnt lgkmcnt(14)
    v_add_f32 v144, v144, v148
    v_add_f32 v145, v145, v149
    v_add_f32 v146, v146, v150
    v_add_f32 v147, v147, v151
    v_mfma_f32_32x32x16_bf16 v[224:239], v[68:71], a[232:235], v[224:239]
    ds_read_b64_tr_b16 v[64:65], v7 offset:0
    ds_read_b128 v[148:151], v14 offset:19456
    v_add_f32 v112, v112, v176
    v_add_f32 v113, v113, v177
    v_add_f32 v114, v114, v178
    v_add_f32 v115, v115, v179
    v_mfma_f32_32x32x16_bf16 v[240:255], v[68:71], a[236:239], v[240:255]
    ds_read_b64_tr_b16 v[66:67], v7 offset:256
    v_add_f32 v116, v116, v180
    v_add_f32 v117, v117, v181
    v_add_f32 v118, v118, v182
    v_add_f32 v119, v119, v183
    s_waitcnt lgkmcnt(11)
    v_mfma_f32_32x32x16_bf16 v[192:207], v[48:51], a[240:243], v[192:207]
    ds_read_b64_tr_b16 v[68:69], v8 offset:0
    v_add_f32 v120, v120, v184
    v_add_f32 v121, v121, v185
    v_add_f32 v122, v122, v186
    v_add_f32 v123, v123, v187
    v_add_f32 v124, v124, v188
    v_mfma_f32_32x32x16_bf16 v[208:223], v[48:51], a[244:247], v[208:223]
    ds_read_b64_tr_b16 v[70:71], v8 offset:256
    v_add_f32 v125, v125, v189
    v_add_f32 v126, v126, v190
    v_add_f32 v127, v127, v191
    v_add_f32 v144, v144, v152
    v_add_f32 v145, v145, v153
    v_mfma_f32_32x32x16_bf16 v[224:239], v[52:55], a[240:243], v[224:239]
    ds_read_b64_tr_b16 v[48:49], v7 offset:1024
    v_add_f32 v146, v146, v154
    v_add_f32 v147, v147, v155
    s_waitcnt lgkmcnt(13)
    v_add_f32 v112, v112, v160
    v_add_f32 v113, v113, v161
    v_add_f32 v114, v114, v162
    v_mfma_f32_32x32x16_bf16 v[240:255], v[52:55], a[244:247], v[240:255]
    ds_read_b64_tr_b16 v[50:51], v7 offset:1280
    v_add_f32 v115, v115, v163
    s_waitcnt lgkmcnt(12)
    v_add_f32 v116, v116, v164
    v_add_f32 v117, v117, v165
    v_add_f32 v118, v118, v166
    s_waitcnt lgkmcnt(8)
    v_mfma_f32_32x32x16_bf16 v[192:207], v[56:59], a[248:251], v[192:207]
    ds_read_b64_tr_b16 v[52:53], v8 offset:1024
    v_add_f32 v119, v119, v167
    v_add_f32 v120, v120, v168
    v_add_f32 v121, v121, v169
    v_add_f32 v122, v122, v170
    v_add_f32 v123, v123, v171
    v_mfma_f32_32x32x16_bf16 v[208:223], v[56:59], a[252:255], v[208:223]
    ds_read_b64_tr_b16 v[54:55], v8 offset:1280
    s_waitcnt lgkmcnt(9)
    v_add_f32 v124, v124, v172
    v_add_f32 v125, v125, v173
    v_add_f32 v126, v126, v174
    v_add_f32 v127, v127, v175
    s_waitcnt lgkmcnt(7)
    v_add_f32 v144, v144, v148
    v_mfma_f32_32x32x16_bf16 v[224:239], v[60:63], a[248:251], v[224:239]
    ds_read_b64_tr_b16 v[56:57], v7 offset:2048
    v_add_f32 v145, v145, v149
    v_add_f32 v146, v146, v150
    v_add_f32 v147, v147, v151
    s_add_u32 s38, s55, 0
    v_mfma_f32_32x32x16_bf16 v[240:255], v[60:63], a[252:255], v[240:255]
    ds_read_b64_tr_b16 v[58:59], v7 offset:2304
    buffer_load_dwordx4 v[160:163], v1, s[4:7], s38 offen offset:0
    s_waitcnt lgkmcnt(6)
    v_mfma_f32_32x32x16_bf16 v[192:207], v[64:67], v[16:19], v[192:207]
    ds_read_b64_tr_b16 v[60:61], v8 offset:2048
    v_mfma_f32_32x32x16_bf16 v[208:223], v[64:67], v[20:23], v[208:223]
    ds_read_b64_tr_b16 v[62:63], v8 offset:2304
    buffer_load_dwordx4 v[164:167], v1, s[4:7], s38 offen offset:1024
    v_mfma_f32_32x32x16_bf16 v[224:239], v[68:71], v[16:19], v[224:239]
    ds_read_b64_tr_b16 v[64:65], v7 offset:3072
    v_mfma_f32_32x32x16_bf16 v[240:255], v[68:71], v[20:23], v[240:255]
    ds_read_b64_tr_b16 v[66:67], v7 offset:3328
    buffer_load_dwordx4 v[168:171], v1, s[4:7], s38 offen offset:2048
    s_waitcnt lgkmcnt(6)
    v_mfma_f32_32x32x16_bf16 v[192:207], v[48:51], v[24:27], v[192:207]
    ds_read_b64_tr_b16 v[68:69], v8 offset:3072
    v_mfma_f32_32x32x16_bf16 v[208:223], v[48:51], v[28:31], v[208:223]
    ds_read_b64_tr_b16 v[70:71], v8 offset:3328
    buffer_load_dwordx4 v[172:175], v1, s[4:7], s38 offen offset:3072
    s_add_u32 s38, s55, 4096
    buffer_load_dwordx4 v[152:155], v1, s[4:7], s38 offen offset:0
    buffer_load_dwordx4 v[176:179], v1, s[4:7], s38 offen offset:1024
    buffer_load_dwordx4 v[180:183], v1, s[4:7], s38 offen offset:2048
    buffer_load_dwordx4 v[184:187], v1, s[4:7], s38 offen offset:3072
    s_add_u32 s38, s55, 8192
    buffer_load_dwordx4 v[188:191], v1, s[4:7], s38 offen offset:0
    buffer_load_dwordx4 v[148:151], v1, s[4:7], s38 offen offset:1024
    v_mov_b32 v15, s67
    v_add_u32 v15, 4, v15
    s_waitcnt vmcnt(11)
    s_mov_b64 exec, 1
    buffer_store_dword v15, off, s[4:7], s60 sc1
    s_mov_b64 exec, -1
    v_mfma_f32_32x32x16_bf16 v[224:239], v[52:55], v[24:27], v[224:239]
    s_barrier
    ds_read_b64_tr_b16 v[48:49], v5 offset:8192
    s_mov_b32 s12, -1
    s_mov_b32 s13, 4194303
    v_cvt_pk_bf16_f32 v112, v112, v113
    v_mfma_f32_32x32x16_bf16 v[240:255], v[52:55], v[28:31], v[240:255]
    ds_read_b64_tr_b16 v[50:51], v5 offset:8448
    s_add_u32 s34, s67, 2
    v_subrev_u32 v88, s34, v88
    v_cmp_gt_u32 vcc, 8, v88
    s_nop 1
    s_andn2_b64 vcc, s[12:13], vcc
    s_cbranch_scc1 Lwd_o_spin
Lwd_o_back:
    s_waitcnt lgkmcnt(6)
    v_mfma_f32_32x32x16_bf16 v[192:207], v[56:59], v[32:35], v[192:207]
    ds_read_b64_tr_b16 v[52:53], v5 offset:9216
    s_add_u32 m0, s26, 147456
    s_add_u32 s34, s16, 0
    buffer_load_dwordx4 v1, s[4:7], s34 offen sc1 lds
    v_cvt_pk_bf16_f32 v113, v114, v115
    v_mfma_f32_32x32x16_bf16 v[208:223], v[56:59], v[36:39], v[208:223]
    ds_read_b64_tr_b16 v[54:55], v5 offset:9472
    v_mov_b32 v114, 0
    v_mov_b32 v115, 0
    v_cvt_pk_bf16_f32 v116, v116, v117
    v_cvt_pk_bf16_f32 v117, v118, v119
    v_mov_b32 v118, 0
    v_mfma_f32_32x32x16_bf16 v[224:239], v[60:63], v[32:35], v[224:239]
    ds_read_b64_tr_b16 v[56:57], v5 offset:10240
    buffer_load_dwordx4 v1, s[4:7], s34 offen offset:1024 sc1 lds
    v_mov_b32 v119, 0
    v_cvt_pk_bf16_f32 v120, v120, v121
    v_cvt_pk_bf16_f32 v121, v122, v123
    v_mfma_f32_32x32x16_bf16 v[240:255], v[60:63], v[36:39], v[240:255]
    ds_read_b64_tr_b16 v[58:59], v5 offset:10496
    v_mov_b32 v122, 0
    v_mov_b32 v123, 0
    v_cvt_pk_bf16_f32 v124, v124, v125
    v_cvt_pk_bf16_f32 v125, v126, v127
    s_waitcnt lgkmcnt(6)
    v_mfma_f32_32x32x16_bf16 v[192:207], v[64:67], v[40:43], v[192:207]
    ds_read_b64_tr_b16 v[60:61], v5 offset:11264
    s_add_u32 m0, s26, 0
    s_add_u32 s34, s19, 0
    buffer_load_dwordx4 v1, s[4:7], s34 offen sc1 lds
    v_mov_b32 v126, 0
    v_mfma_f32_32x32x16_bf16 v[208:223], v[64:67], v[44:47], v[208:223]
    ds_read_b64_tr_b16 v[62:63], v5 offset:11520
    v_mov_b32 v127, 0
    v_cvt_pk_bf16_f32 v144, v144, v145
    v_cvt_pk_bf16_f32 v145, v146, v147
    v_mov_b32 v146, 0
    v_mov_b32 v147, 0
    v_mfma_f32_32x32x16_bf16 v[224:239], v[68:71], v[40:43], v[224:239]
    ds_read_b64_tr_b16 v[64:65], v5 offset:49152
    buffer_load_dwordx4 v1, s[4:7], s34 offen offset:1024 sc1 lds
    v_permlane32_swap_b32 v112, v114
    v_permlane32_swap_b32 v113, v115
    v_permlane32_swap_b32 v116, v118
    v_mfma_f32_32x32x16_bf16 v[240:255], v[68:71], v[44:47], v[240:255]
    ds_read_b64_tr_b16 v[66:67], v5 offset:49408
    v_permlane32_swap_b32 v117, v119
    v_permlane32_swap_b32 v120, v122
    v_permlane32_swap_b32 v121, v123
    v_permlane32_swap_b32 v124, v126
    s_waitcnt lgkmcnt(6)
    v_mfma_f32_32x32x16_bf16 v[96:111], v[48:51], a[0:3], 0
    ds_read_b64_tr_b16 v[68:69], v5 offset:50176
    v_permlane32_swap_b32 v125, v127
    v_permlane32_swap_b32 v144, v146
    v_permlane32_swap_b32 v145, v147
    v_mov_b32 v146, 0
    v_mov_b32 v147, 0
    v_mfma_f32_32x32x16_bf16 v[128:143], v[48:51], a[4:7], 0
    ds_read_b64_tr_b16 v[70:71], v5 offset:50432
    v_mul_f32 v80, s62, v192
    v_mul_f32 v81, s62, v193
    v_mul_f32 v82, s62, v194
    v_mul_f32 v83, s62, v195
    v_mfma_f32_32x32x16_bf16 v[96:111], v[52:55], a[8:11], v[96:111]
    ds_read_b64_tr_b16 v[48:49], v5 offset:51200
    s_add_u32 m0, s26, 16384
    s_add_u32 s34, s16, 8192
    buffer_load_dwordx4 v1, s[4:7], s34 offen sc1 lds
    v_mfma_f32_32x32x16_bf16 v[128:143], v[52:55], a[12:15], v[128:143]
    ds_read_b64_tr_b16 v[50:51], v5 offset:51456
    v_exp_f32 v80, v80
    v_mul_f32 v200, v192, v200
    s_waitcnt lgkmcnt(6)
    v_mfma_f32_32x32x16_bf16 v[96:111], v[56:59], a[16:19], v[96:111]
    ds_read_b64_tr_b16 v[52:53], v5 offset:52224
    v_exp_f32 v81, v81
    v_mul_f32 v201, v193, v201
    v_exp_f32 v82, v82
    v_mfma_f32_32x32x16_bf16 v[128:143], v[56:59], a[20:23], v[128:143]
    ds_read_b64_tr_b16 v[54:55], v5 offset:52480
    v_mul_f32 v202, v194, v202
    v_exp_f32 v83, v83
    v_mul_f32 v203, v195, v203
    v_add_f32 v80, 1.0, v80
    v_mfma_f32_32x32x16_bf16 v[96:111], v[60:63], a[24:27], v[96:111]
    ds_read_b64_tr_b16 v[56:57], v7 offset:32768
    buffer_load_dwordx4 v1, s[4:7], s34 offen offset:1024 sc1 lds
    v_add_f32 v81, 1.0, v81
    v_add_f32 v82, 1.0, v82
    v_add_f32 v83, 1.0, v83
    v_mfma_f32_32x32x16_bf16 v[128:143], v[60:63], a[28:31], v[128:143]
    ds_read_b64_tr_b16 v[58:59], v7 offset:33024
    v_rcp_f32 v80, v80
    v_rcp_f32 v81, v81
    s_waitcnt lgkmcnt(6)
    v_mfma_f32_32x32x16_bf16 v[96:111], v[64:67], a[32:35], v[96:111]
    ds_read_b64_tr_b16 v[60:61], v7 offset:33792
    v_rcp_f32 v82, v82
    v_rcp_f32 v83, v83
    v_mul_f32 v200, v200, v80
    v_mfma_f32_32x32x16_bf16 v[128:143], v[64:67], a[36:39], v[128:143]
    ds_read_b64_tr_b16 v[62:63], v7 offset:34048
    v_mul_f32 v201, v201, v81
    v_mul_f32 v202, v202, v82
    v_mul_f32 v203, v203, v83
    v_cvt_pk_bf16_f32 v76, v200, v201
    v_cvt_pk_bf16_f32 v77, v202, v203
    v_mfma_f32_32x32x16_bf16 v[96:111], v[68:71], a[40:43], v[96:111]
    ds_read_b64_tr_b16 v[64:65], v7 offset:34816
    s_add_u32 m0, s26, 24576
    s_add_u32 s34, s16, 16384
    buffer_load_dwordx4 v1, s[4:7], s34 offen sc1 lds
    v_mul_f32 v80, s62, v196
    v_mfma_f32_32x32x16_bf16 v[128:143], v[68:71], a[44:47], v[128:143]
    ds_read_b64_tr_b16 v[66:67], v7 offset:35072
    v_mul_f32 v81, s62, v197
    v_mul_f32 v82, s62, v198
    v_mul_f32 v83, s62, v199
    s_waitcnt lgkmcnt(6)
    v_mfma_f32_32x32x16_bf16 v[96:111], v[48:51], a[48:51], v[96:111]
    ds_read_b64_tr_b16 v[68:69], v7 offset:35840
    v_exp_f32 v80, v80
    v_mul_f32 v204, v196, v204
    v_exp_f32 v81, v81
    v_mfma_f32_32x32x16_bf16 v[128:143], v[48:51], a[52:55], v[128:143]
    ds_read_b64_tr_b16 v[70:71], v7 offset:36096
    v_mul_f32 v205, v197, v205
    v_exp_f32 v82, v82
    v_mul_f32 v206, v198, v206
    v_mfma_f32_32x32x16_bf16 v[96:111], v[52:55], a[56:59], v[96:111]
    ds_read_b64_tr_b16 v[48:49], v5 offset:57344
    buffer_load_dwordx4 v1, s[4:7], s34 offen offset:1024 sc1 lds
    v_exp_f32 v83, v83
    v_mul_f32 v207, v199, v207
    v_mfma_f32_32x32x16_bf16 v[128:143], v[52:55], a[60:63], v[128:143]
    ds_read_b64_tr_b16 v[50:51], v5 offset:57600
    v_add_f32 v80, 1.0, v80
    v_add_f32 v81, 1.0, v81
    v_add_f32 v82, 1.0, v82
    v_add_f32 v83, 1.0, v83
    s_waitcnt lgkmcnt(6)
    v_mfma_f32_32x32x16_bf16 v[96:111], v[56:59], a[64:67], v[96:111]
    ds_read_b64_tr_b16 v[52:53], v5 offset:58368
    v_rcp_f32 v80, v80
    v_rcp_f32 v81, v81
    v_mfma_f32_32x32x16_bf16 v[128:143], v[56:59], a[68:71], v[128:143]
    ds_read_b64_tr_b16 v[54:55], v5 offset:58624
    v_rcp_f32 v82, v82
    v_rcp_f32 v83, v83
    v_mul_f32 v204, v204, v80
    v_mfma_f32_32x32x16_bf16 v[96:111], v[60:63], a[72:75], v[96:111]
    ds_read_b64_tr_b16 v[56:57], v5 offset:59392
    s_add_u32 m0, s26, 40960
    s_add_u32 s34, s16, 24576
    buffer_load_dwordx4 v1, s[4:7], s34 offen sc1 lds
    v_mul_f32 v205, v205, v81
    v_mfma_f32_32x32x16_bf16 v[128:143], v[60:63], a[76:79], v[128:143]
    ds_read_b64_tr_b16 v[58:59], v5 offset:59648
    v_mul_f32 v206, v206, v82
    v_mul_f32 v207, v207, v83
    v_cvt_pk_bf16_f32 v78, v204, v205
    v_cvt_pk_bf16_f32 v79, v206, v207
    s_waitcnt lgkmcnt(6)
    v_mfma_f32_32x32x16_bf16 v[96:111], v[64:67], a[80:83], v[96:111]
    ds_read_b64_tr_b16 v[60:61], v5 offset:60416
    buffer_store_dwordx4 v[76:79], v3, s[4:7], s47 offen offset:0 sc1
    v_mfma_f32_32x32x16_bf16 v[128:143], v[64:67], a[84:87], v[128:143]
    ds_read_b64_tr_b16 v[62:63], v5 offset:60672
    v_mul_f32 v80, s62, v208
    v_mul_f32 v81, s62, v209
    v_mul_f32 v82, s62, v210
    v_mul_f32 v83, s62, v211
    v_mfma_f32_32x32x16_bf16 v[96:111], v[68:71], a[88:91], v[96:111]
    ds_read_b64_tr_b16 v[64:65], v7 offset:49152
    v_exp_f32 v80, v80
    v_mul_f32 v216, v208, v216
    v_exp_f32 v81, v81
    v_mfma_f32_32x32x16_bf16 v[128:143], v[68:71], a[92:95], v[128:143]
    ds_read_b64_tr_b16 v[66:67], v7 offset:49408
    v_mul_f32 v217, v209, v217
    v_exp_f32 v82, v82
    v_mul_f32 v218, v210, v218
    s_waitcnt lgkmcnt(6)
    v_mfma_f32_32x32x16_bf16 v[96:111], v[48:51], a[96:99], v[96:111]
    ds_read_b64_tr_b16 v[68:69], v7 offset:50176
    buffer_load_dwordx4 v1, s[4:7], s34 offen offset:1024 sc1 lds
    v_exp_f32 v83, v83
    v_mul_f32 v219, v211, v219
    v_mfma_f32_32x32x16_bf16 v[128:143], v[48:51], a[100:103], v[128:143]
    ds_read_b64_tr_b16 v[70:71], v7 offset:50432
    v_add_f32 v80, 1.0, v80
    v_add_f32 v81, 1.0, v81
    v_add_f32 v82, 1.0, v82
    v_add_f32 v83, 1.0, v83
    v_mfma_f32_32x32x16_bf16 v[96:111], v[52:55], a[104:107], v[96:111]
    ds_read_b64_tr_b16 v[48:49], v7 offset:51200
    v_rcp_f32 v80, v80
    v_rcp_f32 v81, v81
    v_mfma_f32_32x32x16_bf16 v[128:143], v[52:55], a[108:111], v[128:143]
    ds_read_b64_tr_b16 v[50:51], v7 offset:51456
    v_rcp_f32 v82, v82
    v_rcp_f32 v83, v83
    s_waitcnt lgkmcnt(6)
    v_mfma_f32_32x32x16_bf16 v[96:111], v[56:59], a[112:115], v[96:111]
    ds_read_b64_tr_b16 v[52:53], v7 offset:52224
    s_add_u32 m0, s26, 90112
    s_add_u32 s34, s19, 8192
    buffer_load_dwordx4 v1, s[4:7], s34 offen sc1 lds
    v_mul_f32 v216, v216, v80
    v_mfma_f32_32x32x16_bf16 v[128:143], v[56:59], a[116:119], v[128:143]
    ds_read_b64_tr_b16 v[54:55], v7 offset:52480
    v_mul_f32 v217, v217, v81
    v_mul_f32 v218, v218, v82
    v_mul_f32 v219, v219, v83
    v_cvt_pk_bf16_f32 v72, v216, v217
    v_cvt_pk_bf16_f32 v73, v218, v219
    v_mfma_f32_32x32x16_bf16 v[96:111], v[60:63], a[120:123], v[96:111]
    ds_read_b64_tr_b16 v[56:57], v9 offset:24576
    v_mul_f32 v80, s62, v212
    v_mul_f32 v81, s62, v213
    v_mul_f32 v82, s62, v214
    v_mul_f32 v83, s62, v215
    v_mfma_f32_32x32x16_bf16 v[128:143], v[60:63], a[124:127], v[128:143]
    ds_read_b64_tr_b16 v[58:59], v9 offset:24832
    v_exp_f32 v80, v80
    v_mul_f32 v220, v212, v220
    s_waitcnt lgkmcnt(6)
    v_mfma_f32_32x32x16_bf16 v[96:111], v[64:67], a[128:131], v[96:111]
    ds_read_b64_tr_b16 v[60:61], v9 offset:25600
    buffer_load_dwordx4 v1, s[4:7], s34 offen offset:1024 sc1 lds
    v_exp_f32 v81, v81
    v_mul_f32 v221, v213, v221
    v_mfma_f32_32x32x16_bf16 v[128:143], v[64:67], a[132:135], v[128:143]
    ds_read_b64_tr_b16 v[62:63], v9 offset:25856
    v_exp_f32 v82, v82
    v_mul_f32 v222, v214, v222
    v_exp_f32 v83, v83
    v_mfma_f32_32x32x16_bf16 v[96:111], v[68:71], a[136:139], v[96:111]
    ds_read_b64_tr_b16 v[64:65], v9 offset:26624
    v_mul_f32 v223, v215, v223
    v_add_f32 v80, 1.0, v80
    v_add_f32 v81, 1.0, v81
    v_add_f32 v82, 1.0, v82
    v_add_f32 v83, 1.0, v83
    v_mfma_f32_32x32x16_bf16 v[128:143], v[68:71], a[140:143], v[128:143]
    ds_read_b64_tr_b16 v[66:67], v9 offset:26880
    v_rcp_f32 v80, v80
    v_rcp_f32 v81, v81
    s_waitcnt lgkmcnt(6)
    v_mfma_f32_32x32x16_bf16 v[96:111], v[48:51], a[144:147], v[96:111]
    ds_read_b64_tr_b16 v[68:69], v9 offset:27648
    s_add_u32 m0, s26, 106496
    s_add_u32 s34, s16, 32768
    buffer_load_dwordx4 v1, s[4:7], s34 offen sc1 lds
    v_mfma_f32_32x32x16_bf16 v[128:143], v[48:51], a[148:151], v[128:143]
    ds_read_b64_tr_b16 v[70:71], v9 offset:27904
    v_rcp_f32 v82, v82
    v_rcp_f32 v83, v83
    v_mul_f32 v220, v220, v80
    v_mfma_f32_32x32x16_bf16 v[96:111], v[52:55], a[152:155], v[96:111]
    ds_read_b64_tr_b16 v[48:49], v7 offset:8192
    v_mul_f32 v221, v221, v81
    v_mul_f32 v222, v222, v82
    v_mul_f32 v223, v223, v83
    v_cvt_pk_bf16_f32 v74, v220, v221
    v_cvt_pk_bf16_f32 v75, v222, v223
    v_mfma_f32_32x32x16_bf16 v[128:143], v[52:55], a[156:159], v[128:143]
    ds_read_b64_tr_b16 v[50:51], v7 offset:8448
    buffer_store_dwordx4 v[72:75], v3, s[4:7], s48 offen offset:0 sc1
    s_waitcnt lgkmcnt(6)
    v_mfma_f32_32x32x16_bf16 v[96:111], v[56:59], a[160:163], v[96:111]
    ds_read_b64_tr_b16 v[52:53], v7 offset:9216
    s_waitcnt vmcnt(25)
    v_mfma_f32_32x32x16_bf16 v[192:207], v[112:115], v[160:163], 0
    s_waitcnt vmcnt(24)
    v_mfma_f32_32x32x16_bf16 v[192:207], v[116:119], v[164:167], v[192:207]
    s_waitcnt vmcnt(23)
    v_mfma_f32_32x32x16_bf16 v[192:207], v[120:123], v[168:171], v[192:207]
    s_waitcnt vmcnt(22)
    v_mfma_f32_32x32x16_bf16 v[192:207], v[124:127], v[172:175], v[192:207]
    s_waitcnt vmcnt(21)
    v_mfma_f32_32x32x16_bf16 v[192:207], v[144:147], v[152:155], v[192:207]
    s_waitcnt vmcnt(20)
    v_mfma_f32_32x32x16_bf16 v[208:223], v[112:115], v[176:179], 0
    s_waitcnt vmcnt(19)
    v_mfma_f32_32x32x16_bf16 v[208:223], v[116:119], v[180:183], v[208:223]
    s_waitcnt vmcnt(18)
    v_mfma_f32_32x32x16_bf16 v[208:223], v[120:123], v[184:187], v[208:223]
    s_waitcnt vmcnt(17)
    v_mfma_f32_32x32x16_bf16 v[208:223], v[124:127], v[188:191], v[208:223]
    s_waitcnt vmcnt(16)
    v_mfma_f32_32x32x16_bf16 v[208:223], v[144:147], v[148:151], v[208:223]
    v_mul_f32 v80, s62, v224
    v_mul_f32 v81, s62, v225
    v_mul_f32 v82, s62, v226
    v_mul_f32 v83, s62, v227
    v_exp_f32 v80, v80
    v_mfma_f32_32x32x16_bf16 v[128:143], v[56:59], a[164:167], v[128:143]
    ds_read_b64_tr_b16 v[54:55], v7 offset:9472
    buffer_load_dwordx4 v1, s[4:7], s34 offen offset:1024 sc1 lds
    v_mul_f32 v232, v224, v232
    v_exp_f32 v81, v81
    v_mfma_f32_32x32x16_bf16 v[96:111], v[60:63], a[168:171], v[96:111]
    ds_read_b64_tr_b16 v[56:57], v7 offset:10240
    v_mul_f32 v233, v225, v233
    v_exp_f32 v82, v82
    v_mul_f32 v234, v226, v234
    v_mfma_f32_32x32x16_bf16 v[128:143], v[60:63], a[172:175], v[128:143]
    ds_read_b64_tr_b16 v[58:59], v7 offset:10496
    v_exp_f32 v83, v83
    v_mul_f32 v235, v227, v235
    v_add_f32 v80, 1.0, v80
    s_waitcnt lgkmcnt(6)
    v_mfma_f32_32x32x16_bf16 v[96:111], v[64:67], a[176:179], v[96:111]
    ds_read_b64_tr_b16 v[60:61], v7 offset:11264
    v_lshlrev_b32 v93, 5, v0
    s_mov_b64 exec, s[72:73]
    buffer_load_dword v93, v93, s[4:7], s23 offen sc1
    s_mov_b64 exec, -1
    v_mfma_f32_32x32x16_bf16 v[128:143], v[64:67], a[180:183], v[128:143]
    ds_read_b64_tr_b16 v[62:63], v7 offset:11520
    v_add_f32 v81, 1.0, v81
    v_add_f32 v82, 1.0, v82
    v_add_f32 v83, 1.0, v83
    v_rcp_f32 v80, v80
    v_mfma_f32_32x32x16_bf16 v[96:111], v[68:71], a[184:187], v[96:111]
    ds_read_b64_tr_b16 v[64:65], v5 offset:32768
    v_rcp_f32 v81, v81
    v_rcp_f32 v82, v82
    v_mfma_f32_32x32x16_bf16 v[128:143], v[68:71], a[188:191], v[128:143]
    ds_read_b64_tr_b16 v[66:67], v5 offset:33024
    v_rcp_f32 v83, v83
    v_mul_f32 v232, v232, v80
    v_mul_f32 v233, v233, v81
    s_waitcnt lgkmcnt(6)
    v_mfma_f32_32x32x16_bf16 v[96:111], v[48:51], a[192:195], v[96:111]
    ds_read_b64_tr_b16 v[68:69], v5 offset:33792
    v_mul_f32 v234, v234, v82
    v_mul_f32 v235, v235, v83
    v_cvt_pk_bf16_f32 v76, v232, v233
    v_cvt_pk_bf16_f32 v77, v234, v235
    v_mul_f32 v80, s62, v228
    v_mfma_f32_32x32x16_bf16 v[128:143], v[48:51], a[196:199], v[128:143]
    ds_read_b64_tr_b16 v[70:71], v5 offset:34048
    v_mul_f32 v81, s62, v229
    v_mul_f32 v82, s62, v230
    v_mul_f32 v83, s62, v231
    v_exp_f32 v80, v80
    v_mfma_f32_32x32x16_bf16 v[96:111], v[52:55], a[200:203], v[96:111]
    ds_read_b64_tr_b16 v[48:49], v5 offset:34816
    v_mul_f32 v236, v228, v236
    v_exp_f32 v81, v81
    v_mul_f32 v237, v229, v237
    v_mfma_f32_32x32x16_bf16 v[128:143], v[52:55], a[204:207], v[128:143]
    ds_read_b64_tr_b16 v[50:51], v5 offset:35072
    v_exp_f32 v82, v82
    v_mul_f32 v238, v230, v238
    s_waitcnt lgkmcnt(6)
    v_mfma_f32_32x32x16_bf16 v[96:111], v[56:59], a[208:211], v[96:111]
    ds_read_b64_tr_b16 v[52:53], v5 offset:35840
    v_exp_f32 v83, v83
    v_mul_f32 v239, v231, v239
    v_add_f32 v80, 1.0, v80
    v_add_f32 v81, 1.0, v81
    v_mfma_f32_32x32x16_bf16 v[128:143], v[56:59], a[212:215], v[128:143]
    ds_read_b64_tr_b16 v[54:55], v5 offset:36096
    v_add_f32 v82, 1.0, v82
    v_add_f32 v83, 1.0, v83
    v_rcp_f32 v80, v80
    v_mfma_f32_32x32x16_bf16 v[96:111], v[60:63], a[216:219], v[96:111]
    ds_read_b64_tr_b16 v[56:57], v7 offset:16384
    v_rcp_f32 v81, v81
    v_rcp_f32 v82, v82
    v_mfma_f32_32x32x16_bf16 v[128:143], v[60:63], a[220:223], v[128:143]
    ds_read_b64_tr_b16 v[58:59], v7 offset:16640
    v_rcp_f32 v83, v83
    v_mul_f32 v236, v236, v80
    v_mul_f32 v237, v237, v81
    s_waitcnt lgkmcnt(6)
    v_mfma_f32_32x32x16_bf16 v[96:111], v[64:67], a[224:227], v[96:111]
    ds_read_b64_tr_b16 v[60:61], v7 offset:17408
    v_mul_f32 v238, v238, v82
    v_mul_f32 v239, v239, v83
    v_cvt_pk_bf16_f32 v78, v236, v237
    v_cvt_pk_bf16_f32 v79, v238, v239
    v_mfma_f32_32x32x16_bf16 v[128:143], v[64:67], a[228:231], v[128:143]
    ds_read_b64_tr_b16 v[62:63], v7 offset:17664
    buffer_store_dwordx4 v[76:79], v3, s[4:7], s47 offen offset:512 sc1
    v_mfma_f32_32x32x16_bf16 v[96:111], v[68:71], a[232:235], v[96:111]
    ds_read_b64_tr_b16 v[64:65], v7 offset:18432
    v_add_f32 v202, 0x358637bd, v202
    v_rcp_f32 v202, v202
    v_nop
    v_mul_f32 v192, v192, v202
    v_mfma_f32_32x32x16_bf16 v[128:143], v[68:71], a[236:239], v[128:143]
    ds_read_b64_tr_b16 v[66:67], v7 offset:18688
    v_mul_f32 v193, v193, v202
    v_mul_f32 v194, v194, v202
    v_mul_f32 v195, v195, v202
    v_mul_f32 v196, v196, v202
    s_waitcnt lgkmcnt(6)
    v_mfma_f32_32x32x16_bf16 v[96:111], v[48:51], a[240:243], v[96:111]
    ds_read_b64_tr_b16 v[68:69], v7 offset:19456
    v_mul_f32 v197, v197, v202
    v_mul_f32 v198, v198, v202
    v_mul_f32 v199, v199, v202
    v_mul_f32 v200, v200, v202
    v_mul_f32 v201, v201, v202
    v_mfma_f32_32x32x16_bf16 v[128:143], v[48:51], a[244:247], v[128:143]
    ds_read_b64_tr_b16 v[70:71], v7 offset:19712
    v_cvt_pk_bf16_f32 v204, v192, v193
    v_cvt_pk_bf16_f32 v205, v194, v195
    v_cvt_pk_bf16_f32 v206, v196, v197
    v_cvt_pk_bf16_f32 v207, v198, v199
    v_mfma_f32_32x32x16_bf16 v[96:111], v[52:55], a[248:251], v[96:111]
    s_barrier
    ds_read_b64_tr_b16 v[48:49], v6 offset:8192
    s_add_u32 m0, s26, 65536
    s_add_u32 s34, s16, 40960
    buffer_load_dwordx4 v1, s[4:7], s34 offen sc1 lds
    v_mfma_f32_32x32x16_bf16 v[128:143], v[52:55], a[252:255], v[128:143]
    ds_read_b64_tr_b16 v[50:51], v6 offset:8448
    v_cvt_pk_bf16_f32 v203, v200, v201
    s_waitcnt lgkmcnt(6)
    v_mfma_f32_32x32x16_bf16 v[96:111], v[56:59], v[16:19], v[96:111]
    ds_read_b64_tr_b16 v[52:53], v6 offset:9216
    buffer_store_dwordx4 v[204:207], v3, s[4:7], s51 offen sc1
    v_mfma_f32_32x32x16_bf16 v[128:143], v[56:59], v[20:23], v[128:143]
    ds_read_b64_tr_b16 v[54:55], v6 offset:9472
    v_mfma_f32_32x32x16_bf16 v[96:111], v[60:63], v[24:27], v[96:111]
    ds_read_b64_tr_b16 v[56:57], v6 offset:10240
    buffer_store_dword v203, v4, s[4:7], s53 offen sc1
    v_add_f32 v218, 0x358637bd, v218
    v_rcp_f32 v218, v218
    v_mfma_f32_32x32x16_bf16 v[128:143], v[60:63], v[28:31], v[128:143]
    ds_read_b64_tr_b16 v[58:59], v6 offset:10496
    v_nop
    v_mul_f32 v208, v208, v218
    v_mul_f32 v209, v209, v218
    v_mul_f32 v210, v210, v218
    s_waitcnt lgkmcnt(6)
    v_mfma_f32_32x32x16_bf16 v[96:111], v[64:67], v[32:35], v[96:111]
    ds_read_b64_tr_b16 v[60:61], v6 offset:11264
    s_add_u32 s36, s67, 3
    v_subrev_u32 v92, s36, v92
    v_cmp_gt_u32 vcc, 8, v92
    s_nop 1
    s_andn2_b64 vcc, s[72:73], vcc
    s_cbranch_scc1 L1_o_spin
L1_o_back:
    v_mfma_f32_32x32x16_bf16 v[128:143], v[64:67], v[36:39], v[128:143]
    ds_read_b64_tr_b16 v[62:63], v6 offset:11520
    v_mul_f32 v211, v211, v218
    v_mul_f32 v212, v212, v218
    v_mul_f32 v213, v213, v218
    v_mul_f32 v214, v214, v218
    v_mul_f32 v215, v215, v218
    v_mfma_f32_32x32x16_bf16 v[96:111], v[68:71], v[40:43], v[96:111]
    ds_read_b64_tr_b16 v[64:65], v6 offset:49152
    buffer_load_dwordx4 v1, s[4:7], s34 offen offset:1024 sc1 lds
    v_mul_f32 v216, v216, v218
    v_mul_f32 v217, v217, v218
    v_cvt_pk_bf16_f32 v220, v208, v209
    v_mfma_f32_32x32x16_bf16 v[128:143], v[68:71], v[44:47], v[128:143]
    ds_read_b64_tr_b16 v[66:67], v6 offset:49408
    v_cvt_pk_bf16_f32 v221, v210, v211
    v_cvt_pk_bf16_f32 v222, v212, v213
    v_cvt_pk_bf16_f32 v223, v214, v215
    s_waitcnt lgkmcnt(6)
    v_mfma_f32_32x32x16_bf16 v[160:175], v[48:51], a[0:3], 0
    ds_read_b64_tr_b16 v[68:69], v6 offset:50176
    v_cvt_pk_bf16_f32 v219, v216, v217
    v_mfma_f32_32x32x16_bf16 v[176:191], v[48:51], a[4:7], 0
    ds_read_b64_tr_b16 v[70:71], v6 offset:50432
    s_add_u32 s36, s30, 0
    s_add_u32 s37, s33, 0
    v_mfma_f32_32x32x16_bf16 v[160:175], v[52:55], a[8:11], v[160:175]
    ds_read_b64_tr_b16 v[48:49], v6 offset:51200
    buffer_load_dwordx4 a[0:3], v1, s[4:7], s36 offen offset:0 sc1
    v_mfma_f32_32x32x16_bf16 v[176:191], v[52:55], a[12:15], v[176:191]
    ds_read_b64_tr_b16 v[50:51], v6 offset:51456
    buffer_store_dwordx4 v[220:223], v3, s[4:7], s52 offen sc1
    s_waitcnt lgkmcnt(6)
    v_mfma_f32_32x32x16_bf16 v[160:175], v[56:59], a[16:19], v[160:175]
    ds_read_b64_tr_b16 v[52:53], v6 offset:52224
    v_mfma_f32_32x32x16_bf16 v[176:191], v[56:59], a[20:23], v[176:191]
    ds_read_b64_tr_b16 v[54:55], v6 offset:52480
    buffer_store_dword v219, v4, s[4:7], s54 offen sc1
    v_mul_f32 v80, s62, v240
    v_mul_f32 v81, s62, v241
    v_mul_f32 v82, s62, v242
    v_mfma_f32_32x32x16_bf16 v[160:175], v[60:63], a[24:27], v[160:175]
    ds_read_b64_tr_b16 v[56:57], v8 offset:32768
    v_mul_f32 v83, s62, v243
    v_exp_f32 v80, v80
    v_mul_f32 v248, v240, v248
    v_mfma_f32_32x32x16_bf16 v[176:191], v[60:63], a[28:31], v[176:191]
    ds_read_b64_tr_b16 v[58:59], v8 offset:33024
    v_exp_f32 v81, v81
    v_mul_f32 v249, v241, v249
    s_waitcnt lgkmcnt(6)
    v_mfma_f32_32x32x16_bf16 v[160:175], v[64:67], a[32:35], v[160:175]
    ds_read_b64_tr_b16 v[60:61], v8 offset:33792
    v_exp_f32 v82, v82
    v_mul_f32 v250, v242, v250
    v_exp_f32 v83, v83
    v_mfma_f32_32x32x16_bf16 v[176:191], v[64:67], a[36:39], v[176:191]
    ds_read_b64_tr_b16 v[62:63], v8 offset:34048
    buffer_load_dwordx4 a[4:7], v1, s[4:7], s37 offen offset:0 sc1
    v_mul_f32 v251, v243, v251
    v_add_f32 v80, 1.0, v80
    v_add_f32 v81, 1.0, v81
    v_mfma_f32_32x32x16_bf16 v[160:175], v[68:71], a[40:43], v[160:175]
    ds_read_b64_tr_b16 v[64:65], v8 offset:34816
    v_add_f32 v82, 1.0, v82
    v_add_f32 v83, 1.0, v83
    v_rcp_f32 v80, v80
    v_mfma_f32_32x32x16_bf16 v[176:191], v[68:71], a[44:47], v[176:191]
    ds_read_b64_tr_b16 v[66:67], v8 offset:35072
    v_rcp_f32 v81, v81
    v_rcp_f32 v82, v82
    s_waitcnt lgkmcnt(6)
    v_mfma_f32_32x32x16_bf16 v[160:175], v[48:51], a[48:51], v[160:175]
    ds_read_b64_tr_b16 v[68:69], v8 offset:35840
    v_rcp_f32 v83, v83
    v_mul_f32 v248, v248, v80
    v_mul_f32 v249, v249, v81
    v_mul_f32 v250, v250, v82
    v_mfma_f32_32x32x16_bf16 v[176:191], v[48:51], a[52:55], v[176:191]
    ds_read_b64_tr_b16 v[70:71], v8 offset:36096
    buffer_load_dwordx4 a[8:11], v1, s[4:7], s36 offen offset:1024 sc1
    v_mul_f32 v251, v251, v83
    v_cvt_pk_bf16_f32 v72, v248, v249
    v_cvt_pk_bf16_f32 v73, v250, v251
    v_mfma_f32_32x32x16_bf16 v[160:175], v[52:55], a[56:59], v[160:175]
    s_barrier
    ds_read_b64_tr_b16 v[48:49], v6 offset:57344
    v_mul_f32 v80, s62, v244
    v_mul_f32 v81, s62, v245
    v_mul_f32 v82, s62, v246
    v_mfma_f32_32x32x16_bf16 v[176:191], v[52:55], a[60:63], v[176:191]
    ds_read_b64_tr_b16 v[50:51], v6 offset:57600
    v_mul_f32 v83, s62, v247
    v_exp_f32 v80, v80
    v_mul_f32 v252, v244, v252
    s_waitcnt lgkmcnt(6)
    v_mfma_f32_32x32x16_bf16 v[160:175], v[56:59], a[64:67], v[160:175]
    ds_read_b64_tr_b16 v[52:53], v6 offset:58368
    v_exp_f32 v81, v81
    v_mul_f32 v253, v245, v253
    v_exp_f32 v82, v82
    v_mfma_f32_32x32x16_bf16 v[176:191], v[56:59], a[68:71], v[176:191]
    ds_read_b64_tr_b16 v[54:55], v6 offset:58624
    buffer_load_dwordx4 a[12:15], v1, s[4:7], s37 offen offset:1024 sc1
    v_mul_f32 v254, v246, v254
    v_exp_f32 v83, v83
    v_mfma_f32_32x32x16_bf16 v[160:175], v[60:63], a[72:75], v[160:175]
    ds_read_b64_tr_b16 v[56:57], v6 offset:59392
    v_mul_f32 v255, v247, v255
    v_add_f32 v80, 1.0, v80
    v_add_f32 v81, 1.0, v81
    v_add_f32 v82, 1.0, v82
    v_add_f32 v83, 1.0, v83
    v_mfma_f32_32x32x16_bf16 v[176:191], v[60:63], a[76:79], v[176:191]
    ds_read_b64_tr_b16 v[58:59], v6 offset:59648
    v_rcp_f32 v80, v80
    v_rcp_f32 v81, v81
    s_waitcnt lgkmcnt(6)
    v_mfma_f32_32x32x16_bf16 v[160:175], v[64:67], a[80:83], v[160:175]
    ds_read_b64_tr_b16 v[60:61], v6 offset:60416
    v_rcp_f32 v82, v82
    v_rcp_f32 v83, v83
    v_mul_f32 v252, v252, v80
    v_mfma_f32_32x32x16_bf16 v[176:191], v[64:67], a[84:87], v[176:191]
    ds_read_b64_tr_b16 v[62:63], v6 offset:60672
    buffer_load_dwordx4 a[16:19], v1, s[4:7], s36 offen offset:2048 sc1
    v_mul_f32 v253, v253, v81
    v_mul_f32 v254, v254, v82
    v_mul_f32 v255, v255, v83
    v_mfma_f32_32x32x16_bf16 v[160:175], v[68:71], a[88:91], v[160:175]
    ds_read_b64_tr_b16 v[64:65], v8 offset:49152
    v_cvt_pk_bf16_f32 v74, v252, v253
    v_cvt_pk_bf16_f32 v75, v254, v255
    v_mfma_f32_32x32x16_bf16 v[176:191], v[68:71], a[92:95], v[176:191]
    ds_read_b64_tr_b16 v[66:67], v8 offset:49408
    buffer_store_dwordx4 v[72:75], v3, s[4:7], s48 offen offset:512 sc1
    s_waitcnt lgkmcnt(6)
    v_mfma_f32_32x32x16_bf16 v[160:175], v[48:51], a[96:99], v[160:175]
    ds_read_b64_tr_b16 v[68:69], v8 offset:50176
    v_mul_f32 v80, s62, v96
    v_mul_f32 v81, s62, v97
    v_mul_f32 v82, s62, v98
    v_mul_f32 v83, s62, v99
    v_mfma_f32_32x32x16_bf16 v[176:191], v[48:51], a[100:103], v[176:191]
    ds_read_b64_tr_b16 v[70:71], v8 offset:50432
    v_exp_f32 v80, v80
    v_mul_f32 v104, v96, v104
    v_exp_f32 v81, v81
    v_mfma_f32_32x32x16_bf16 v[160:175], v[52:55], a[104:107], v[160:175]
    ds_read_b64_tr_b16 v[48:49], v8 offset:51200
    v_mul_f32 v105, v97, v105
    v_exp_f32 v82, v82
    v_mul_f32 v106, v98, v106
    v_mfma_f32_32x32x16_bf16 v[176:191], v[52:55], a[108:111], v[176:191]
    ds_read_b64_tr_b16 v[50:51], v8 offset:51456
    buffer_load_dwordx4 a[20:23], v1, s[4:7], s37 offen offset:2048 sc1
    v_exp_f32 v83, v83
    s_waitcnt lgkmcnt(6)
    v_mfma_f32_32x32x16_bf16 v[160:175], v[56:59], a[112:115], v[160:175]
    ds_read_b64_tr_b16 v[52:53], v8 offset:52224
    v_mul_f32 v107, v99, v107
    v_add_f32 v80, 1.0, v80
    v_add_f32 v81, 1.0, v81
    v_add_f32 v82, 1.0, v82
    v_add_f32 v83, 1.0, v83
    v_mfma_f32_32x32x16_bf16 v[176:191], v[56:59], a[116:119], v[176:191]
    ds_read_b64_tr_b16 v[54:55], v8 offset:52480
    v_rcp_f32 v80, v80
    v_rcp_f32 v81, v81
    v_mfma_f32_32x32x16_bf16 v[160:175], v[60:63], a[120:123], v[160:175]
    ds_read_b64_tr_b16 v[56:57], v10 offset:24576
    v_rcp_f32 v82, v82
    v_rcp_f32 v83, v83
    v_mul_f32 v104, v104, v80
    v_mfma_f32_32x32x16_bf16 v[176:191], v[60:63], a[124:127], v[176:191]
    ds_read_b64_tr_b16 v[58:59], v10 offset:24832
    buffer_load_dwordx4 a[24:27], v1, s[4:7], s36 offen offset:3072 sc1
    v_mul_f32 v105, v105, v81
    v_mul_f32 v106, v106, v82
    s_waitcnt lgkmcnt(6)
    v_mfma_f32_32x32x16_bf16 v[160:175], v[64:67], a[128:131], v[160:175]
    ds_read_b64_tr_b16 v[60:61], v10 offset:25600
    v_mul_f32 v107, v107, v83
    v_cvt_pk_bf16_f32 v76, v104, v105
    v_cvt_pk_bf16_f32 v77, v106, v107
    v_mul_f32 v80, s62, v100
    v_mul_f32 v81, s62, v101
    v_mfma_f32_32x32x16_bf16 v[176:191], v[64:67], a[132:135], v[176:191]
    ds_read_b64_tr_b16 v[62:63], v10 offset:25856
    v_mul_f32 v82, s62, v102
    v_mul_f32 v83, s62, v103
    v_exp_f32 v80, v80
    v_mul_f32 v108, v100, v108
    v_mfma_f32_32x32x16_bf16 v[160:175], v[68:71], a[136:139], v[160:175]
    ds_read_b64_tr_b16 v[64:65], v10 offset:26624
    v_exp_f32 v81, v81
    v_mul_f32 v109, v101, v109
    v_exp_f32 v82, v82
    v_mfma_f32_32x32x16_bf16 v[176:191], v[68:71], a[140:143], v[176:191]
    ds_read_b64_tr_b16 v[66:67], v10 offset:26880
    buffer_load_dwordx4 a[28:31], v1, s[4:7], s37 offen offset:3072 sc1
    s_add_u32 s36, s30, 4096
    s_add_u32 s37, s33, 4096
    s_waitcnt lgkmcnt(6)
    v_mfma_f32_32x32x16_bf16 v[160:175], v[48:51], a[144:147], v[160:175]
    ds_read_b64_tr_b16 v[68:69], v10 offset:27648
    v_mul_f32 v110, v102, v110
    v_exp_f32 v83, v83
    v_mul_f32 v111, v103, v111
    v_add_f32 v80, 1.0, v80
    v_mfma_f32_32x32x16_bf16 v[176:191], v[48:51], a[148:151], v[176:191]
    ds_read_b64_tr_b16 v[70:71], v10 offset:27904
    v_add_f32 v81, 1.0, v81
    v_add_f32 v82, 1.0, v82
    v_add_f32 v83, 1.0, v83
    v_rcp_f32 v80, v80
    v_mfma_f32_32x32x16_bf16 v[160:175], v[52:55], a[152:155], v[160:175]
    s_barrier
    ds_read_b64_tr_b16 v[48:49], v8 offset:8192
    v_rcp_f32 v81, v81
    v_mfma_f32_32x32x16_bf16 v[176:191], v[52:55], a[156:159], v[176:191]
    ds_read_b64_tr_b16 v[50:51], v8 offset:8448
    buffer_load_dwordx4 a[32:35], v1, s[4:7], s36 offen offset:0 sc1
    v_rcp_f32 v82, v82
    s_waitcnt lgkmcnt(6)
    v_mfma_f32_32x32x16_bf16 v[160:175], v[56:59], a[160:163], v[160:175]
    ds_read_b64_tr_b16 v[52:53], v8 offset:9216
    v_rcp_f32 v83, v83
    v_mul_f32 v108, v108, v80
    v_mul_f32 v109, v109, v81
    v_mul_f32 v110, v110, v82
    v_mfma_f32_32x32x16_bf16 v[176:191], v[56:59], a[164:167], v[176:191]
    ds_read_b64_tr_b16 v[54:55], v8 offset:9472
    v_mul_f32 v111, v111, v83
    v_cvt_pk_bf16_f32 v78, v108, v109
    v_cvt_pk_bf16_f32 v79, v110, v111
    v_mfma_f32_32x32x16_bf16 v[160:175], v[60:63], a[168:171], v[160:175]
    ds_read_b64_tr_b16 v[56:57], v8 offset:10240
    buffer_store_dwordx4 v[76:79], v3, s[4:7], s49 offen offset:0 sc1
    v_mfma_f32_32x32x16_bf16 v[176:191], v[60:63], a[172:175], v[176:191]
    ds_read_b64_tr_b16 v[58:59], v8 offset:10496
    v_mul_f32 v80, s62, v128
    v_mul_f32 v81, s62, v129
    v_mul_f32 v82, s62, v130
    v_mul_f32 v83, s62, v131
    s_waitcnt lgkmcnt(6)
    v_mfma_f32_32x32x16_bf16 v[160:175], v[64:67], a[176:179], v[160:175]
    ds_read_b64_tr_b16 v[60:61], v8 offset:11264
    v_exp_f32 v80, v80
    v_mul_f32 v136, v128, v136
    v_exp_f32 v81, v81
    v_mfma_f32_32x32x16_bf16 v[176:191], v[64:67], a[180:183], v[176:191]
    ds_read_b64_tr_b16 v[62:63], v8 offset:11520
    v_mul_f32 v137, v129, v137
    v_exp_f32 v82, v82
    v_mul_f32 v138, v130, v138
    v_mfma_f32_32x32x16_bf16 v[160:175], v[68:71], a[184:187], v[160:175]
    ds_read_b64_tr_b16 v[64:65], v6 offset:32768
    buffer_load_dwordx4 a[36:39], v1, s[4:7], s37 offen offset:0 sc1
    v_exp_f32 v83, v83
    v_mul_f32 v139, v131, v139
    v_mfma_f32_32x32x16_bf16 v[176:191], v[68:71], a[188:191], v[176:191]
    ds_read_b64_tr_b16 v[66:67], v6 offset:33024
    v_add_f32 v80, 1.0, v80
    v_add_f32 v81, 1.0, v81
    v_add_f32 v82, 1.0, v82
    v_add_f32 v83, 1.0, v83
    s_waitcnt lgkmcnt(6)
    v_mfma_f32_32x32x16_bf16 v[160:175], v[48:51], a[192:195], v[160:175]
    ds_read_b64_tr_b16 v[68:69], v6 offset:33792
    v_rcp_f32 v80, v80
    v_rcp_f32 v81, v81
    v_mfma_f32_32x32x16_bf16 v[176:191], v[48:51], a[196:199], v[176:191]
    ds_read_b64_tr_b16 v[70:71], v6 offset:34048
    v_rcp_f32 v82, v82
    v_rcp_f32 v83, v83
    v_mul_f32 v136, v136, v80
    v_mfma_f32_32x32x16_bf16 v[160:175], v[52:55], a[200:203], v[160:175]
    ds_read_b64_tr_b16 v[48:49], v6 offset:34816
    buffer_load_dwordx4 a[40:43], v1, s[4:7], s36 offen offset:1024 sc1
    v_mul_f32 v137, v137, v81
    v_mul_f32 v138, v138, v82
    v_mul_f32 v139, v139, v83
    v_mfma_f32_32x32x16_bf16 v[176:191], v[52:55], a[204:207], v[176:191]
    ds_read_b64_tr_b16 v[50:51], v6 offset:35072
    v_cvt_pk_bf16_f32 v72, v136, v137
    v_cvt_pk_bf16_f32 v73, v138, v139
    v_mul_f32 v80, s62, v132
    v_mul_f32 v81, s62, v133
    s_waitcnt lgkmcnt(6)
    v_mfma_f32_32x32x16_bf16 v[160:175], v[56:59], a[208:211], v[160:175]
    ds_read_b64_tr_b16 v[52:53], v6 offset:35840
    v_mul_f32 v82, s62, v134
    v_mul_f32 v83, s62, v135
    v_exp_f32 v80, v80
    v_mul_f32 v140, v132, v140
    v_mfma_f32_32x32x16_bf16 v[176:191], v[56:59], a[212:215], v[176:191]
    ds_read_b64_tr_b16 v[54:55], v6 offset:36096
    v_exp_f32 v81, v81
    v_mul_f32 v141, v133, v141
    v_exp_f32 v82, v82
    v_mfma_f32_32x32x16_bf16 v[160:175], v[60:63], a[216:219], v[160:175]
    ds_read_b64_tr_b16 v[56:57], v8 offset:16384
    buffer_load_dwordx4 a[44:47], v1, s[4:7], s37 offen offset:1024 sc1
    v_mul_f32 v142, v134, v142
    v_exp_f32 v83, v83
    v_mfma_f32_32x32x16_bf16 v[176:191], v[60:63], a[220:223], v[176:191]
    ds_read_b64_tr_b16 v[58:59], v8 offset:16640
    v_mul_f32 v143, v135, v143
    v_add_f32 v80, 1.0, v80
    v_add_f32 v81, 1.0, v81
    v_add_f32 v82, 1.0, v82
    s_waitcnt lgkmcnt(6)
    v_mfma_f32_32x32x16_bf16 v[160:175], v[64:67], a[224:227], v[160:175]
    ds_read_b64_tr_b16 v[60:61], v8 offset:17408
    v_add_f32 v83, 1.0, v83
    v_rcp_f32 v80, v80
    v_rcp_f32 v81, v81
    v_mfma_f32_32x32x16_bf16 v[176:191], v[64:67], a[228:231], v[176:191]
    ds_read_b64_tr_b16 v[62:63], v8 offset:17664
    v_rcp_f32 v82, v82
    v_rcp_f32 v83, v83
    v_mul_f32 v140, v140, v80
    v_mfma_f32_32x32x16_bf16 v[160:175], v[68:71], a[232:235], v[160:175]
    ds_read_b64_tr_b16 v[64:65], v8 offset:18432
    s_add_u32 m0, s26, 122880
    s_add_u32 s34, s19, 16384
    buffer_load_dwordx4 v1, s[4:7], s34 offen sc1 lds
    v_mul_f32 v141, v141, v81
    v_mfma_f32_32x32x16_bf16 v[176:191], v[68:71], a[236:239], v[176:191]
    ds_read_b64_tr_b16 v[66:67], v8 offset:18688
    v_mul_f32 v142, v142, v82
    v_mul_f32 v143, v143, v83
    v_cvt_pk_bf16_f32 v74, v140, v141
    v_cvt_pk_bf16_f32 v75, v142, v143
    s_waitcnt lgkmcnt(6)
    v_mfma_f32_32x32x16_bf16 v[160:175], v[48:51], a[240:243], v[160:175]
    ds_read_b64_tr_b16 v[68:69], v8 offset:19456
    buffer_store_dwordx4 v[72:75], v3, s[4:7], s50 offen offset:0 sc1
    v_mfma_f32_32x32x16_bf16 v[176:191], v[48:51], a[244:247], v[176:191]
    ds_read_b64_tr_b16 v[70:71], v8 offset:19712
    v_mfma_f32_32x32x16_bf16 v[160:175], v[52:55], a[248:251], v[160:175]
    s_waitcnt vmcnt(32)
    s_barrier
    ds_read_b128 v[48:51], v12 offset:16384
    v_mfma_f32_32x32x16_bf16 v[176:191], v[52:55], a[252:255], v[176:191]
    s_waitcnt lgkmcnt(5)
    v_mfma_f32_32x32x16_bf16 v[160:175], v[56:59], v[16:19], v[160:175]
    ds_read_b128 v[52:55], v12 offset:17408
    buffer_load_dwordx4 v1, s[4:7], s34 offen offset:1024 sc1 lds
    v_mov_b32 v15, s67
    v_add_u32 v15, 5, v15
    v_mfma_f32_32x32x16_bf16 v[176:191], v[56:59], v[20:23], v[176:191]
    s_waitcnt vmcnt(11)
    s_mov_b64 exec, 1
    buffer_store_dword v15, off, s[4:7], s60 sc1
    s_mov_b64 exec, -1
    v_mfma_f32_32x32x16_bf16 v[160:175], v[60:63], v[24:27], v[160:175]
    ds_read_b128 v[56:59], v12 offset:18432
    v_mfma_f32_32x32x16_bf16 v[176:191], v[60:63], v[28:31], v[176:191]
    s_waitcnt lgkmcnt(3)
    v_mfma_f32_32x32x16_bf16 v[160:175], v[64:67], v[32:35], v[160:175]
    ds_read_b128 v[60:63], v12 offset:19456
    v_mfma_f32_32x32x16_bf16 v[176:191], v[64:67], v[36:39], v[176:191]
    s_add_u32 m0, s26, 131072
    s_add_u32 s34, s16, 49152
    buffer_load_dwordx4 v1, s[4:7], s34 offen sc1 lds
    v_mfma_f32_32x32x16_bf16 v[160:175], v[68:71], v[40:43], v[160:175]
    ds_read_b128 v[64:67], v12 offset:20480
    v_mfma_f32_32x32x16_bf16 v[176:191], v[68:71], v[44:47], v[176:191]
    s_waitcnt lgkmcnt(3)
    v_mfma_f32_16x16x32_bf16 v[192:195], v[48:51], a[0:3], 0
    ds_read_b128 v[68:71], v1 offset:0
    buffer_load_dwordx4 v1, s[4:7], s34 offen offset:1024 sc1 lds
    v_mfma_f32_16x16x32_bf16 v[196:199], v[48:51], a[4:7], 0
    s_nop 4
    v_mul_f32 v80, s62, v160
    v_mul_f32 v81, s62, v161
    v_mul_f32 v82, s62, v162
    v_mul_f32 v83, s62, v163
    v_mfma_f32_16x16x32_bf16 v[200:203], v[52:55], a[0:3], 0
    ds_read_b128 v[48:51], v1 offset:1024
    v_exp_f32 v80, v80
    v_mul_f32 v168, v160, v168
    v_mfma_f32_16x16x32_bf16 v[204:207], v[52:55], a[4:7], 0
    s_add_u32 m0, s26, 139264
    s_add_u32 s34, s16, 57344
    buffer_load_dwordx4 v1, s[4:7], s34 offen sc1 lds
    s_waitcnt lgkmcnt(3)
    v_mfma_f32_16x16x32_bf16 v[208:211], v[56:59], a[0:3], 0
    ds_read_b128 v[52:55], v12 offset:21504
    v_exp_f32 v81, v81
    v_mul_f32 v169, v161, v169
    v_mfma_f32_16x16x32_bf16 v[212:215], v[56:59], a[4:7], 0
    v_exp_f32 v82, v82
    v_mul_f32 v170, v162, v170
    v_exp_f32 v83, v83
    v_mfma_f32_16x16x32_bf16 v[216:219], v[60:63], a[0:3], 0
    ds_read_b128 v[56:59], v12 offset:22528
    buffer_load_dwordx4 v1, s[4:7], s34 offen offset:1024 sc1 lds
    v_mul_f32 v171, v163, v171
    v_add_f32 v80, 1.0, v80
    v_mfma_f32_16x16x32_bf16 v[220:223], v[60:63], a[4:7], 0
    v_add_f32 v81, 1.0, v81
    v_add_f32 v82, 1.0, v82
    v_add_f32 v83, 1.0, v83
    s_waitcnt lgkmcnt(3)
    v_mfma_f32_16x16x32_bf16 v[224:227], v[64:67], a[0:3], 0
    ds_read_b128 v[60:63], v12 offset:23552
    v_rcp_f32 v80, v80
    v_rcp_f32 v81, v81
    v_mfma_f32_16x16x32_bf16 v[228:231], v[64:67], a[4:7], 0
    s_add_u32 m0, s26, 8192
    s_add_u32 s34, s16, 65536
    buffer_load_dwordx4 v1, s[4:7], s34 offen sc1 lds
    v_mfma_f32_16x16x32_bf16 v[144:147], v[68:71], a[0:3], 0
    ds_read_b128 v[64:67], v1 offset:16384
    v_rcp_f32 v82, v82
    v_rcp_f32 v83, v83
    v_mfma_f32_16x16x32_bf16 v[148:151], v[68:71], a[4:7], 0
    v_mul_f32 v168, v168, v80
    v_mul_f32 v169, v169, v81
    v_mul_f32 v170, v170, v82
    s_waitcnt lgkmcnt(3)
    v_mfma_f32_16x16x32_bf16 v[152:155], v[48:51], a[0:3], 0
    ds_read_b128 v[68:71], v1 offset:17408
    buffer_load_dwordx4 v1, s[4:7], s34 offen offset:1024 sc1 lds
    v_mul_f32 v171, v171, v83
    v_cvt_pk_bf16_f32 v76, v168, v169
    v_mfma_f32_16x16x32_bf16 v[156:159], v[48:51], a[4:7], 0
    v_cvt_pk_bf16_f32 v77, v170, v171
    v_mul_f32 v80, s62, v164
    v_mul_f32 v81, s62, v165
    v_mul_f32 v82, s62, v166
    v_mfma_f32_16x16x32_bf16 v[192:195], v[52:55], a[8:11], v[192:195]
    ds_read_b128 v[48:51], v1 offset:2048
    v_mul_f32 v83, s62, v167
    v_exp_f32 v80, v80
    v_mul_f32 v172, v164, v172
    v_mfma_f32_16x16x32_bf16 v[196:199], v[52:55], a[12:15], v[196:199]
    buffer_load_dwordx4 a[48:51], v1, s[4:7], s36 offen offset:2048 sc1
    v_exp_f32 v81, v81
    s_waitcnt lgkmcnt(3)
    v_mfma_f32_16x16x32_bf16 v[200:203], v[56:59], a[8:11], v[200:203]
    ds_read_b128 v[52:55], v1 offset:3072
    v_mul_f32 v173, v165, v173
    v_exp_f32 v82, v82
    v_mul_f32 v174, v166, v174
    v_mfma_f32_16x16x32_bf16 v[204:207], v[56:59], a[12:15], v[204:207]
    v_exp_f32 v83, v83
    v_mul_f32 v175, v167, v175
    v_add_f32 v80, 1.0, v80
    v_add_f32 v81, 1.0, v81
    v_mfma_f32_16x16x32_bf16 v[208:211], v[60:63], a[8:11], v[208:211]
    ds_read_b128 v[56:59], v1 offset:18432
    buffer_load_dwordx4 a[52:55], v1, s[4:7], s37 offen offset:2048 sc1
    v_add_f32 v82, 1.0, v82
    v_add_f32 v83, 1.0, v83
    v_mfma_f32_16x16x32_bf16 v[212:215], v[60:63], a[12:15], v[212:215]
    v_rcp_f32 v80, v80
    v_rcp_f32 v81, v81
    s_waitcnt lgkmcnt(3)
    v_mfma_f32_16x16x32_bf16 v[216:219], v[64:67], a[8:11], v[216:219]
    ds_read_b128 v[60:63], v1 offset:19456
    v_rcp_f32 v82, v82
    v_rcp_f32 v83, v83
    v_mfma_f32_16x16x32_bf16 v[220:223], v[64:67], a[12:15], v[220:223]
    s_add_u32 m0, s26, 49152
    s_add_u32 s34, s19, 24576
    buffer_load_dwordx4 v1, s[4:7], s34 offen sc1 lds
    v_mul_f32 v172, v172, v80
    v_mfma_f32_16x16x32_bf16 v[224:227], v[68:71], a[8:11], v[224:227]
    ds_read_b128 v[64:67], v1 offset:20480
    v_mul_f32 v173, v173, v81
    v_mul_f32 v174, v174, v82
    v_mul_f32 v175, v175, v83
    v_mfma_f32_16x16x32_bf16 v[228:231], v[68:71], a[12:15], v[228:231]
    v_cvt_pk_bf16_f32 v78, v172, v173
    v_cvt_pk_bf16_f32 v79, v174, v175
    s_waitcnt lgkmcnt(3)
    v_mfma_f32_16x16x32_bf16 v[144:147], v[48:51], a[8:11], v[144:147]
    ds_read_b128 v[68:71], v1 offset:21504
    buffer_load_dwordx4 v1, s[4:7], s34 offen offset:1024 sc1 lds
    v_mfma_f32_16x16x32_bf16 v[148:151], v[48:51], a[12:15], v[148:151]
    buffer_store_dwordx4 v[76:79], v3, s[4:7], s49 offen offset:512 sc1
    v_mfma_f32_16x16x32_bf16 v[152:155], v[52:55], a[8:11], v[152:155]
    ds_read_b128 v[48:51], v1 offset:22528
    v_mul_f32 v80, s62, v176
    v_mul_f32 v81, s62, v177
    v_mul_f32 v82, s62, v178
    v_mfma_f32_16x16x32_bf16 v[156:159], v[52:55], a[12:15], v[156:159]
    v_mul_f32 v83, s62, v179
    v_exp_f32 v80, v80
    v_mul_f32 v184, v176, v184
    s_waitcnt lgkmcnt(3)
    v_mfma_f32_16x16x32_bf16 v[192:195], v[56:59], a[16:19], v[192:195]
    ds_read_b128 v[52:55], v1 offset:4096
    buffer_load_dwordx4 a[56:59], v1, s[4:7], s36 offen offset:3072 sc1
    v_exp_f32 v81, v81
    s_waitcnt vmcnt(23)
    v_mfma_f32_16x16x32_bf16 v[196:199], v[56:59], a[20:23], v[196:199]
    v_mul_f32 v185, v177, v185
    v_exp_f32 v82, v82
    v_mul_f32 v186, v178, v186
    v_mfma_f32_16x16x32_bf16 v[200:203], v[60:63], a[16:19], v[200:203]
    ds_read_b128 v[56:59], v1 offset:5120
    v_exp_f32 v83, v83
    v_mul_f32 v187, v179, v187
    v_add_f32 v80, 1.0, v80
    v_mfma_f32_16x16x32_bf16 v[204:207], v[60:63], a[20:23], v[204:207]
    buffer_load_dwordx4 a[60:63], v1, s[4:7], s37 offen offset:3072 sc1
    v_add_f32 v81, 1.0, v81
    v_add_f32 v82, 1.0, v82
    s_waitcnt lgkmcnt(3)
    v_mfma_f32_16x16x32_bf16 v[208:211], v[64:67], a[16:19], v[208:211]
    ds_read_b128 v[60:63], v1 offset:23552
    v_add_f32 v83, 1.0, v83
    v_rcp_f32 v80, v80
    v_mfma_f32_16x16x32_bf16 v[212:215], v[64:67], a[20:23], v[212:215]
    v_rcp_f32 v81, v81
    v_rcp_f32 v82, v82
    v_mfma_f32_16x16x32_bf16 v[216:219], v[68:71], a[16:19], v[216:219]
    ds_read_b128 v[64:67], v1 offset:24576
    s_add_u32 m0, s26, 155648
    s_add_u32 s34, s16, 73728
    buffer_load_dwordx4 v1, s[4:7], s34 offen sc1 lds
    v_mfma_f32_16x16x32_bf16 v[220:223], v[68:71], a[20:23], v[220:223]
    v_rcp_f32 v83, v83
    v_mul_f32 v184, v184, v80
    v_mul_f32 v185, v185, v81
    s_waitcnt lgkmcnt(3)
    v_mfma_f32_16x16x32_bf16 v[224:227], v[48:51], a[16:19], v[224:227]
    ds_read_b128 v[68:71], v1 offset:25600
    v_mul_f32 v186, v186, v82
    v_mul_f32 v187, v187, v83
    v_cvt_pk_bf16_f32 v72, v184, v185
    v_mfma_f32_16x16x32_bf16 v[228:231], v[48:51], a[20:23], v[228:231]
    buffer_load_dwordx4 v1, s[4:7], s34 offen offset:1024 sc1 lds
    v_cvt_pk_bf16_f32 v73, v186, v187
    v_mul_f32 v80, s62, v180
    v_mul_f32 v81, s62, v181
    v_mfma_f32_16x16x32_bf16 v[144:147], v[52:55], a[16:19], v[144:147]
    s_barrier
    ds_read_b128 v[48:51], v1 offset:26624
    v_mul_f32 v82, s62, v182
    v_mfma_f32_16x16x32_bf16 v[148:151], v[52:55], a[20:23], v[148:151]
    v_mul_f32 v83, s62, v183
    v_exp_f32 v80, v80
    v_mul_f32 v188, v180, v188
    s_waitcnt lgkmcnt(3)
    v_mfma_f32_16x16x32_bf16 v[152:155], v[56:59], a[16:19], v[152:155]
    ds_read_b128 v[52:55], v1 offset:27648
    s_add_u32 m0, s26, 57344
    s_add_u32 s34, s16, 81920
    buffer_load_dwordx4 v1, s[4:7], s34 offen sc1 lds
    v_mfma_f32_16x16x32_bf16 v[156:159], v[56:59], a[20:23], v[156:159]
    v_exp_f32 v81, v81
    v_mul_f32 v189, v181, v189
    v_exp_f32 v82, v82
    s_waitcnt vmcnt(26)
    v_mfma_f32_16x16x32_bf16 v[192:195], v[60:63], a[24:27], v[192:195]
    ds_read_b128 v[56:59], v1 offset:6144
    s_add_u32 s36, s30, 8192
    s_add_u32 s37, s33, 8192
    v_mul_f32 v190, v182, v190
    s_waitcnt vmcnt(25)
    v_mfma_f32_16x16x32_bf16 v[196:199], v[60:63], a[28:31], v[196:199]
    buffer_load_dwordx4 a[64:67], v1, s[4:7], s36 offen offset:0 sc1
    v_exp_f32 v83, v83
    s_waitcnt lgkmcnt(3)
    v_mfma_f32_16x16x32_bf16 v[200:203], v[64:67], a[24:27], v[200:203]
    ds_read_b128 v[60:63], v1 offset:7168
    v_mul_f32 v191, v183, v191
    v_add_f32 v80, 1.0, v80
    v_add_f32 v81, 1.0, v81
    v_mfma_f32_16x16x32_bf16 v[204:207], v[64:67], a[28:31], v[204:207]
    v_add_f32 v82, 1.0, v82
    v_add_f32 v83, 1.0, v83
    v_rcp_f32 v80, v80
    v_mfma_f32_16x16x32_bf16 v[208:211], v[68:71], a[24:27], v[208:211]
    ds_read_b128 v[64:67], v1 offset:28672
    buffer_load_dwordx4 a[68:71], v1, s[4:7], s37 offen offset:0 sc1
    v_rcp_f32 v81, v81
    v_mfma_f32_16x16x32_bf16 v[212:215], v[68:71], a[28:31], v[212:215]
    v_rcp_f32 v82, v82
    v_rcp_f32 v83, v83
    s_waitcnt lgkmcnt(3)
    v_mfma_f32_16x16x32_bf16 v[216:219], v[48:51], a[24:27], v[216:219]
    ds_read_b128 v[68:71], v1 offset:29696
    v_mul_f32 v188, v188, v80
    v_mul_f32 v189, v189, v81
    v_mul_f32 v190, v190, v82
    v_mfma_f32_16x16x32_bf16 v[220:223], v[48:51], a[28:31], v[220:223]
    buffer_load_dwordx4 v1, s[4:7], s34 offen offset:1024 sc1 lds
    v_mul_f32 v191, v191, v83
    v_cvt_pk_bf16_f32 v74, v188, v189
    v_cvt_pk_bf16_f32 v75, v190, v191
    v_mfma_f32_16x16x32_bf16 v[224:227], v[52:55], a[24:27], v[224:227]
    ds_read_b128 v[48:51], v1 offset:30720
    buffer_store_dwordx4 v[72:75], v3, s[4:7], s50 offen offset:512 sc1
    v_mfma_f32_16x16x32_bf16 v[228:231], v[52:55], a[28:31], v[228:231]
    s_waitcnt lgkmcnt(3)
    v_mfma_f32_16x16x32_bf16 v[144:147], v[56:59], a[24:27], v[144:147]
    ds_read_b128 v[52:55], v1 offset:31744
    v_mfma_f32_16x16x32_bf16 v[148:151], v[56:59], a[28:31], v[148:151]
    s_add_u32 m0, s26, 98304
    s_add_u32 s34, s19, 32768
    buffer_load_dwordx4 v1, s[4:7], s34 offen sc1 lds
    v_mfma_f32_16x16x32_bf16 v[152:155], v[60:63], a[24:27], v[152:155]
    ds_read_b128 v[56:59], v1 offset:40960
    v_mfma_f32_16x16x32_bf16 v[156:159], v[60:63], a[28:31], v[156:159]
    s_waitcnt lgkmcnt(3)
    s_waitcnt vmcnt(29)
    v_mfma_f32_16x16x32_bf16 v[192:195], v[64:67], a[32:35], v[192:195]
    ds_read_b128 v[60:63], v11 offset:24576
    buffer_load_dwordx4 a[72:75], v1, s[4:7], s36 offen offset:1024 sc1
    s_waitcnt vmcnt(28)
    v_mfma_f32_16x16x32_bf16 v[196:199], v[64:67], a[36:39], v[196:199]
    v_mfma_f32_16x16x32_bf16 v[200:203], v[68:71], a[32:35], v[200:203]
    ds_read_b128 v[64:67], v11 offset:25600
    v_mfma_f32_16x16x32_bf16 v[204:207], v[68:71], a[36:39], v[204:207]
    buffer_load_dwordx4 a[76:79], v1, s[4:7], s37 offen offset:1024 sc1
    s_waitcnt lgkmcnt(3)
    v_mfma_f32_16x16x32_bf16 v[208:211], v[48:51], a[32:35], v[208:211]
    ds_read_b128 v[68:71], v1 offset:41984
    v_lshlrev_b32 v94, 5, v0
    s_mov_b64 exec, s[72:73]
    buffer_load_dword v94, v94, s[4:7], s23 offen sc1
    s_mov_b64 exec, -1
    v_mfma_f32_16x16x32_bf16 v[212:215], v[48:51], a[36:39], v[212:215]
    v_mfma_f32_16x16x32_bf16 v[216:219], v[52:55], a[32:35], v[216:219]
    ds_read_b128 v[48:51], v1 offset:43008
    buffer_load_dwordx4 v1, s[4:7], s34 offen offset:1024 sc1 lds
    v_mfma_f32_16x16x32_bf16 v[220:223], v[52:55], a[36:39], v[220:223]
    s_waitcnt lgkmcnt(3)
    v_mfma_f32_16x16x32_bf16 v[224:227], v[56:59], a[32:35], v[224:227]
    ds_read_b128 v[52:55], v1 offset:44032
    v_mfma_f32_16x16x32_bf16 v[228:231], v[56:59], a[36:39], v[228:231]
    s_add_u32 m0, s26, 32768
    s_add_u32 s34, s16, 90112
    buffer_load_dwordx4 v1, s[4:7], s34 offen sc1 lds
    v_mfma_f32_16x16x32_bf16 v[144:147], v[60:63], a[32:35], v[144:147]
    ds_read_b128 v[56:59], v1 offset:45056
    v_mfma_f32_16x16x32_bf16 v[148:151], v[60:63], a[36:39], v[148:151]
    s_waitcnt lgkmcnt(3)
    v_mfma_f32_16x16x32_bf16 v[152:155], v[64:67], a[32:35], v[152:155]
    ds_read_b128 v[60:63], v1 offset:46080
    buffer_load_dwordx4 v1, s[4:7], s34 offen offset:1024 sc1 lds
    v_mfma_f32_16x16x32_bf16 v[156:159], v[64:67], a[36:39], v[156:159]
    s_waitcnt vmcnt(32)
    v_mfma_f32_16x16x32_bf16 v[192:195], v[68:71], a[40:43], v[192:195]
    ds_read_b128 v[64:67], v11 offset:26624
    s_waitcnt vmcnt(31)
    v_mfma_f32_16x16x32_bf16 v[196:199], v[68:71], a[44:47], v[196:199]
    buffer_load_dwordx4 a[80:83], v1, s[4:7], s36 offen offset:2048 sc1
    s_waitcnt lgkmcnt(3)
    v_mfma_f32_16x16x32_bf16 v[200:203], v[48:51], a[40:43], v[200:203]
    ds_read_b128 v[68:71], v11 offset:27648
    v_mfma_f32_16x16x32_bf16 v[204:207], v[48:51], a[44:47], v[204:207]
    v_mfma_f32_16x16x32_bf16 v[208:211], v[52:55], a[40:43], v[208:211]
    ds_read_b128 v[48:51], v1 offset:47104
    buffer_load_dwordx4 a[84:87], v1, s[4:7], s37 offen offset:2048 sc1
    v_mfma_f32_16x16x32_bf16 v[212:215], v[52:55], a[44:47], v[212:215]
    s_waitcnt lgkmcnt(3)
    v_mfma_f32_16x16x32_bf16 v[216:219], v[56:59], a[40:43], v[216:219]
    ds_read_b128 v[52:55], v1 offset:48128
    v_mfma_f32_16x16x32_bf16 v[220:223], v[56:59], a[44:47], v[220:223]
    s_add_u32 m0, s26, 73728
    s_add_u32 s34, s16, 98304
    buffer_load_dwordx4 v1, s[4:7], s34 offen sc1 lds
    v_mfma_f32_16x16x32_bf16 v[224:227], v[60:63], a[40:43], v[224:227]
    ds_read_b128 v[56:59], v11 offset:40960
    v_mfma_f32_16x16x32_bf16 v[228:231], v[60:63], a[44:47], v[228:231]
    s_waitcnt lgkmcnt(3)
    v_mfma_f32_16x16x32_bf16 v[144:147], v[64:67], a[40:43], v[144:147]
    ds_read_b128 v[60:63], v11 offset:41984
    buffer_load_dwordx4 v1, s[4:7], s34 offen offset:1024 sc1 lds
    v_mfma_f32_16x16x32_bf16 v[148:151], v[64:67], a[44:47], v[148:151]
    v_mfma_f32_16x16x32_bf16 v[152:155], v[68:71], a[40:43], v[152:155]
    ds_read_b128 v[64:67], v11 offset:43008
    v_mfma_f32_16x16x32_bf16 v[156:159], v[68:71], a[44:47], v[156:159]
    s_waitcnt lgkmcnt(3)
    s_waitcnt vmcnt(24)
    v_mfma_f32_16x16x32_bf16 v[192:195], v[48:51], a[48:51], v[192:195]
    ds_read_b128 v[68:71], v11 offset:28672
    buffer_load_dwordx4 a[88:91], v1, s[4:7], s36 offen offset:3072 sc1
    s_waitcnt vmcnt(24)
    v_mfma_f32_16x16x32_bf16 v[196:199], v[48:51], a[52:55], v[196:199]
    v_mfma_f32_16x16x32_bf16 v[200:203], v[52:55], a[48:51], v[200:203]
    s_barrier
    ds_read_b128 v[48:51], v11 offset:29696
    v_mfma_f32_16x16x32_bf16 v[204:207], v[52:55], a[52:55], v[204:207]
    buffer_load_dwordx4 a[92:95], v1, s[4:7], s37 offen offset:3072 sc1
    s_waitcnt lgkmcnt(3)
    v_mfma_f32_16x16x32_bf16 v[208:211], v[56:59], a[48:51], v[208:211]
    ds_read_b128 v[52:55], v11 offset:44032
    s_add_u32 s36, s67, 4
    v_subrev_u32 v93, s36, v93
    v_cmp_gt_u32 vcc, 8, v93
    s_nop 1
    s_andn2_b64 vcc, s[72:73], vcc
    s_cbranch_scc1 L2_o_spin
L2_o_back:
    v_mfma_f32_16x16x32_bf16 v[212:215], v[56:59], a[52:55], v[212:215]
    v_mfma_f32_16x16x32_bf16 v[216:219], v[60:63], a[48:51], v[216:219]
    ds_read_b128 v[56:59], v11 offset:45056
    s_add_u32 m0, s26, 147456
    s_add_u32 s34, s16, 106496
    buffer_load_dwordx4 v1, s[4:7], s34 offen sc1 lds
    v_mfma_f32_16x16x32_bf16 v[220:223], v[60:63], a[52:55], v[220:223]
    s_waitcnt lgkmcnt(3)
    v_mfma_f32_16x16x32_bf16 v[224:227], v[64:67], a[48:51], v[224:227]
    ds_read_b128 v[60:63], v11 offset:46080
    v_mfma_f32_16x16x32_bf16 v[228:231], v[64:67], a[52:55], v[228:231]
    buffer_load_dwordx4 v1, s[4:7], s34 offen offset:1024 sc1 lds
    v_mfma_f32_16x16x32_bf16 v[144:147], v[68:71], a[48:51], v[144:147]
    ds_read_b128 v[64:67], v11 offset:47104
    v_mfma_f32_16x16x32_bf16 v[148:151], v[68:71], a[52:55], v[148:151]
    s_waitcnt lgkmcnt(3)
    v_mfma_f32_16x16x32_bf16 v[152:155], v[48:51], a[48:51], v[152:155]
    ds_read_b128 v[68:71], v11 offset:48128
    s_add_u32 m0, s26, 16384
    s_add_u32 s34, s19, 40960
    buffer_load_dwordx4 v1, s[4:7], s34 offen sc1 lds
    v_mfma_f32_16x16x32_bf16 v[156:159], v[48:51], a[52:55], v[156:159]
    s_waitcnt vmcnt(24)
    v_mfma_f32_16x16x32_bf16 v[192:195], v[52:55], a[56:59], v[192:195]
    ds_read_b128 v[48:51], v11 offset:30720
    s_add_u32 s36, s30, 12288
    s_waitcnt vmcnt(23)
    v_mfma_f32_16x16x32_bf16 v[196:199], v[52:55], a[60:63], v[196:199]
    s_add_u32 s37, s33, 12288
    s_waitcnt lgkmcnt(3)
    v_mfma_f32_16x16x32_bf16 v[200:203], v[56:59], a[56:59], v[200:203]
    ds_read_b128 v[52:55], v11 offset:31744
    buffer_load_dwordx4 a[96:99], v1, s[4:7], s36 offen offset:0 sc1
    v_mfma_f32_16x16x32_bf16 v[204:207], v[56:59], a[60:63], v[204:207]
    v_mfma_f32_16x16x32_bf16 v[208:211], v[60:63], a[56:59], v[208:211]
    ds_read_b128 v[56:59], v11 offset:0
    v_mfma_f32_16x16x32_bf16 v[212:215], v[60:63], a[60:63], v[212:215]
    buffer_load_dwordx4 a[100:103], v1, s[4:7], s37 offen offset:0 sc1
    s_waitcnt lgkmcnt(3)
    v_mfma_f32_16x16x32_bf16 v[216:219], v[64:67], a[56:59], v[216:219]
    ds_read_b128 v[60:63], v11 offset:1024
    v_mfma_f32_16x16x32_bf16 v[220:223], v[64:67], a[60:63], v[220:223]
    v_mfma_f32_16x16x32_bf16 v[224:227], v[68:71], a[56:59], v[224:227]
    ds_read_b128 v[64:67], v11 offset:2048
    buffer_load_dwordx4 v1, s[4:7], s34 offen offset:1024 sc1 lds
    v_mfma_f32_16x16x32_bf16 v[228:231], v[68:71], a[60:63], v[228:231]
    s_waitcnt lgkmcnt(3)
    v_mfma_f32_16x16x32_bf16 v[144:147], v[48:51], a[56:59], v[144:147]
    ds_read_b128 v[68:71], v11 offset:3072
    v_mfma_f32_16x16x32_bf16 v[148:151], v[48:51], a[60:63], v[148:151]
    s_add_u32 m0, s26, 81920
    s_add_u32 s34, s16, 114688
    buffer_load_dwordx4 v1, s[4:7], s34 offen sc1 lds
    v_mfma_f32_16x16x32_bf16 v[152:155], v[52:55], a[56:59], v[152:155]
    ds_read_b128 v[48:51], v11 offset:4096
    v_mfma_f32_16x16x32_bf16 v[156:159], v[52:55], a[60:63], v[156:159]
    s_waitcnt lgkmcnt(3)
    s_waitcnt vmcnt(23)
    v_mfma_f32_16x16x32_bf16 v[192:195], v[56:59], a[64:67], v[192:195]
    ds_read_b128 v[52:55], v11 offset:57344
    buffer_load_dwordx4 a[104:107], v1, s[4:7], s36 offen offset:1024 sc1
    s_waitcnt vmcnt(23)
    v_mfma_f32_16x16x32_bf16 v[196:199], v[56:59], a[68:71], v[196:199]
    v_mfma_f32_16x16x32_bf16 v[200:203], v[60:63], a[64:67], v[200:203]
    ds_read_b128 v[56:59], v11 offset:58368
    v_mfma_f32_16x16x32_bf16 v[204:207], v[60:63], a[68:71], v[204:207]
    buffer_load_dwordx4 a[108:111], v1, s[4:7], s37 offen offset:1024 sc1
    s_waitcnt lgkmcnt(3)
    v_mfma_f32_16x16x32_bf16 v[208:211], v[64:67], a[64:67], v[208:211]
    ds_read_b128 v[60:63], v11 offset:5120
    v_mfma_f32_16x16x32_bf16 v[212:215], v[64:67], a[68:71], v[212:215]
    v_mfma_f32_16x16x32_bf16 v[216:219], v[68:71], a[64:67], v[216:219]
    ds_read_b128 v[64:67], v11 offset:6144
    buffer_load_dwordx4 v1, s[4:7], s34 offen offset:1024 sc1 lds
    v_mfma_f32_16x16x32_bf16 v[220:223], v[68:71], a[68:71], v[220:223]
    s_waitcnt lgkmcnt(3)
    v_mfma_f32_16x16x32_bf16 v[224:227], v[48:51], a[64:67], v[224:227]
    ds_read_b128 v[68:71], v11 offset:7168
    v_mfma_f32_16x16x32_bf16 v[228:231], v[48:51], a[68:71], v[228:231]
    v_mfma_f32_16x16x32_bf16 v[144:147], v[52:55], a[64:67], v[144:147]
    ds_read_b128 v[48:51], v12 offset:0
    v_mfma_f32_16x16x32_bf16 v[148:151], v[52:55], a[68:71], v[148:151]
    s_waitcnt lgkmcnt(3)
    v_mfma_f32_16x16x32_bf16 v[152:155], v[56:59], a[64:67], v[152:155]
    ds_read_b128 v[52:55], v12 offset:1024
    v_mfma_f32_16x16x32_bf16 v[156:159], v[56:59], a[68:71], v[156:159]
    s_waitcnt vmcnt(21)
    v_mfma_f32_16x16x32_bf16 v[192:195], v[60:63], a[72:75], v[192:195]
    ds_read_b128 v[56:59], v11 offset:59392
    buffer_load_dwordx4 a[112:115], v1, s[4:7], s36 offen offset:2048 sc1
    s_waitcnt vmcnt(21)
    v_mfma_f32_16x16x32_bf16 v[196:199], v[60:63], a[76:79], v[196:199]
    s_waitcnt lgkmcnt(3)
    v_mfma_f32_16x16x32_bf16 v[200:203], v[64:67], a[72:75], v[200:203]
    ds_read_b128 v[60:63], v11 offset:60416
    v_mfma_f32_16x16x32_bf16 v[204:207], v[64:67], a[76:79], v[204:207]
    buffer_load_dwordx4 a[116:119], v1, s[4:7], s37 offen offset:2048 sc1
    v_mfma_f32_16x16x32_bf16 v[208:211], v[68:71], a[72:75], v[208:211]
    ds_read_b128 v[64:67], v12 offset:2048
    v_mfma_f32_16x16x32_bf16 v[212:215], v[68:71], a[76:79], v[212:215]
    s_waitcnt lgkmcnt(3)
    v_mfma_f32_16x16x32_bf16 v[216:219], v[48:51], a[72:75], v[216:219]
    ds_read_b128 v[68:71], v12 offset:3072
    v_mfma_f32_16x16x32_bf16 v[220:223], v[48:51], a[76:79], v[220:223]
    v_mfma_f32_16x16x32_bf16 v[224:227], v[52:55], a[72:75], v[224:227]
    s_barrier
    ds_read_b128 v[48:51], v12 offset:4096
    v_mfma_f32_16x16x32_bf16 v[228:231], v[52:55], a[76:79], v[228:231]
    s_add_u32 m0, s26, 0
    s_add_u32 s34, s16, 122880
    buffer_load_dwordx4 v1, s[4:7], s34 offen sc1 lds
    s_waitcnt lgkmcnt(3)
    v_mfma_f32_16x16x32_bf16 v[144:147], v[56:59], a[72:75], v[144:147]
    ds_read_b128 v[52:55], v12 offset:5120
    v_mfma_f32_16x16x32_bf16 v[148:151], v[56:59], a[76:79], v[148:151]
    v_mfma_f32_16x16x32_bf16 v[152:155], v[60:63], a[72:75], v[152:155]
    ds_read_b128 v[56:59], v12 offset:6144
    buffer_load_dwordx4 v1, s[4:7], s34 offen offset:1024 sc1 lds
    v_mfma_f32_16x16x32_bf16 v[156:159], v[60:63], a[76:79], v[156:159]
    s_waitcnt lgkmcnt(3)
    s_waitcnt vmcnt(19)
    v_mfma_f32_16x16x32_bf16 v[192:195], v[64:67], a[80:83], v[192:195]
    ds_read_b128 v[60:63], v11 offset:61440
    s_waitcnt vmcnt(18)
    v_mfma_f32_16x16x32_bf16 v[196:199], v[64:67], a[84:87], v[196:199]
    buffer_load_dwordx4 a[120:123], v1, s[4:7], s36 offen offset:3072 sc1
    v_mfma_f32_16x16x32_bf16 v[200:203], v[68:71], a[80:83], v[200:203]
    ds_read_b128 v[64:67], v11 offset:62464
    v_mfma_f32_16x16x32_bf16 v[204:207], v[68:71], a[84:87], v[204:207]
    s_waitcnt lgkmcnt(3)
    v_mfma_f32_16x16x32_bf16 v[208:211], v[48:51], a[80:83], v[208:211]
    ds_read_b128 v[68:71], v12 offset:7168
    buffer_load_dwordx4 a[124:127], v1, s[4:7], s37 offen offset:3072 sc1
    v_mfma_f32_16x16x32_bf16 v[212:215], v[48:51], a[84:87], v[212:215]
    v_mov_b32 v15, s67
    v_add_u32 v15, 6, v15
    v_mfma_f32_16x16x32_bf16 v[216:219], v[52:55], a[80:83], v[216:219]
    ds_read_b128 v[48:51], v12 offset:8192
    s_mov_b64 exec, 1
    buffer_store_dword v15, off, s[4:7], s60 sc1
    s_mov_b64 exec, -1
    v_mfma_f32_16x16x32_bf16 v[220:223], v[52:55], a[84:87], v[220:223]
    s_and_b32 s40, s2, 1
    s_waitcnt lgkmcnt(3)
    v_mfma_f32_16x16x32_bf16 v[224:227], v[56:59], a[80:83], v[224:227]
    ds_read_b128 v[52:55], v12 offset:9216
    s_lshl_b32 s40, s40, 3
    v_mfma_f32_16x16x32_bf16 v[228:231], v[56:59], a[84:87], v[228:231]
    s_add_u32 m0, s26, 24576
    s_add_u32 s34, s19, 49152
    buffer_load_dwordx4 v1, s[4:7], s34 offen sc1 lds
    v_mfma_f32_16x16x32_bf16 v[144:147], v[60:63], a[80:83], v[144:147]
    ds_read_b128 v[56:59], v12 offset:10240
    s_and_b32 s38, s66, 7
    v_mfma_f32_16x16x32_bf16 v[148:151], v[60:63], a[84:87], v[148:151]
    s_add_u32 s40, s40, s38
    s_waitcnt lgkmcnt(3)
    v_mfma_f32_16x16x32_bf16 v[152:155], v[64:67], a[80:83], v[152:155]
    ds_read_b128 v[60:63], v12 offset:11264
    buffer_load_dwordx4 v1, s[4:7], s34 offen offset:1024 sc1 lds
    v_mfma_f32_16x16x32_bf16 v[156:159], v[64:67], a[84:87], v[156:159]
    s_lshr_b32 s39, s66, 3
    s_lshl_b32 s56, s40, 3
    s_waitcnt vmcnt(20)
    v_mfma_f32_16x16x32_bf16 v[192:195], v[68:71], a[88:91], v[192:195]
    ds_read_b128 v[64:67], v11 offset:63488
    s_add_u32 s36, s30, 16384
    s_waitcnt vmcnt(19)
    v_mfma_f32_16x16x32_bf16 v[196:199], v[68:71], a[92:95], v[196:199]
    s_add_u32 s37, s33, 16384
    s_waitcnt lgkmcnt(3)
    v_mfma_f32_16x16x32_bf16 v[200:203], v[48:51], a[88:91], v[200:203]
    ds_read_b128 v[68:71], v11 offset:64512
    buffer_load_dwordx4 a[128:131], v1, s[4:7], s36 offen offset:0 sc1
    v_mfma_f32_16x16x32_bf16 v[204:207], v[48:51], a[92:95], v[204:207]
    s_lshl_b32 s38, s3, 1
    s_add_u32 s56, s56, s38
    v_mfma_f32_16x16x32_bf16 v[208:211], v[52:55], a[88:91], v[208:211]
    ds_read_b128 v[48:51], v12 offset:12288
    s_mul_i32 s56, s56, 18432
    v_mfma_f32_16x16x32_bf16 v[212:215], v[52:55], a[92:95], v[212:215]
    buffer_load_dwordx4 a[132:135], v1, s[4:7], s37 offen offset:0 sc1
    s_waitcnt lgkmcnt(3)
    v_mfma_f32_16x16x32_bf16 v[216:219], v[56:59], a[88:91], v[216:219]
    ds_read_b128 v[52:55], v12 offset:13312
    s_mul_i32 s38, s39, 288
    v_mfma_f32_16x16x32_bf16 v[220:223], v[56:59], a[92:95], v[220:223]
    s_add_u32 s56, s56, s38
    s_add_u32 s46, s56, 256
    v_mfma_f32_16x16x32_bf16 v[224:227], v[60:63], a[88:91], v[224:227]
    ds_read_b128 v[56:59], v12 offset:14336
    s_add_u32 m0, s26, 40960
    s_add_u32 s34, s16, 131072
    buffer_load_dwordx4 v1, s[4:7], s34 offen sc1 lds
    v_mfma_f32_16x16x32_bf16 v[228:231], v[60:63], a[92:95], v[228:231]
    s_lshl_b32 s38, s65, 6
    s_waitcnt lgkmcnt(3)
    v_mfma_f32_16x16x32_bf16 v[144:147], v[64:67], a[88:91], v[144:147]
    ds_read_b128 v[60:63], v12 offset:15360
    s_add_u32 s56, s56, s38
    v_mfma_f32_16x16x32_bf16 v[148:151], v[64:67], a[92:95], v[148:151]
    buffer_load_dwordx4 v1, s[4:7], s34 offen offset:1024 sc1 lds
    v_mfma_f32_16x16x32_bf16 v[152:155], v[68:71], a[88:91], v[152:155]
    ds_read_b128 v[64:67], v1 offset:8192
    s_add_u32 s64, s56, 18432
    v_mfma_f32_16x16x32_bf16 v[156:159], v[68:71], a[92:95], v[156:159]
    s_add_u32 s57, s46, 18432
    s_waitcnt lgkmcnt(3)
    s_waitcnt vmcnt(19)
    v_mfma_f32_16x16x32_bf16 v[192:195], v[48:51], a[96:99], v[192:195]
    ds_read_b128 v[68:71], v1 offset:49152
    buffer_load_dwordx4 a[136:139], v1, s[4:7], s36 offen offset:1024 sc1
    s_waitcnt vmcnt(19)
    v_mfma_f32_16x16x32_bf16 v[196:199], v[48:51], a[100:103], v[196:199]
    s_lshl_b32 s39, s65, 11
    s_mov_b32 s59, 0x3f80
    v_mfma_f32_16x16x32_bf16 v[200:203], v[52:55], a[96:99], v[200:203]
    ds_read_b128 v[48:51], v1 offset:50176
    s_mov_b32 s58, 0x3f800000
    v_mfma_f32_16x16x32_bf16 v[204:207], v[52:55], a[100:103], v[204:207]
    buffer_load_dwordx4 a[140:143], v1, s[4:7], s37 offen offset:1024 sc1
    s_waitcnt lgkmcnt(3)
    v_mfma_f32_16x16x32_bf16 v[208:211], v[56:59], a[96:99], v[208:211]
    ds_read_b128 v[52:55], v1 offset:9216
    s_add_u32 s38, s65, 1
    v_mfma_f32_16x16x32_bf16 v[212:215], v[56:59], a[100:103], v[212:215]
    s_and_b32 s38, s38, 3
    s_mul_i32 s38, s38, 36864
    v_mfma_f32_16x16x32_bf16 v[216:219], v[60:63], a[96:99], v[216:219]
    ds_read_b128 v[56:59], v1 offset:10240
    s_add_u32 m0, s26, 114688
    s_add_u32 s34, s16, 139264
    buffer_load_dwordx4 v1, s[4:7], s34 offen sc1 lds
    v_mfma_f32_16x16x32_bf16 v[220:223], v[60:63], a[100:103], v[220:223]
    s_add_u32 s38, s38, s22
    s_waitcnt lgkmcnt(3)
    v_mfma_f32_16x16x32_bf16 v[224:227], v[64:67], a[96:99], v[224:227]
    ds_read_b128 v[60:63], v1 offset:11264
    s_add_u32 s42, s38, s39
    v_mfma_f32_16x16x32_bf16 v[228:231], v[64:67], a[100:103], v[228:231]
    buffer_load_dwordx4 v1, s[4:7], s34 offen offset:1024 sc1 lds
    v_mfma_f32_16x16x32_bf16 v[144:147], v[68:71], a[96:99], v[144:147]
    ds_read_b128 v[64:67], v1 offset:12288
    s_add_u32 s38, s65, 2
    v_mfma_f32_16x16x32_bf16 v[148:151], v[68:71], a[100:103], v[148:151]
    s_and_b32 s38, s38, 3
    s_waitcnt lgkmcnt(3)
    v_mfma_f32_16x16x32_bf16 v[152:155], v[48:51], a[96:99], v[152:155]
    ds_read_b128 v[68:71], v1 offset:13312
    s_lshl_b32 s40, s38, 11
    v_mfma_f32_16x16x32_bf16 v[156:159], v[48:51], a[100:103], v[156:159]
    s_add_u32 s43, s21, s40
    s_mul_i32 s38, s38, 36864
    s_waitcnt vmcnt(19)
    v_mfma_f32_16x16x32_bf16 v[192:195], v[52:55], a[104:107], v[192:195]
    s_barrier
    ds_read_b128 v[48:51], v1 offset:51200
    s_waitcnt vmcnt(18)
    v_mfma_f32_16x16x32_bf16 v[196:199], v[52:55], a[108:111], v[196:199]
    buffer_load_dwordx4 a[144:147], v1, s[4:7], s36 offen offset:2048 sc1
    s_waitcnt lgkmcnt(3)
    v_mfma_f32_16x16x32_bf16 v[200:203], v[56:59], a[104:107], v[200:203]
    ds_read_b128 v[52:55], v1 offset:52224
    s_add_u32 s38, s38, s22
    v_mfma_f32_16x16x32_bf16 v[204:207], v[56:59], a[108:111], v[204:207]
    s_add_u32 s41, s38, s39
    s_add_u32 s38, s65, 3
    v_mfma_f32_16x16x32_bf16 v[208:211], v[60:63], a[104:107], v[208:211]
    ds_read_b128 v[56:59], v1 offset:14336
    buffer_load_dwordx4 a[148:151], v1, s[4:7], s37 offen offset:2048 sc1
    v_mfma_f32_16x16x32_bf16 v[212:215], v[60:63], a[108:111], v[212:215]
    s_and_b32 s38, s38, 3
    s_waitcnt lgkmcnt(3)
    v_mfma_f32_16x16x32_bf16 v[216:219], v[64:67], a[104:107], v[216:219]
    ds_read_b128 v[60:63], v1 offset:15360
    s_lshl_b32 s40, s38, 11
    v_mfma_f32_16x16x32_bf16 v[220:223], v[64:67], a[108:111], v[220:223]
    s_add_u32 m0, s26, 65536
    s_add_u32 s34, s16, 147456
    buffer_load_dwordx4 v1, s[4:7], s34 offen sc1 lds
    v_mfma_f32_16x16x32_bf16 v[224:227], v[68:71], a[104:107], v[224:227]
    ds_read_b128 v[64:67], v12 offset:24576
    s_add_u32 s55, s21, s40
    v_mfma_f32_16x16x32_bf16 v[228:231], v[68:71], a[108:111], v[228:231]
    s_mul_i32 s38, s38, 36864
    s_waitcnt lgkmcnt(3)
    v_mfma_f32_16x16x32_bf16 v[144:147], v[48:51], a[104:107], v[144:147]
    ds_read_b128 v[68:71], v12 offset:25600
    buffer_load_dwordx4 v1, s[4:7], s34 offen offset:1024 sc1 lds
    v_mfma_f32_16x16x32_bf16 v[148:151], v[48:51], a[108:111], v[148:151]
    s_add_u32 s38, s38, s22
    s_add_u32 s45, s38, s39
    v_mfma_f32_16x16x32_bf16 v[152:155], v[52:55], a[104:107], v[152:155]
    ds_read_b128 v[48:51], v12 offset:26624
    s_load_dwordx2 s[8:9], s[0:1], 0
    v_mfma_f32_16x16x32_bf16 v[156:159], v[52:55], a[108:111], v[156:159]
    s_add_u32 m0, s26, 90112
    s_add_u32 s34, s16, 155648
    buffer_load_dwordx4 v1, s[4:7], s34 offen sc1 lds
    s_waitcnt lgkmcnt(0)
    s_waitcnt vmcnt(21)
    v_mfma_f32_16x16x32_bf16 v[192:195], v[56:59], a[112:115], v[192:195]
    ds_read_b128 v[52:55], v1 offset:53248
    s_load_dwordx2 s[12:13], s[0:1], 64
    s_waitcnt vmcnt(20)
    v_mfma_f32_16x16x32_bf16 v[196:199], v[56:59], a[116:119], v[196:199]
    v_lshrrev_b32 v13, 2, v0
    v_and_b32 v2, 15, v13
    v_mfma_f32_16x16x32_bf16 v[200:203], v[60:63], a[112:115], v[200:203]
    ds_read_b128 v[56:59], v1 offset:54272
    buffer_load_dwordx4 a[152:155], v1, s[4:7], s36 offen offset:3072 sc1
    v_mfma_f32_16x16x32_bf16 v[204:207], v[60:63], a[116:119], v[204:207]
    v_mul_u32_u24 v2, 1152, v2
    v_mfma_f32_16x16x32_bf16 v[208:211], v[64:67], a[112:115], v[208:211]
    ds_read_b128 v[60:63], v12 offset:27648
    v_lshrrev_b32 v13, 4, v13
    v_mfma_f32_16x16x32_bf16 v[212:215], v[64:67], a[116:119], v[212:215]
    buffer_load_dwordx4 a[156:159], v1, s[4:7], s37 offen offset:3072 sc1
    v_mfma_f32_16x16x32_bf16 v[216:219], v[68:71], a[112:115], v[216:219]
    ds_read_b128 v[64:67], v12 offset:28672
    s_add_u32 s36, s67, 5
    v_subrev_u32 v94, s36, v94
    v_cmp_gt_u32 vcc, 8, v94
    s_nop 1
    s_andn2_b64 vcc, s[72:73], vcc
    s_cbranch_scc1 L3_o_spin
L3_o_back:
    v_mfma_f32_16x16x32_bf16 v[220:223], v[68:71], a[116:119], v[220:223]
    v_lshl_add_u32 v2, v13, 3, v2
    s_waitcnt lgkmcnt(0)
    v_mfma_f32_16x16x32_bf16 v[224:227], v[48:51], a[112:115], v[224:227]
    ds_read_b128 v[68:71], v12 offset:29696
    buffer_load_dwordx4 v1, s[4:7], s34 offen offset:1024 sc1 lds
    v_mfma_f32_16x16x32_bf16 v[228:231], v[48:51], a[116:119], v[228:231]
    s_cmp_eq_u32 s3, s65
    s_cselect_b32 s38, 0, 2147483632
    v_add_u32 v4, s38, v1
    v_mfma_f32_16x16x32_bf16 v[144:147], v[52:55], a[112:115], v[144:147]
    ds_read_b128 v[48:51], v12 offset:30720
    s_waitcnt lgkmcnt(0)
    s_mov_b32 s10, 2359296
    s_mov_b32 s11, 0x20000
    s_mov_b32 s14, 2359296
    s_mov_b32 s15, 0x20000
    v_mfma_f32_16x16x32_bf16 v[148:151], v[52:55], a[116:119], v[148:151]
    v_mfma_f32_16x16x32_bf16 v[152:155], v[56:59], a[112:115], v[152:155]
    ds_read_b128 v[52:55], v12 offset:31744
    v_mfma_f32_16x16x32_bf16 v[156:159], v[56:59], a[116:119], v[156:159]
    s_waitcnt vmcnt(20)
    v_mfma_f32_16x16x32_bf16 v[192:195], v[60:63], a[120:123], v[192:195]
    ds_read_b128 v[56:59], v1 offset:55296
    s_add_u32 s36, s30, 20480
    s_waitcnt vmcnt(19)
    v_mfma_f32_16x16x32_bf16 v[196:199], v[60:63], a[124:127], v[196:199]
    s_add_u32 s37, s33, 20480
    v_mfma_f32_16x16x32_bf16 v[200:203], v[64:67], a[120:123], v[200:203]
    ds_read_b128 v[60:63], v1 offset:56320
    buffer_load_dwordx4 a[160:163], v1, s[4:7], s36 offen offset:0 sc1
    v_mfma_f32_16x16x32_bf16 v[204:207], v[64:67], a[124:127], v[204:207]
    v_mfma_f32_16x16x32_bf16 v[208:211], v[68:71], a[120:123], v[208:211]
    ds_read_b128 v[64:67], v1 offset:57344
    v_mfma_f32_16x16x32_bf16 v[212:215], v[68:71], a[124:127], v[212:215]
    buffer_load_dwordx4 a[164:167], v1, s[4:7], s37 offen offset:0 sc1
    s_waitcnt lgkmcnt(3)
    v_mfma_f32_16x16x32_bf16 v[216:219], v[48:51], a[120:123], v[216:219]
    ds_read_b128 v[68:71], v1 offset:58368
    v_mfma_f32_16x16x32_bf16 v[220:223], v[48:51], a[124:127], v[220:223]
    v_mfma_f32_16x16x32_bf16 v[224:227], v[52:55], a[120:123], v[224:227]
    ds_read_b128 v[48:51], v1 offset:59392
    v_mfma_f32_16x16x32_bf16 v[228:231], v[52:55], a[124:127], v[228:231]
    s_waitcnt lgkmcnt(3)
    v_mfma_f32_16x16x32_bf16 v[144:147], v[56:59], a[120:123], v[144:147]
    ds_read_b128 v[52:55], v1 offset:60416
    v_mfma_f32_16x16x32_bf16 v[148:151], v[56:59], a[124:127], v[148:151]
    v_mfma_f32_16x16x32_bf16 v[152:155], v[60:63], a[120:123], v[152:155]
    ds_read_b128 v[56:59], v1 offset:61440
    v_mfma_f32_16x16x32_bf16 v[156:159], v[60:63], a[124:127], v[156:159]
    s_waitcnt lgkmcnt(3)
    s_waitcnt vmcnt(17)
    v_mfma_f32_16x16x32_bf16 v[192:195], v[64:67], a[128:131], v[192:195]
    ds_read_b128 v[60:63], v11 offset:32768
    buffer_load_dwordx4 a[168:171], v1, s[4:7], s36 offen offset:1024 sc1
    s_waitcnt vmcnt(17)
    v_mfma_f32_16x16x32_bf16 v[196:199], v[64:67], a[132:135], v[196:199]
    v_mfma_f32_16x16x32_bf16 v[200:203], v[68:71], a[128:131], v[200:203]
    ds_read_b128 v[64:67], v11 offset:33792
    v_mfma_f32_16x16x32_bf16 v[204:207], v[68:71], a[132:135], v[204:207]
    buffer_load_dwordx4 a[172:175], v1, s[4:7], s37 offen offset:1024 sc1
    s_waitcnt lgkmcnt(3)
    v_mfma_f32_16x16x32_bf16 v[208:211], v[48:51], a[128:131], v[208:211]
    ds_read_b128 v[68:71], v1 offset:62464
    v_mfma_f32_16x16x32_bf16 v[212:215], v[48:51], a[132:135], v[212:215]
    v_mfma_f32_16x16x32_bf16 v[216:219], v[52:55], a[128:131], v[216:219]
    s_barrier
    ds_read_b128 v[48:51], v1 offset:63488
    v_lshlrev_b32 v95, 5, v0
    s_mov_b64 exec, s[72:73]
    buffer_load_dword v95, v95, s[4:7], s23 offen sc1
    s_mov_b64 exec, -1
    v_mfma_f32_16x16x32_bf16 v[220:223], v[52:55], a[132:135], v[220:223]
    s_add_u32 m0, s26, 122880
    s_add_u32 s34, s16, 163840
    buffer_load_dwordx4 v1, s[4:7], s34 offen sc1 lds
    s_waitcnt lgkmcnt(3)
    v_mfma_f32_16x16x32_bf16 v[224:227], v[56:59], a[128:131], v[224:227]
    ds_read_b128 v[52:55], v1 offset:64512
    v_mfma_f32_16x16x32_bf16 v[228:231], v[56:59], a[132:135], v[228:231]
    v_mfma_f32_16x16x32_bf16 v[144:147], v[60:63], a[128:131], v[144:147]
    ds_read_b128 v[56:59], v1 offset:32768
    buffer_load_dwordx4 v1, s[4:7], s34 offen offset:1024 sc1 lds
    v_mfma_f32_16x16x32_bf16 v[148:151], v[60:63], a[132:135], v[148:151]
    s_waitcnt lgkmcnt(3)
    v_mfma_f32_16x16x32_bf16 v[152:155], v[64:67], a[128:131], v[152:155]
    ds_read_b128 v[60:63], v1 offset:33792
    v_lshlrev_b32 v92, 5, v0
    s_mov_b64 exec, s[70:71]
    buffer_load_dword v92, v92, s[4:7], s23 offen sc1
    s_mov_b64 exec, -1
    v_mfma_f32_16x16x32_bf16 v[156:159], v[64:67], a[132:135], v[156:159]
    s_add_u32 m0, s26, 131072
    s_add_u32 s34, s16, 172032
    buffer_load_dwordx4 v1, s[4:7], s34 offen sc1 lds
    s_waitcnt vmcnt(20)
    v_mfma_f32_16x16x32_bf16 v[192:195], v[68:71], a[136:139], v[192:195]
    ds_read_b128 v[64:67], v11 offset:34816
    s_waitcnt vmcnt(19)
    v_mfma_f32_16x16x32_bf16 v[196:199], v[68:71], a[140:143], v[196:199]
    s_waitcnt lgkmcnt(3)
    v_mfma_f32_16x16x32_bf16 v[200:203], v[48:51], a[136:139], v[200:203]
    ds_read_b128 v[68:71], v11 offset:35840
    buffer_load_dwordx4 a[176:179], v1, s[4:7], s36 offen offset:2048 sc1
    v_mfma_f32_16x16x32_bf16 v[204:207], v[48:51], a[140:143], v[204:207]
    v_mfma_f32_16x16x32_bf16 v[208:211], v[52:55], a[136:139], v[208:211]
    ds_read_b128 v[48:51], v1 offset:34816
    v_mfma_f32_16x16x32_bf16 v[212:215], v[52:55], a[140:143], v[212:215]
    buffer_load_dwordx4 a[180:183], v1, s[4:7], s37 offen offset:2048 sc1
    s_waitcnt lgkmcnt(3)
    v_mfma_f32_16x16x32_bf16 v[216:219], v[56:59], a[136:139], v[216:219]
    ds_read_b128 v[52:55], v1 offset:35840
    v_mfma_f32_16x16x32_bf16 v[220:223], v[56:59], a[140:143], v[220:223]
    v_mfma_f32_16x16x32_bf16 v[224:227], v[60:63], a[136:139], v[224:227]
    ds_read_b128 v[56:59], v1 offset:36864
    buffer_load_dwordx4 v1, s[4:7], s34 offen offset:1024 sc1 lds
    v_mfma_f32_16x16x32_bf16 v[228:231], v[60:63], a[140:143], v[228:231]
    s_waitcnt lgkmcnt(3)
    v_mfma_f32_16x16x32_bf16 v[144:147], v[64:67], a[136:139], v[144:147]
    ds_read_b128 v[60:63], v1 offset:37888
    v_mfma_f32_16x16x32_bf16 v[148:151], v[64:67], a[140:143], v[148:151]
    s_add_u32 m0, s26, 139264
    s_add_u32 s34, s16, 180224
    buffer_load_dwordx4 v1, s[4:7], s34 offen sc1 lds
    v_mfma_f32_16x16x32_bf16 v[152:155], v[68:71], a[136:139], v[152:155]
    ds_read_b128 v[64:67], v1 offset:38912
    v_mfma_f32_16x16x32_bf16 v[156:159], v[68:71], a[140:143], v[156:159]
    s_waitcnt lgkmcnt(3)
    s_waitcnt vmcnt(20)
    v_mfma_f32_16x16x32_bf16 v[192:195], v[48:51], a[144:147], v[192:195]
    ds_read_b128 v[68:71], v11 offset:36864
    buffer_load_dwordx4 a[184:187], v1, s[4:7], s36 offen offset:3072 sc1
    s_waitcnt vmcnt(20)
    v_mfma_f32_16x16x32_bf16 v[196:199], v[48:51], a[148:151], v[196:199]
    v_mfma_f32_16x16x32_bf16 v[200:203], v[52:55], a[144:147], v[200:203]
    ds_read_b128 v[48:51], v11 offset:37888
    v_mfma_f32_16x16x32_bf16 v[204:207], v[52:55], a[148:151], v[204:207]
    buffer_load_dwordx4 a[188:191], v1, s[4:7], s37 offen offset:3072 sc1
    s_waitcnt lgkmcnt(3)
    v_mfma_f32_16x16x32_bf16 v[208:211], v[56:59], a[144:147], v[208:211]
    ds_read_b128 v[52:55], v1 offset:39936
    v_mfma_f32_16x16x32_bf16 v[212:215], v[56:59], a[148:151], v[212:215]
    v_mfma_f32_16x16x32_bf16 v[216:219], v[60:63], a[144:147], v[216:219]
    ds_read_b128 v[56:59], v11 offset:8192
    buffer_load_dwordx4 v1, s[4:7], s34 offen offset:1024 sc1 lds
    v_mfma_f32_16x16x32_bf16 v[220:223], v[60:63], a[148:151], v[220:223]
    s_waitcnt lgkmcnt(3)
    v_mfma_f32_16x16x32_bf16 v[224:227], v[64:67], a[144:147], v[224:227]
    ds_read_b128 v[60:63], v11 offset:9216
    v_mfma_f32_16x16x32_bf16 v[228:231], v[64:67], a[148:151], v[228:231]
    s_add_u32 m0, s26, 106496
    s_add_u32 s34, s19, 57344
    buffer_load_dwordx4 v1, s[4:7], s34 offen sc1 lds
    v_mfma_f32_16x16x32_bf16 v[144:147], v[68:71], a[144:147], v[144:147]
    ds_read_b128 v[64:67], v11 offset:10240
    v_mfma_f32_16x16x32_bf16 v[148:151], v[68:71], a[148:151], v[148:151]
    s_waitcnt lgkmcnt(3)
    v_mfma_f32_16x16x32_bf16 v[152:155], v[48:51], a[144:147], v[152:155]
    ds_read_b128 v[68:71], v11 offset:11264
    buffer_load_dwordx4 v1, s[4:7], s34 offen offset:1024 sc1 lds
    v_mfma_f32_16x16x32_bf16 v[156:159], v[48:51], a[148:151], v[156:159]
    s_waitcnt vmcnt(20)
    v_mfma_f32_16x16x32_bf16 v[192:195], v[52:55], a[152:155], v[192:195]
    ds_read_b128 v[48:51], v11 offset:38912
    s_add_u32 s36, s30, 24576
    s_waitcnt vmcnt(19)
    v_mfma_f32_16x16x32_bf16 v[196:199], v[52:55], a[156:159], v[196:199]
    s_add_u32 s37, s33, 24576
    s_waitcnt lgkmcnt(3)
    v_mfma_f32_16x16x32_bf16 v[200:203], v[56:59], a[152:155], v[200:203]
    ds_read_b128 v[52:55], v11 offset:39936
    buffer_load_dwordx4 a[192:195], v1, s[4:7], s36 offen offset:0 sc1
    v_mfma_f32_16x16x32_bf16 v[204:207], v[56:59], a[156:159], v[204:207]
    v_mfma_f32_16x16x32_bf16 v[208:211], v[60:63], a[152:155], v[208:211]
    ds_read_b128 v[56:59], v11 offset:12288
    v_mfma_f32_16x16x32_bf16 v[212:215], v[60:63], a[156:159], v[212:215]
    buffer_load_dwordx4 a[196:199], v1, s[4:7], s37 offen offset:0 sc1
    s_waitcnt lgkmcnt(3)
    v_mfma_f32_16x16x32_bf16 v[216:219], v[64:67], a[152:155], v[216:219]
    ds_read_b128 v[60:63], v11 offset:13312
    v_mfma_f32_16x16x32_bf16 v[220:223], v[64:67], a[156:159], v[220:223]
    v_mfma_f32_16x16x32_bf16 v[224:227], v[68:71], a[152:155], v[224:227]
    ds_read_b128 v[64:67], v11 offset:14336
    v_mfma_f32_16x16x32_bf16 v[228:231], v[68:71], a[156:159], v[228:231]
    s_waitcnt lgkmcnt(3)
    v_mfma_f32_16x16x32_bf16 v[144:147], v[48:51], a[152:155], v[144:147]
    ds_read_b128 v[68:71], v11 offset:15360
    v_mfma_f32_16x16x32_bf16 v[148:151], v[48:51], a[156:159], v[148:151]
    v_mfma_f32_16x16x32_bf16 v[152:155], v[52:55], a[152:155], v[152:155]
    s_barrier
    ds_read_b128 v[48:51], v12 offset:16384
    v_mfma_f32_16x16x32_bf16 v[156:159], v[52:55], a[156:159], v[156:159]
    s_add_u32 m0, s26, 155648
    s_add_u32 s34, s19, 65536
    buffer_load_dwordx4 v1, s[4:7], s34 offen sc1 lds
    s_waitcnt lgkmcnt(3)
    s_waitcnt vmcnt(20)
    v_mfma_f32_16x16x32_bf16 v[192:195], v[56:59], a[160:163], v[192:195]
    ds_read_b128 v[52:55], v1 offset:16384
    s_waitcnt vmcnt(19)
    v_mfma_f32_16x16x32_bf16 v[196:199], v[56:59], a[164:167], v[196:199]
    v_mfma_f32_16x16x32_bf16 v[200:203], v[60:63], a[160:163], v[200:203]
    ds_read_b128 v[56:59], v1 offset:17408
    buffer_load_dwordx4 a[200:203], v1, s[4:7], s36 offen offset:1024 sc1
    v_mfma_f32_16x16x32_bf16 v[204:207], v[60:63], a[164:167], v[204:207]
    s_waitcnt lgkmcnt(3)
    v_mfma_f32_16x16x32_bf16 v[208:211], v[64:67], a[160:163], v[208:211]
    ds_read_b128 v[60:63], v12 offset:17408
    v_mfma_f32_16x16x32_bf16 v[212:215], v[64:67], a[164:167], v[212:215]
    buffer_load_dwordx4 a[204:207], v1, s[4:7], s37 offen offset:1024 sc1
    v_mfma_f32_16x16x32_bf16 v[216:219], v[68:71], a[160:163], v[216:219]
    ds_read_b128 v[64:67], v12 offset:18432
    v_mfma_f32_16x16x32_bf16 v[220:223], v[68:71], a[164:167], v[220:223]
    s_waitcnt lgkmcnt(3)
    v_mfma_f32_16x16x32_bf16 v[224:227], v[48:51], a[160:163], v[224:227]
    ds_read_b128 v[68:71], v12 offset:19456
    buffer_load_dwordx4 v1, s[4:7], s34 offen offset:1024 sc1 lds
    v_mfma_f32_16x16x32_bf16 v[228:231], v[48:51], a[164:167], v[228:231]
    v_mfma_f32_16x16x32_bf16 v[144:147], v[52:55], a[160:163], v[144:147]
    ds_read_b128 v[48:51], v12 offset:20480
    v_mfma_f32_16x16x32_bf16 v[148:151], v[52:55], a[164:167], v[148:151]
    s_add_u32 m0, s26, 8192
    s_add_u32 s34, s20, 0
    buffer_load_dwordx4 v1, s[4:7], s34 offen sc1 lds
    s_waitcnt lgkmcnt(3)
    v_mfma_f32_16x16x32_bf16 v[152:155], v[56:59], a[160:163], v[152:155]
    ds_read_b128 v[52:55], v12 offset:21504
    v_mfma_f32_16x16x32_bf16 v[156:159], v[56:59], a[164:167], v[156:159]
    s_waitcnt vmcnt(22)
    v_mfma_f32_16x16x32_bf16 v[192:195], v[60:63], a[168:171], v[192:195]
    ds_read_b128 v[56:59], v1 offset:18432
    buffer_load_dwordx4 a[208:211], v1, s[4:7], s36 offen offset:2048 sc1
    s_waitcnt vmcnt(22)
    v_mfma_f32_16x16x32_bf16 v[196:199], v[60:63], a[172:175], v[196:199]
    s_waitcnt lgkmcnt(3)
    v_mfma_f32_16x16x32_bf16 v[200:203], v[64:67], a[168:171], v[200:203]
    ds_read_b128 v[60:63], v1 offset:19456
    v_mfma_f32_16x16x32_bf16 v[204:207], v[64:67], a[172:175], v[204:207]
    buffer_load_dwordx4 a[212:215], v1, s[4:7], s37 offen offset:2048 sc1
    v_mfma_f32_16x16x32_bf16 v[208:211], v[68:71], a[168:171], v[208:211]
    ds_read_b128 v[64:67], v12 offset:22528
    v_mfma_f32_16x16x32_bf16 v[212:215], v[68:71], a[172:175], v[212:215]
    s_waitcnt lgkmcnt(3)
    v_mfma_f32_16x16x32_bf16 v[216:219], v[48:51], a[168:171], v[216:219]
    ds_read_b128 v[68:71], v12 offset:23552
    buffer_load_dwordx4 v1, s[4:7], s34 offen offset:1024 sc1 lds
    v_mfma_f32_16x16x32_bf16 v[220:223], v[48:51], a[172:175], v[220:223]
    v_mfma_f32_16x16x32_bf16 v[224:227], v[52:55], a[168:171], v[224:227]
    ds_read_b128 v[48:51], v11 offset:16384
    v_mfma_f32_16x16x32_bf16 v[228:231], v[52:55], a[172:175], v[228:231]
    s_add_u32 m0, s26, 49152
    s_add_u32 s34, s20, 8192
    buffer_load_dwordx4 v1, s[4:7], s34 offen sc1 lds
    s_waitcnt lgkmcnt(3)
    v_mfma_f32_16x16x32_bf16 v[144:147], v[56:59], a[168:171], v[144:147]
    ds_read_b128 v[52:55], v11 offset:17408
    v_mfma_f32_16x16x32_bf16 v[148:151], v[56:59], a[172:175], v[148:151]
    v_mfma_f32_16x16x32_bf16 v[152:155], v[60:63], a[168:171], v[152:155]
    ds_read_b128 v[56:59], v11 offset:18432
    buffer_load_dwordx4 v1, s[4:7], s34 offen offset:1024 sc1 lds
    v_mfma_f32_16x16x32_bf16 v[156:159], v[60:63], a[172:175], v[156:159]
    s_waitcnt lgkmcnt(3)
    s_waitcnt vmcnt(20)
    v_mfma_f32_16x16x32_bf16 v[192:195], v[64:67], a[176:179], v[192:195]
    ds_read_b128 v[60:63], v1 offset:20480
    s_waitcnt vmcnt(19)
    v_mfma_f32_16x16x32_bf16 v[196:199], v[64:67], a[180:183], v[196:199]
    buffer_load_dwordx4 a[216:219], v1, s[4:7], s36 offen offset:3072 sc1
    v_mfma_f32_16x16x32_bf16 v[200:203], v[68:71], a[176:179], v[200:203]
    ds_read_b128 v[64:67], v1 offset:21504
    v_mfma_f32_16x16x32_bf16 v[204:207], v[68:71], a[180:183], v[204:207]
    s_waitcnt lgkmcnt(3)
    v_mfma_f32_16x16x32_bf16 v[208:211], v[48:51], a[176:179], v[208:211]
    ds_read_b128 v[68:71], v11 offset:19456
    buffer_load_dwordx4 a[220:223], v1, s[4:7], s37 offen offset:3072 sc1
    v_mfma_f32_16x16x32_bf16 v[212:215], v[48:51], a[180:183], v[212:215]
    s_add_u32 s36, s67, 6
    v_subrev_u32 v95, s36, v95
    v_cmp_gt_u32 vcc, 8, v95
    s_nop 1
    s_andn2_b64 vcc, s[72:73], vcc
    s_cbranch_scc1 L4_o_spin
L4_o_back:
    v_mfma_f32_16x16x32_bf16 v[216:219], v[52:55], a[176:179], v[216:219]
    ds_read_b128 v[48:51], v11 offset:20480
    v_mfma_f32_16x16x32_bf16 v[220:223], v[52:55], a[180:183], v[220:223]
    s_waitcnt lgkmcnt(3)
    v_mfma_f32_16x16x32_bf16 v[224:227], v[56:59], a[176:179], v[224:227]
    ds_read_b128 v[52:55], v11 offset:21504
    v_mfma_f32_16x16x32_bf16 v[228:231], v[56:59], a[180:183], v[228:231]
    v_mfma_f32_16x16x32_bf16 v[144:147], v[60:63], a[176:179], v[144:147]
    ds_read_b128 v[56:59], v11 offset:22528
    v_mfma_f32_16x16x32_bf16 v[148:151], v[60:63], a[180:183], v[148:151]
    s_waitcnt lgkmcnt(3)
    v_mfma_f32_16x16x32_bf16 v[152:155], v[64:67], a[176:179], v[152:155]
    ds_read_b128 v[60:63], v11 offset:23552
    v_mfma_f32_16x16x32_bf16 v[156:159], v[64:67], a[180:183], v[156:159]
    s_waitcnt vmcnt(18)
    v_mfma_f32_16x16x32_bf16 v[192:195], v[68:71], a[184:187], v[192:195]
    ds_read_b128 v[64:67], v1 offset:22528
    s_add_u32 s36, s30, 28672
    s_waitcnt vmcnt(17)
    v_mfma_f32_16x16x32_bf16 v[196:199], v[68:71], a[188:191], v[196:199]
    s_add_u32 s37, s33, 28672
    s_waitcnt lgkmcnt(3)
    v_mfma_f32_16x16x32_bf16 v[200:203], v[48:51], a[184:187], v[200:203]
    ds_read_b128 v[68:71], v1 offset:23552
    buffer_load_dwordx4 a[224:227], v1, s[4:7], s36 offen offset:0 sc1
    v_mfma_f32_16x16x32_bf16 v[204:207], v[48:51], a[188:191], v[204:207]
    v_mfma_f32_16x16x32_bf16 v[208:211], v[52:55], a[184:187], v[208:211]
    s_barrier
    ds_read_b128 v[48:51], v1 offset:0
    v_mfma_f32_16x16x32_bf16 v[212:215], v[52:55], a[188:191], v[212:215]
    buffer_load_dwordx4 a[228:231], v1, s[4:7], s37 offen offset:0 sc1
    s_waitcnt lgkmcnt(3)
    v_mfma_f32_16x16x32_bf16 v[216:219], v[56:59], a[184:187], v[216:219]
    ds_read_b128 v[52:55], v1 offset:1024
    v_mfma_f32_16x16x32_bf16 v[220:223], v[56:59], a[188:191], v[220:223]
    v_mfma_f32_16x16x32_bf16 v[224:227], v[60:63], a[184:187], v[224:227]
    ds_read_b128 v[56:59], v1 offset:2048
    s_add_u32 m0, s26, 32768
    s_add_u32 s34, s20, 16384
    buffer_load_dwordx4 v1, s[4:7], s34 offen sc1 lds
    v_mfma_f32_16x16x32_bf16 v[228:231], v[60:63], a[188:191], v[228:231]
    s_waitcnt lgkmcnt(3)
    v_mfma_f32_16x16x32_bf16 v[144:147], v[64:67], a[184:187], v[144:147]
    ds_read_b128 v[60:63], v1 offset:3072
    v_mfma_f32_16x16x32_bf16 v[148:151], v[64:67], a[188:191], v[148:151]
    buffer_load_dwordx4 a[232:235], v1, s[4:7], s36 offen offset:1024 sc1
    v_mfma_f32_16x16x32_bf16 v[152:155], v[68:71], a[184:187], v[152:155]
    ds_read_b128 v[64:67], v1 offset:4096
    v_mfma_f32_16x16x32_bf16 v[156:159], v[68:71], a[188:191], v[156:159]
    s_waitcnt lgkmcnt(3)
    s_waitcnt vmcnt(17)
    v_mfma_f32_16x16x32_bf16 v[192:195], v[48:51], a[192:195], v[192:195]
    ds_read_b128 v[68:71], v1 offset:24576
    buffer_load_dwordx4 a[236:239], v1, s[4:7], s37 offen offset:1024 sc1
    s_waitcnt vmcnt(17)
    v_mfma_f32_16x16x32_bf16 v[196:199], v[48:51], a[196:199], v[196:199]
    v_mfma_f32_16x16x32_bf16 v[200:203], v[52:55], a[192:195], v[200:203]
    ds_read_b128 v[48:51], v1 offset:25600
    v_mfma_f32_16x16x32_bf16 v[204:207], v[52:55], a[196:199], v[204:207]
    buffer_load_dwordx4 v1, s[4:7], s34 offen offset:1024 sc1 lds
    s_waitcnt lgkmcnt(3)
    v_mfma_f32_16x16x32_bf16 v[208:211], v[56:59], a[192:195], v[208:211]
    ds_read_b128 v[52:55], v1 offset:5120
    v_mfma_f32_16x16x32_bf16 v[212:215], v[56:59], a[196:199], v[212:215]
    v_mfma_f32_16x16x32_bf16 v[216:219], v[60:63], a[192:195], v[216:219]
    ds_read_b128 v[56:59], v1 offset:6144
    buffer_load_dwordx4 a[240:243], v1, s[4:7], s36 offen offset:2048 sc1
    v_mfma_f32_16x16x32_bf16 v[220:223], v[60:63], a[196:199], v[220:223]
    s_waitcnt lgkmcnt(3)
    v_mfma_f32_16x16x32_bf16 v[224:227], v[64:67], a[192:195], v[224:227]
    ds_read_b128 v[60:63], v1 offset:7168
    v_mfma_f32_16x16x32_bf16 v[228:231], v[64:67], a[196:199], v[228:231]
    buffer_load_dwordx4 a[244:247], v1, s[4:7], s37 offen offset:2048 sc1
    v_mfma_f32_16x16x32_bf16 v[144:147], v[68:71], a[192:195], v[144:147]
    ds_read_b128 v[64:67], v1 offset:40960
    v_mfma_f32_16x16x32_bf16 v[148:151], v[68:71], a[196:199], v[148:151]
    s_waitcnt lgkmcnt(3)
    v_mfma_f32_16x16x32_bf16 v[152:155], v[48:51], a[192:195], v[152:155]
    ds_read_b128 v[68:71], v1 offset:41984
    s_add_u32 m0, s26, 57344
    s_add_u32 s34, s20, 24576
    buffer_load_dwordx4 v1, s[4:7], s34 offen sc1 lds
    v_mfma_f32_16x16x32_bf16 v[156:159], v[48:51], a[196:199], v[156:159]
    s_waitcnt vmcnt(19)
    v_mfma_f32_16x16x32_bf16 v[192:195], v[52:55], a[200:203], v[192:195]
    ds_read_b128 v[48:51], v1 offset:26624
    s_waitcnt vmcnt(18)
    v_mfma_f32_16x16x32_bf16 v[196:199], v[52:55], a[204:207], v[196:199]
    buffer_load_dwordx4 v1, s[4:7], s34 offen offset:1024 sc1 lds
    s_waitcnt lgkmcnt(3)
    v_mfma_f32_16x16x32_bf16 v[200:203], v[56:59], a[200:203], v[200:203]
    ds_read_b128 v[52:55], v1 offset:27648
    v_mfma_f32_16x16x32_bf16 v[204:207], v[56:59], a[204:207], v[204:207]
    v_mfma_f32_16x16x32_bf16 v[208:211], v[60:63], a[200:203], v[208:211]
    ds_read_b128 v[56:59], v1 offset:43008
    buffer_load_dwordx4 a[248:251], v1, s[4:7], s36 offen offset:3072 sc1
    v_mfma_f32_16x16x32_bf16 v[212:215], v[60:63], a[204:207], v[212:215]
    s_waitcnt lgkmcnt(3)
    v_mfma_f32_16x16x32_bf16 v[216:219], v[64:67], a[200:203], v[216:219]
    ds_read_b128 v[60:63], v1 offset:44032
    v_mfma_f32_16x16x32_bf16 v[220:223], v[64:67], a[204:207], v[220:223]
    buffer_load_dwordx4 a[252:255], v1, s[4:7], s37 offen offset:3072 sc1
    v_mfma_f32_16x16x32_bf16 v[224:227], v[68:71], a[200:203], v[224:227]
    ds_read_b128 v[64:67], v1 offset:45056
    v_mfma_f32_16x16x32_bf16 v[228:231], v[68:71], a[204:207], v[228:231]
    s_waitcnt lgkmcnt(3)
    v_mfma_f32_16x16x32_bf16 v[144:147], v[48:51], a[200:203], v[144:147]
    ds_read_b128 v[68:71], v1 offset:46080
    s_add_u32 m0, s26, 73728
    s_add_u32 s34, s20, 32768
    buffer_load_dwordx4 v1, s[4:7], s34 offen sc1 lds
    v_mfma_f32_16x16x32_bf16 v[148:151], v[48:51], a[204:207], v[148:151]
    v_mfma_f32_16x16x32_bf16 v[152:155], v[52:55], a[200:203], v[152:155]
    ds_read_b128 v[48:51], v1 offset:47104
    s_add_u32 s36, s30, 32768
    v_mfma_f32_16x16x32_bf16 v[156:159], v[52:55], a[204:207], v[156:159]
    s_add_u32 s37, s33, 32768
    s_waitcnt lgkmcnt(3)
    s_waitcnt vmcnt(19)
    v_mfma_f32_16x16x32_bf16 v[192:195], v[56:59], a[208:211], v[192:195]
    ds_read_b128 v[52:55], v1 offset:28672
    buffer_load_dwordx4 v[16:19], v1, s[4:7], s36 offen offset:0 sc1
    s_waitcnt vmcnt(19)
    v_mfma_f32_16x16x32_bf16 v[196:199], v[56:59], a[212:215], v[196:199]
    v_mfma_f32_16x16x32_bf16 v[200:203], v[60:63], a[208:211], v[200:203]
    ds_read_b128 v[56:59], v1 offset:29696
    v_mfma_f32_16x16x32_bf16 v[204:207], v[60:63], a[212:215], v[204:207]
    buffer_load_dwordx4 v[20:23], v1, s[4:7], s37 offen offset:0 sc1
    s_waitcnt lgkmcnt(3)
    v_mfma_f32_16x16x32_bf16 v[208:211], v[64:67], a[208:211], v[208:211]
    ds_read_b128 v[60:63], v1 offset:48128
    v_mfma_f32_16x16x32_bf16 v[212:215], v[64:67], a[212:215], v[212:215]
    v_mfma_f32_16x16x32_bf16 v[216:219], v[68:71], a[208:211], v[216:219]
    ds_read_b128 v[64:67], v11 offset:49152
    buffer_load_dwordx4 v1, s[4:7], s34 offen offset:1024 sc1 lds
    v_mfma_f32_16x16x32_bf16 v[220:223], v[68:71], a[212:215], v[220:223]
    s_waitcnt lgkmcnt(3)
    v_mfma_f32_16x16x32_bf16 v[224:227], v[48:51], a[208:211], v[224:227]
    ds_read_b128 v[68:71], v11 offset:50176
    v_mfma_f32_16x16x32_bf16 v[228:231], v[48:51], a[212:215], v[228:231]
    buffer_load_dwordx4 v[24:27], v1, s[4:7], s36 offen offset:1024 sc1
    v_mfma_f32_16x16x32_bf16 v[144:147], v[52:55], a[208:211], v[144:147]
    s_barrier
    ds_read_b128 v[48:51], v11 offset:51200
    v_mfma_f32_16x16x32_bf16 v[148:151], v[52:55], a[212:215], v[148:151]
    s_waitcnt lgkmcnt(3)
    v_mfma_f32_16x16x32_bf16 v[152:155], v[56:59], a[208:211], v[152:155]
    ds_read_b128 v[52:55], v11 offset:52224
    buffer_load_dwordx4 v[28:31], v1, s[4:7], s37 offen offset:1024 sc1
    v_mfma_f32_16x16x32_bf16 v[156:159], v[56:59], a[212:215], v[156:159]
    s_waitcnt vmcnt(19)
    v_mfma_f32_16x16x32_bf16 v[192:195], v[60:63], a[216:219], v[192:195]
    ds_read_b128 v[56:59], v1 offset:30720
    s_waitcnt vmcnt(18)
    v_mfma_f32_16x16x32_bf16 v[196:199], v[60:63], a[220:223], v[196:199]
    s_add_u32 m0, s26, 147456
    s_add_u32 s34, s20, 40960
    buffer_load_dwordx4 v1, s[4:7], s34 offen sc1 lds
    s_waitcnt lgkmcnt(3)
    v_mfma_f32_16x16x32_bf16 v[200:203], v[64:67], a[216:219], v[200:203]
    ds_read_b128 v[60:63], v1 offset:31744
    v_mfma_f32_16x16x32_bf16 v[204:207], v[64:67], a[220:223], v[204:207]
    v_mfma_f32_16x16x32_bf16 v[208:211], v[68:71], a[216:219], v[208:211]
    ds_read_b128 v[64:67], v11 offset:53248
    buffer_load_dwordx4 v[32:35], v1, s[4:7], s36 offen offset:2048 sc1
    v_mfma_f32_16x16x32_bf16 v[212:215], v[68:71], a[220:223], v[212:215]
    s_waitcnt lgkmcnt(3)
    v_mfma_f32_16x16x32_bf16 v[216:219], v[48:51], a[216:219], v[216:219]
    ds_read_b128 v[68:71], v11 offset:54272
    v_mfma_f32_16x16x32_bf16 v[220:223], v[48:51], a[220:223], v[220:223]
    buffer_load_dwordx4 v[36:39], v1, s[4:7], s37 offen offset:2048 sc1
    v_mfma_f32_16x16x32_bf16 v[224:227], v[52:55], a[216:219], v[224:227]
    ds_read_b128 v[48:51], v11 offset:55296
    v_mfma_f32_16x16x32_bf16 v[228:231], v[52:55], a[220:223], v[228:231]
    s_waitcnt lgkmcnt(3)
    v_mfma_f32_16x16x32_bf16 v[144:147], v[56:59], a[216:219], v[144:147]
    ds_read_b128 v[52:55], v11 offset:56320
    buffer_load_dwordx4 v1, s[4:7], s34 offen offset:1024 sc1 lds
    v_mfma_f32_16x16x32_bf16 v[148:151], v[56:59], a[220:223], v[148:151]
    v_mfma_f32_16x16x32_bf16 v[152:155], v[60:63], a[216:219], v[152:155]
    ds_read_b128 v[56:59], v11 offset:0
    v_mfma_f32_16x16x32_bf16 v[156:159], v[60:63], a[220:223], v[156:159]
    s_add_u32 m0, s26, 16384
    s_add_u32 s34, s20, 49152
    buffer_load_dwordx4 v1, s[4:7], s34 offen sc1 lds
    s_waitcnt lgkmcnt(3)
    s_waitcnt vmcnt(22)
    v_mfma_f32_16x16x32_bf16 v[192:195], v[64:67], a[224:227], v[192:195]
    ds_read_b128 v[60:63], v11 offset:1024
    s_waitcnt vmcnt(21)
    v_mfma_f32_16x16x32_bf16 v[196:199], v[64:67], a[228:231], v[196:199]
    v_mfma_f32_16x16x32_bf16 v[200:203], v[68:71], a[224:227], v[200:203]
    ds_read_b128 v[64:67], v11 offset:2048
    buffer_load_dwordx4 v[40:43], v1, s[4:7], s36 offen offset:3072 sc1
    v_mfma_f32_16x16x32_bf16 v[204:207], v[68:71], a[228:231], v[204:207]
    s_waitcnt lgkmcnt(3)
    v_mfma_f32_16x16x32_bf16 v[208:211], v[48:51], a[224:227], v[208:211]
    ds_read_b128 v[68:71], v11 offset:3072
    v_mfma_f32_16x16x32_bf16 v[212:215], v[48:51], a[228:231], v[212:215]
    buffer_load_dwordx4 v[44:47], v1, s[4:7], s37 offen offset:3072 sc1
    v_mfma_f32_16x16x32_bf16 v[216:219], v[52:55], a[224:227], v[216:219]
    ds_read_b128 v[48:51], v11 offset:4096
    s_add_u32 s36, s67, 5
    v_subrev_u32 v92, s36, v92
    v_cmp_gt_u32 vcc, 8, v92
    s_nop 1
    s_andn2_b64 vcc, s[70:71], vcc
    s_cbranch_scc1 Lo_o_spin
Lo_o_back:
    v_mfma_f32_16x16x32_bf16 v[220:223], v[52:55], a[228:231], v[220:223]
    s_waitcnt lgkmcnt(3)
    v_mfma_f32_16x16x32_bf16 v[224:227], v[56:59], a[224:227], v[224:227]
    ds_read_b128 v[52:55], v11 offset:5120
    buffer_load_dwordx4 v1, s[4:7], s34 offen offset:1024 sc1 lds
    v_mfma_f32_16x16x32_bf16 v[228:231], v[56:59], a[228:231], v[228:231]
    s_waitcnt vmcnt(22)
    v_mfma_f32_16x16x32_bf16 v[192:195], v[60:63], a[232:235], v[192:195]
    ds_read_b128 v[56:59], v11 offset:6144
    s_waitcnt vmcnt(21)
    v_mfma_f32_16x16x32_bf16 v[196:199], v[60:63], a[236:239], v[196:199]
    s_add_u32 m0, s26, 81920
    s_add_u32 s34, s20, 57344
    buffer_load_dwordx4 v1, s[4:7], s34 offen sc1 lds
    s_waitcnt lgkmcnt(3)
    v_mfma_f32_16x16x32_bf16 v[200:203], v[64:67], a[232:235], v[200:203]
    ds_read_b128 v[60:63], v11 offset:7168
    v_mfma_f32_16x16x32_bf16 v[204:207], v[64:67], a[236:239], v[204:207]
    v_mfma_f32_16x16x32_bf16 v[208:211], v[68:71], a[232:235], v[208:211]
    ds_read_b128 v[64:67], v11 offset:24576
    buffer_load_dwordx4 v1, s[4:7], s34 offen offset:1024 sc1 lds
    v_mfma_f32_16x16x32_bf16 v[212:215], v[68:71], a[236:239], v[212:215]
    s_waitcnt lgkmcnt(3)
    v_mfma_f32_16x16x32_bf16 v[216:219], v[48:51], a[232:235], v[216:219]
    ds_read_b128 v[68:71], v11 offset:25600
    v_mfma_f32_16x16x32_bf16 v[220:223], v[48:51], a[236:239], v[220:223]
    v_mfma_f32_16x16x32_bf16 v[224:227], v[52:55], a[232:235], v[224:227]
    ds_read_b128 v[48:51], v11 offset:26624
    v_mfma_f32_16x16x32_bf16 v[228:231], v[52:55], a[236:239], v[228:231]
    s_waitcnt lgkmcnt(3)
    s_waitcnt vmcnt(21)
    v_mfma_f32_16x16x32_bf16 v[192:195], v[56:59], a[240:243], v[192:195]
    ds_read_b128 v[52:55], v11 offset:27648
    s_waitcnt vmcnt(20)
    v_mfma_f32_16x16x32_bf16 v[196:199], v[56:59], a[244:247], v[196:199]
    v_mfma_f32_16x16x32_bf16 v[200:203], v[60:63], a[240:243], v[200:203]
    ds_read_b128 v[56:59], v11 offset:28672
    v_mfma_f32_16x16x32_bf16 v[204:207], v[60:63], a[244:247], v[204:207]
    s_waitcnt lgkmcnt(3)
    v_mfma_f32_16x16x32_bf16 v[208:211], v[64:67], a[240:243], v[208:211]
    ds_read_b128 v[60:63], v11 offset:29696
    v_mfma_f32_16x16x32_bf16 v[212:215], v[64:67], a[244:247], v[212:215]
    v_mfma_f32_16x16x32_bf16 v[216:219], v[68:71], a[240:243], v[216:219]
    ds_read_b128 v[64:67], v11 offset:30720
    v_mfma_f32_16x16x32_bf16 v[220:223], v[68:71], a[244:247], v[220:223]
    s_waitcnt lgkmcnt(3)
    v_mfma_f32_16x16x32_bf16 v[224:227], v[48:51], a[240:243], v[224:227]
    ds_read_b128 v[68:71], v11 offset:31744
    v_mfma_f32_16x16x32_bf16 v[228:231], v[48:51], a[244:247], v[228:231]
    s_waitcnt vmcnt(17)
    v_mfma_f32_16x16x32_bf16 v[192:195], v[52:55], a[248:251], v[192:195]
    s_barrier
    ds_read_b128 v[48:51], v11 offset:57344
    s_waitcnt vmcnt(16)
    v_mfma_f32_16x16x32_bf16 v[196:199], v[52:55], a[252:255], v[196:199]
    s_add_u32 m0, s26, 0
    s_add_u32 s34, s20, 65536
    buffer_load_dwordx4 v1, s[4:7], s34 offen sc1 lds
    s_waitcnt lgkmcnt(3)
    v_mfma_f32_16x16x32_bf16 v[200:203], v[56:59], a[248:251], v[200:203]
    ds_read_b128 v[52:55], v11 offset:58368
    v_mfma_f32_16x16x32_bf16 v[204:207], v[56:59], a[252:255], v[204:207]
    v_mfma_f32_16x16x32_bf16 v[208:211], v[60:63], a[248:251], v[208:211]
    ds_read_b128 v[56:59], v11 offset:59392
    buffer_load_dwordx4 v1, s[4:7], s34 offen offset:1024 sc1 lds
    v_mfma_f32_16x16x32_bf16 v[212:215], v[60:63], a[252:255], v[212:215]
    s_waitcnt lgkmcnt(3)
    v_mfma_f32_16x16x32_bf16 v[216:219], v[64:67], a[248:251], v[216:219]
    ds_read_b128 v[60:63], v11 offset:60416
    v_mfma_f32_16x16x32_bf16 v[220:223], v[64:67], a[252:255], v[220:223]
    s_add_u32 m0, s26, 40960
    s_add_u32 s34, s28, 0
    buffer_load_dwordx4 v1, s[4:7], s34 offen sc1 lds
    v_mfma_f32_16x16x32_bf16 v[224:227], v[68:71], a[248:251], v[224:227]
    ds_read_b128 v[64:67], v11 offset:61440
    v_mfma_f32_16x16x32_bf16 v[228:231], v[68:71], a[252:255], v[228:231]
    s_waitcnt lgkmcnt(3)
    s_waitcnt vmcnt(17)
    v_mfma_f32_16x16x32_bf16 v[192:195], v[48:51], v[16:19], v[192:195]
    ds_read_b128 v[68:71], v11 offset:62464
    buffer_load_dwordx4 v1, s[4:7], s34 offen offset:1024 sc1 lds
    s_waitcnt vmcnt(17)
    v_mfma_f32_16x16x32_bf16 v[196:199], v[48:51], v[20:23], v[196:199]
    v_mfma_f32_16x16x32_bf16 v[200:203], v[52:55], v[16:19], v[200:203]
    ds_read_b128 v[48:51], v11 offset:63488
    v_mfma_f32_16x16x32_bf16 v[204:207], v[52:55], v[20:23], v[204:207]
    s_add_u32 m0, s26, 98304
    s_add_u32 s34, s28, 8192
    buffer_load_dwordx4 v1, s[4:7], s34 offen sc1 lds
    s_waitcnt lgkmcnt(3)
    v_mfma_f32_16x16x32_bf16 v[208:211], v[56:59], v[16:19], v[208:211]
    ds_read_b128 v[52:55], v11 offset:64512
    v_mfma_f32_16x16x32_bf16 v[212:215], v[56:59], v[20:23], v[212:215]
    v_mfma_f32_16x16x32_bf16 v[216:219], v[60:63], v[16:19], v[216:219]
    ds_read_b128 v[56:59], v12 offset:0
    buffer_load_dwordx4 v1, s[4:7], s34 offen offset:1024 sc1 lds
    v_mfma_f32_16x16x32_bf16 v[220:223], v[60:63], v[20:23], v[220:223]
    s_waitcnt lgkmcnt(3)
    v_mfma_f32_16x16x32_bf16 v[224:227], v[64:67], v[16:19], v[224:227]
    ds_read_b128 v[60:63], v12 offset:1024
    v_mfma_f32_16x16x32_bf16 v[228:231], v[64:67], v[20:23], v[228:231]
    s_waitcnt vmcnt(17)
    v_mfma_f32_16x16x32_bf16 v[192:195], v[68:71], v[24:27], v[192:195]
    ds_read_b128 v[64:67], v12 offset:2048
    s_waitcnt vmcnt(16)
    v_mfma_f32_16x16x32_bf16 v[196:199], v[68:71], v[28:31], v[196:199]
    s_waitcnt lgkmcnt(3)
    v_mfma_f32_16x16x32_bf16 v[200:203], v[48:51], v[24:27], v[200:203]
    ds_read_b128 v[68:71], v12 offset:3072
    v_mfma_f32_16x16x32_bf16 v[204:207], v[48:51], v[28:31], v[204:207]
    v_mfma_f32_16x16x32_bf16 v[208:211], v[52:55], v[24:27], v[208:211]
    ds_read_b128 v[48:51], v12 offset:4096
    v_mfma_f32_16x16x32_bf16 v[212:215], v[52:55], v[28:31], v[212:215]
    s_waitcnt lgkmcnt(3)
    v_mfma_f32_16x16x32_bf16 v[216:219], v[56:59], v[24:27], v[216:219]
    ds_read_b128 v[52:55], v12 offset:5120
    s_mul_i32 s36, s65, 36864
    v_mfma_f32_16x16x32_bf16 v[220:223], v[56:59], v[28:31], v[220:223]
    s_sub_u32 s30, s30, s36
    s_sub_u32 s33, s33, s36
    v_mfma_f32_16x16x32_bf16 v[224:227], v[60:63], v[24:27], v[224:227]
    ds_read_b128 v[56:59], v12 offset:6144
    s_add_u32 s36, s30, 4294948864
    v_mfma_f32_16x16x32_bf16 v[228:231], v[60:63], v[28:31], v[228:231]
    s_add_u32 s37, s33, 4294948864
    s_waitcnt lgkmcnt(3)
    s_waitcnt vmcnt(14)
    v_mfma_f32_16x16x32_bf16 v[192:195], v[64:67], v[32:35], v[192:195]
    ds_read_b128 v[60:63], v12 offset:7168
    buffer_load_dwordx4 v[96:99], v1, s[4:7], s36 offen offset:0 sc1
    s_waitcnt vmcnt(14)
    v_mfma_f32_16x16x32_bf16 v[196:199], v[64:67], v[36:39], v[196:199]
    v_mfma_f32_16x16x32_bf16 v[200:203], v[68:71], v[32:35], v[200:203]
    ds_read_b128 v[64:67], v12 offset:8192
    v_mfma_f32_16x16x32_bf16 v[204:207], v[68:71], v[36:39], v[204:207]
    buffer_load_dwordx4 v[100:103], v1, s[4:7], s37 offen offset:0 sc1
    s_waitcnt lgkmcnt(3)
    v_mfma_f32_16x16x32_bf16 v[208:211], v[48:51], v[32:35], v[208:211]
    ds_read_b128 v[68:71], v12 offset:9216
    v_mfma_f32_16x16x32_bf16 v[212:215], v[48:51], v[36:39], v[212:215]
    v_mfma_f32_16x16x32_bf16 v[216:219], v[52:55], v[32:35], v[216:219]
    ds_read_b128 v[48:51], v12 offset:10240
    buffer_load_dwordx4 v[104:107], v1, s[4:7], s36 offen offset:1024 sc1
    v_mfma_f32_16x16x32_bf16 v[220:223], v[52:55], v[36:39], v[220:223]
    s_waitcnt lgkmcnt(3)
    v_mfma_f32_16x16x32_bf16 v[224:227], v[56:59], v[32:35], v[224:227]
    ds_read_b128 v[52:55], v12 offset:11264
    v_mfma_f32_16x16x32_bf16 v[228:231], v[56:59], v[36:39], v[228:231]
    buffer_load_dwordx4 v[108:111], v1, s[4:7], s37 offen offset:1024 sc1
    s_waitcnt vmcnt(14)
    v_mfma_f32_16x16x32_bf16 v[192:195], v[60:63], v[40:43], v[192:195]
    ds_read_b128 v[56:59], v11 offset:40960
    s_waitcnt vmcnt(13)
    v_mfma_f32_16x16x32_bf16 v[196:199], v[60:63], v[44:47], v[196:199]
    s_waitcnt lgkmcnt(3)
    v_mfma_f32_16x16x32_bf16 v[200:203], v[64:67], v[40:43], v[200:203]
    ds_read_b128 v[60:63], v11 offset:41984
    buffer_load_dwordx4 v[128:131], v1, s[4:7], s36 offen offset:2048 sc1
    v_mfma_f32_16x16x32_bf16 v[204:207], v[64:67], v[44:47], v[204:207]
    v_mfma_f32_16x16x32_bf16 v[208:211], v[68:71], v[40:43], v[208:211]
    ds_read_b128 v[64:67], v11 offset:43008
    v_mfma_f32_16x16x32_bf16 v[212:215], v[68:71], v[44:47], v[212:215]
    buffer_load_dwordx4 v[132:135], v1, s[4:7], s37 offen offset:2048 sc1
    s_waitcnt lgkmcnt(3)
    v_mfma_f32_16x16x32_bf16 v[216:219], v[48:51], v[40:43], v[216:219]
    ds_read_b128 v[68:71], v11 offset:44032
    v_mfma_f32_16x16x32_bf16 v[220:223], v[48:51], v[44:47], v[220:223]
    v_mfma_f32_16x16x32_bf16 v[224:227], v[52:55], v[40:43], v[224:227]
    s_barrier
    ds_read_b128 v[48:51], v11 offset:45056
    v_mfma_f32_16x16x32_bf16 v[228:231], v[52:55], v[44:47], v[228:231]
    buffer_load_dwordx4 v[136:139], v1, s[4:7], s36 offen offset:3072 sc1
    s_waitcnt lgkmcnt(3)
    v_mfma_f32_16x16x32_bf16 v[144:147], v[56:59], a[224:227], v[144:147]
    ds_read_b128 v[52:55], v11 offset:46080
    v_mfma_f32_16x16x32_bf16 v[148:151], v[56:59], a[228:231], v[148:151]
    v_cvt_pk_bf16_f32 v192, v192, v193
    v_cvt_pk_bf16_f32 v193, v194, v195
    v_mfma_f32_16x16x32_bf16 v[152:155], v[60:63], a[224:227], v[152:155]
    ds_read_b128 v[56:59], v11 offset:47104
    buffer_load_dwordx4 v[140:143], v1, s[4:7], s37 offen offset:3072 sc1
    v_mfma_f32_16x16x32_bf16 v[156:159], v[60:63], a[228:231], v[156:159]
    s_add_u32 s36, s30, 4294952960
    s_waitcnt lgkmcnt(3)
    v_mfma_f32_16x16x32_bf16 v[144:147], v[64:67], a[232:235], v[144:147]
    ds_read_b128 v[60:63], v11 offset:48128
    s_add_u32 s37, s33, 4294952960
    v_mfma_f32_16x16x32_bf16 v[148:151], v[64:67], a[236:239], v[148:151]
    buffer_load_dwordx4 v[240:243], v1, s[4:7], s36 offen offset:0 sc1
    v_mfma_f32_16x16x32_bf16 v[152:155], v[68:71], a[232:235], v[152:155]
    ds_read_b128 v[64:67], v12 offset:24576
    v_cvt_pk_bf16_f32 v194, v196, v197
    v_mfma_f32_16x16x32_bf16 v[156:159], v[68:71], a[236:239], v[156:159]
    v_cvt_pk_bf16_f32 v195, v198, v199
    s_waitcnt lgkmcnt(3)
    v_mfma_f32_16x16x32_bf16 v[144:147], v[48:51], a[240:243], v[144:147]
    ds_read_b128 v[68:71], v12 offset:25600
    buffer_load_dwordx4 v[244:247], v1, s[4:7], s37 offen offset:0 sc1
    v_mfma_f32_16x16x32_bf16 v[148:151], v[48:51], a[244:247], v[148:151]
    buffer_store_dwordx4 v[192:195], v1, s[4:7], s43 offen offset:0 sc1
    v_mfma_f32_16x16x32_bf16 v[152:155], v[52:55], a[240:243], v[152:155]
    ds_read_b128 v[48:51], v12 offset:26624
    v_cvt_pk_bf16_f32 v200, v200, v201
    v_mfma_f32_16x16x32_bf16 v[156:159], v[52:55], a[244:247], v[156:159]
    v_cvt_pk_bf16_f32 v201, v202, v203
    s_waitcnt lgkmcnt(3)
    v_mfma_f32_16x16x32_bf16 v[144:147], v[56:59], a[248:251], v[144:147]
    ds_read_b128 v[52:55], v12 offset:27648
    buffer_load_dwordx4 v[248:251], v1, s[4:7], s36 offen offset:1024 sc1
    v_mfma_f32_16x16x32_bf16 v[148:151], v[56:59], a[252:255], v[148:151]
    v_cvt_pk_bf16_f32 v202, v204, v205
    v_cvt_pk_bf16_f32 v203, v206, v207
    v_mfma_f32_16x16x32_bf16 v[152:155], v[60:63], a[248:251], v[152:155]
    ds_read_b128 v[56:59], v12 offset:28672
    v_mfma_f32_16x16x32_bf16 v[156:159], v[60:63], a[252:255], v[156:159]
    buffer_load_dwordx4 v[252:255], v1, s[4:7], s37 offen offset:1024 sc1
    s_waitcnt lgkmcnt(3)
    v_mfma_f32_16x16x32_bf16 v[144:147], v[64:67], v[16:19], v[144:147]
    ds_read_b128 v[60:63], v12 offset:29696
    v_mfma_f32_16x16x32_bf16 v[148:151], v[64:67], v[20:23], v[148:151]
    v_mfma_f32_16x16x32_bf16 v[152:155], v[68:71], v[16:19], v[152:155]
    ds_read_b128 v[64:67], v12 offset:30720
    buffer_load_dwordx4 v[176:179], v1, s[4:7], s36 offen offset:2048 sc1
    v_mfma_f32_16x16x32_bf16 v[156:159], v[68:71], v[20:23], v[156:159]
    s_waitcnt lgkmcnt(3)
    v_mfma_f32_16x16x32_bf16 v[144:147], v[48:51], v[24:27], v[144:147]
    ds_read_b128 v[68:71], v12 offset:31744
    v_mfma_f32_16x16x32_bf16 v[148:151], v[48:51], v[28:31], v[148:151]
    buffer_load_dwordx4 v[180:183], v1, s[4:7], s37 offen offset:2048 sc1
    v_mfma_f32_16x16x32_bf16 v[152:155], v[52:55], v[24:27], v[152:155]
    ds_read_b128 v[48:51], v1 offset:8192
    buffer_store_dwordx4 v[200:203], v1, s[4:7], s43 offen offset:1024 sc1
    v_mfma_f32_16x16x32_bf16 v[156:159], v[52:55], v[28:31], v[156:159]
    v_cvt_pk_bf16_f32 v208, v208, v209
    s_waitcnt lgkmcnt(3)
    v_mfma_f32_16x16x32_bf16 v[144:147], v[56:59], v[32:35], v[144:147]
    ds_read_b128 v[52:55], v1 offset:9216
    v_cvt_pk_bf16_f32 v209, v210, v211
    v_mfma_f32_16x16x32_bf16 v[148:151], v[56:59], v[36:39], v[148:151]
    buffer_load_dwordx4 v[184:187], v1, s[4:7], s36 offen offset:3072 sc1
    v_mfma_f32_16x16x32_bf16 v[152:155], v[60:63], v[32:35], v[152:155]
    ds_read_b128 v[56:59], v1 offset:10240
    v_cvt_pk_bf16_f32 v210, v212, v213
    v_mfma_f32_16x16x32_bf16 v[156:159], v[60:63], v[36:39], v[156:159]
    v_cvt_pk_bf16_f32 v211, v214, v215
    s_waitcnt lgkmcnt(3)
    v_mfma_f32_16x16x32_bf16 v[144:147], v[64:67], v[40:43], v[144:147]
    ds_read_b128 v[60:63], v1 offset:11264
    buffer_load_dwordx4 v[188:191], v1, s[4:7], s37 offen offset:3072 sc1
    v_mfma_f32_16x16x32_bf16 v[148:151], v[64:67], v[44:47], v[148:151]
    v_mfma_f32_16x16x32_bf16 v[152:155], v[68:71], v[40:43], v[152:155]
    ds_read_b128 v[64:67], v1 offset:12288
    v_mfma_f32_16x16x32_bf16 v[156:159], v[68:71], v[44:47], v[156:159]
    s_add_u32 m0, s26, 24576
    s_add_u32 s34, s28, 16384
    buffer_load_dwordx4 v1, s[4:7], s34 offen sc1 lds
    s_waitcnt lgkmcnt(3)
    v_mfma_f32_16x16x32_bf16 v[160:163], v[48:51], a[0:3], 0
    ds_read_b128 v[68:71], v1 offset:13312
    v_mfma_f32_16x16x32_bf16 v[164:167], v[48:51], a[4:7], 0
    v_mfma_f32_16x16x32_bf16 v[168:171], v[52:55], a[0:3], 0
    ds_read_b128 v[48:51], v1 offset:14336
    buffer_load_dwordx4 v1, s[4:7], s34 offen offset:1024 sc1 lds
    v_mfma_f32_16x16x32_bf16 v[172:175], v[52:55], a[4:7], 0
    s_add_u32 s36, s30, 4294957056
    s_waitcnt lgkmcnt(3)
    v_mfma_f32_16x16x32_bf16 v[160:163], v[56:59], a[8:11], v[160:163]
    ds_read_b128 v[52:55], v1 offset:15360
    s_add_u32 s37, s33, 4294957056
    v_mfma_f32_16x16x32_bf16 v[164:167], v[56:59], a[12:15], v[164:167]
    buffer_load_dwordx4 a[0:3], v1, s[4:7], s36 offen offset:0 sc1
    v_mfma_f32_16x16x32_bf16 v[168:171], v[60:63], a[8:11], v[168:171]
    ds_read_b128 v[56:59], v1 offset:49152
    buffer_store_dwordx4 v[208:211], v1, s[4:7], s55 offen offset:0 sc1
    v_mfma_f32_16x16x32_bf16 v[172:175], v[60:63], a[12:15], v[172:175]
    v_cvt_pk_bf16_f32 v216, v216, v217
    s_waitcnt lgkmcnt(3)
    v_mfma_f32_16x16x32_bf16 v[160:163], v[64:67], a[16:19], v[160:163]
    ds_read_b128 v[60:63], v1 offset:50176
    v_cvt_pk_bf16_f32 v217, v218, v219
    v_mfma_f32_16x16x32_bf16 v[164:167], v[64:67], a[20:23], v[164:167]
    buffer_load_dwordx4 a[4:7], v1, s[4:7], s37 offen offset:0 sc1
    v_mfma_f32_16x16x32_bf16 v[168:171], v[68:71], a[16:19], v[168:171]
    ds_read_b128 v[64:67], v1 offset:51200
    v_cvt_pk_bf16_f32 v218, v220, v221
    v_mfma_f32_16x16x32_bf16 v[172:175], v[68:71], a[20:23], v[172:175]
    v_cvt_pk_bf16_f32 v219, v222, v223
    s_waitcnt lgkmcnt(3)
    v_mfma_f32_16x16x32_bf16 v[160:163], v[48:51], a[24:27], v[160:163]
    ds_read_b128 v[68:71], v1 offset:52224
    s_add_u32 m0, s26, 65536
    s_add_u32 s34, s28, 24576
    buffer_load_dwordx4 v1, s[4:7], s34 offen sc1 lds
    v_mfma_f32_16x16x32_bf16 v[164:167], v[48:51], a[28:31], v[164:167]
    v_mfma_f32_16x16x32_bf16 v[168:171], v[52:55], a[24:27], v[168:171]
    s_barrier
    ds_read_b128 v[48:51], v1 offset:53248
    v_mfma_f32_16x16x32_bf16 v[172:175], v[52:55], a[28:31], v[172:175]
    buffer_load_dwordx4 v1, s[4:7], s34 offen offset:1024 sc1 lds
    s_waitcnt lgkmcnt(3)
    v_mfma_f32_16x16x32_bf16 v[160:163], v[56:59], a[32:35], v[160:163]
    ds_read_b128 v[52:55], v1 offset:54272
    v_mfma_f32_16x16x32_bf16 v[164:167], v[56:59], a[36:39], v[164:167]
    v_mfma_f32_16x16x32_bf16 v[168:171], v[60:63], a[32:35], v[168:171]
    ds_read_b128 v[56:59], v1 offset:55296
    s_add_u32 m0, s26, 90112
    s_add_u32 s34, s28, 32768
    buffer_load_dwordx4 v1, s[4:7], s34 offen sc1 lds
    v_mfma_f32_16x16x32_bf16 v[172:175], v[60:63], a[36:39], v[172:175]
    buffer_store_dwordx4 v[216:219], v1, s[4:7], s55 offen offset:1024 sc1
    s_waitcnt lgkmcnt(3)
    v_mfma_f32_16x16x32_bf16 v[160:163], v[64:67], a[40:43], v[160:163]
    ds_read_b128 v[60:63], v1 offset:56320
    s_add_u32 s38, s21, 8192
    v_mfma_f32_16x16x32_bf16 v[164:167], v[64:67], a[44:47], v[164:167]
    v_cvt_pk_bf16_f32 v224, v224, v225
    v_cvt_pk_bf16_f32 v225, v226, v227
    v_mfma_f32_16x16x32_bf16 v[168:171], v[68:71], a[40:43], v[168:171]
    ds_read_b128 v[64:67], v1 offset:32768
    buffer_load_dwordx4 v1, s[4:7], s34 offen offset:1024 sc1 lds
    v_mfma_f32_16x16x32_bf16 v[172:175], v[68:71], a[44:47], v[172:175]
    v_cvt_pk_bf16_f32 v226, v228, v229
    s_waitcnt lgkmcnt(3)
    v_mfma_f32_16x16x32_bf16 v[160:163], v[48:51], a[48:51], v[160:163]
    ds_read_b128 v[68:71], v1 offset:33792
    v_cvt_pk_bf16_f32 v227, v230, v231
    v_mfma_f32_16x16x32_bf16 v[164:167], v[48:51], a[52:55], v[164:167]
    buffer_load_dwordx4 a[8:11], v1, s[4:7], s36 offen offset:1024 sc1
    v_mfma_f32_16x16x32_bf16 v[168:171], v[52:55], a[48:51], v[168:171]
    ds_read_b128 v[48:51], v1 offset:34816
    v_mfma_f32_16x16x32_bf16 v[172:175], v[52:55], a[52:55], v[172:175]
    s_waitcnt lgkmcnt(3)
    v_mfma_f32_16x16x32_bf16 v[160:163], v[56:59], a[56:59], v[160:163]
    ds_read_b128 v[52:55], v1 offset:35840
    buffer_load_dwordx4 a[12:15], v1, s[4:7], s37 offen offset:1024 sc1
    v_mfma_f32_16x16x32_bf16 v[164:167], v[56:59], a[60:63], v[164:167]
    v_mfma_f32_16x16x32_bf16 v[168:171], v[60:63], a[56:59], v[168:171]
    ds_read_b128 v[56:59], v1 offset:36864
    v_mfma_f32_16x16x32_bf16 v[172:175], v[60:63], a[60:63], v[172:175]
    buffer_load_dwordx4 a[16:19], v1, s[4:7], s36 offen offset:2048 sc1
    s_waitcnt lgkmcnt(3)
    v_mfma_f32_16x16x32_bf16 v[160:163], v[64:67], a[64:67], v[160:163]
    ds_read_b128 v[60:63], v1 offset:37888
    buffer_store_dwordx4 v[224:227], v1, s[4:7], s38 offen offset:0 sc1
    v_mfma_f32_16x16x32_bf16 v[164:167], v[64:67], a[68:71], v[164:167]
    v_mfma_f32_16x16x32_bf16 v[168:171], v[68:71], a[64:67], v[168:171]
    ds_read_b128 v[64:67], v1 offset:38912
    v_mfma_f32_16x16x32_bf16 v[172:175], v[68:71], a[68:71], v[172:175]
    buffer_load_dwordx4 a[20:23], v1, s[4:7], s37 offen offset:2048 sc1
    s_waitcnt lgkmcnt(3)
    v_mfma_f32_16x16x32_bf16 v[160:163], v[48:51], a[72:75], v[160:163]
    ds_read_b128 v[68:71], v1 offset:39936
    v_mfma_f32_16x16x32_bf16 v[164:167], v[48:51], a[76:79], v[164:167]
    v_mfma_f32_16x16x32_bf16 v[168:171], v[52:55], a[72:75], v[168:171]
    ds_read_b128 v[48:51], v1 offset:57344
    buffer_load_dwordx4 a[24:27], v1, s[4:7], s36 offen offset:3072 sc1
    v_mfma_f32_16x16x32_bf16 v[172:175], v[52:55], a[76:79], v[172:175]
    s_waitcnt lgkmcnt(3)
    v_mfma_f32_16x16x32_bf16 v[160:163], v[56:59], a[80:83], v[160:163]
    ds_read_b128 v[52:55], v1 offset:58368
    v_mfma_f32_16x16x32_bf16 v[164:167], v[56:59], a[84:87], v[164:167]
    buffer_load_dwordx4 a[28:31], v1, s[4:7], s37 offen offset:3072 sc1
    v_mfma_f32_16x16x32_bf16 v[168:171], v[60:63], a[80:83], v[168:171]
    ds_read_b128 v[56:59], v1 offset:59392
    s_add_u32 s36, s30, 4294961152
    v_mfma_f32_16x16x32_bf16 v[172:175], v[60:63], a[84:87], v[172:175]
    s_add_u32 s37, s33, 4294961152
    s_waitcnt lgkmcnt(3)
    v_mfma_f32_16x16x32_bf16 v[160:163], v[64:67], a[88:91], v[160:163]
    ds_read_b128 v[60:63], v1 offset:60416
    buffer_load_dwordx4 a[32:35], v1, s[4:7], s36 offen offset:0 sc1
    v_mfma_f32_16x16x32_bf16 v[164:167], v[64:67], a[92:95], v[164:167]
    v_mfma_f32_16x16x32_bf16 v[168:171], v[68:71], a[88:91], v[168:171]
    ds_read_b128 v[64:67], v1 offset:61440
    v_mfma_f32_16x16x32_bf16 v[172:175], v[68:71], a[92:95], v[172:175]
    buffer_load_dwordx4 a[36:39], v1, s[4:7], s37 offen offset:0 sc1
    s_waitcnt lgkmcnt(3)
    v_mfma_f32_16x16x32_bf16 v[160:163], v[48:51], a[96:99], v[160:163]
    ds_read_b128 v[68:71], v1 offset:62464
    v_mfma_f32_16x16x32_bf16 v[164:167], v[48:51], a[100:103], v[164:167]
    v_mfma_f32_16x16x32_bf16 v[168:171], v[52:55], a[96:99], v[168:171]
    ds_read_b128 v[48:51], v1 offset:63488
    buffer_load_dwordx4 a[40:43], v1, s[4:7], s36 offen offset:1024 sc1
    v_mfma_f32_16x16x32_bf16 v[172:175], v[52:55], a[100:103], v[172:175]
    s_waitcnt lgkmcnt(3)
    v_mfma_f32_16x16x32_bf16 v[160:163], v[56:59], a[104:107], v[160:163]
    ds_read_b128 v[52:55], v1 offset:64512
    v_mfma_f32_16x16x32_bf16 v[164:167], v[56:59], a[108:111], v[164:167]
    buffer_load_dwordx4 a[44:47], v1, s[4:7], s37 offen offset:1024 sc1
    v_mfma_f32_16x16x32_bf16 v[168:171], v[60:63], a[104:107], v[168:171]
    ds_read_b128 v[56:59], v11 offset:8192
    v_mfma_f32_16x16x32_bf16 v[172:175], v[60:63], a[108:111], v[172:175]
    s_waitcnt lgkmcnt(3)
    v_mfma_f32_16x16x32_bf16 v[160:163], v[64:67], a[112:115], v[160:163]
    ds_read_b128 v[60:63], v11 offset:9216
    buffer_load_dwordx4 a[48:51], v1, s[4:7], s36 offen offset:2048 sc1
    v_mfma_f32_16x16x32_bf16 v[164:167], v[64:67], a[116:119], v[164:167]
    v_mfma_f32_16x16x32_bf16 v[168:171], v[68:71], a[112:115], v[168:171]
    ds_read_b128 v[64:67], v11 offset:10240
    v_mfma_f32_16x16x32_bf16 v[172:175], v[68:71], a[116:119], v[172:175]
    buffer_load_dwordx4 a[52:55], v1, s[4:7], s37 offen offset:2048 sc1
    s_waitcnt lgkmcnt(3)
    v_mfma_f32_16x16x32_bf16 v[160:163], v[48:51], a[120:123], v[160:163]
    ds_read_b128 v[68:71], v11 offset:11264
    v_mfma_f32_16x16x32_bf16 v[164:167], v[48:51], a[124:127], v[164:167]
    v_mfma_f32_16x16x32_bf16 v[168:171], v[52:55], a[120:123], v[168:171]
    s_waitcnt vmcnt(47)
    s_barrier
    ds_read_b128 v[48:51], v11 offset:12288
    v_mfma_f32_16x16x32_bf16 v[172:175], v[52:55], a[124:127], v[172:175]
    buffer_load_dwordx4 a[56:59], v1, s[4:7], s36 offen offset:3072 sc1
    s_waitcnt lgkmcnt(3)
    v_mfma_f32_16x16x32_bf16 v[160:163], v[56:59], a[128:131], v[160:163]
    ds_read_b128 v[52:55], v11 offset:13312
    v_mfma_f32_16x16x32_bf16 v[164:167], v[56:59], a[132:135], v[164:167]
    v_mfma_f32_16x16x32_bf16 v[168:171], v[60:63], a[128:131], v[168:171]
    ds_read_b128 v[56:59], v11 offset:14336
    buffer_load_dwordx4 a[60:63], v1, s[4:7], s37 offen offset:3072 sc1
    v_mfma_f32_16x16x32_bf16 v[172:175], v[60:63], a[132:135], v[172:175]
    s_add_u32 s36, s30, 4294965248
    s_waitcnt lgkmcnt(3)
    v_mfma_f32_16x16x32_bf16 v[160:163], v[64:67], a[136:139], v[160:163]
    ds_read_b128 v[60:63], v11 offset:15360
    s_add_u32 s37, s33, 4294965248
    v_mfma_f32_16x16x32_bf16 v[164:167], v[64:67], a[140:143], v[164:167]
    buffer_load_dwordx4 a[64:67], v1, s[4:7], s36 offen offset:0 sc1
    v_mfma_f32_16x16x32_bf16 v[168:171], v[68:71], a[136:139], v[168:171]
    ds_read_b128 v[64:67], v12 offset:16384
    v_mfma_f32_16x16x32_bf16 v[172:175], v[68:71], a[140:143], v[172:175]
    s_waitcnt lgkmcnt(3)
    v_mfma_f32_16x16x32_bf16 v[160:163], v[48:51], a[144:147], v[160:163]
    ds_read_b128 v[68:71], v12 offset:17408
    buffer_load_dwordx4 a[68:71], v1, s[4:7], s37 offen offset:0 sc1
    v_mfma_f32_16x16x32_bf16 v[164:167], v[48:51], a[148:151], v[164:167]
    v_mov_b32 v15, s67
    v_add_u32 v15, 7, v15
    v_mfma_f32_16x16x32_bf16 v[168:171], v[52:55], a[144:147], v[168:171]
    ds_read_b128 v[48:51], v12 offset:18432
    s_waitcnt vmcnt(13)
    s_mov_b64 exec, 1
    buffer_store_dword v15, off, s[4:7], s60 sc1
    s_mov_b64 exec, -1
    v_mfma_f32_16x16x32_bf16 v[172:175], v[52:55], a[148:151], v[172:175]
    v_cvt_pk_bf16_f32 v144, v144, v145
    s_waitcnt lgkmcnt(3)
    v_mfma_f32_16x16x32_bf16 v[160:163], v[56:59], a[152:155], v[160:163]
    ds_read_b128 v[52:55], v12 offset:19456
    v_cvt_pk_bf16_f32 v145, v146, v147
    v_mfma_f32_16x16x32_bf16 v[164:167], v[56:59], a[156:159], v[164:167]
    s_add_u32 m0, s26, 122880
    s_add_u32 s34, s28, 40960
    buffer_load_dwordx4 v1, s[4:7], s34 offen sc1 lds
    v_mfma_f32_16x16x32_bf16 v[168:171], v[60:63], a[152:155], v[168:171]
    ds_read_b128 v[56:59], v12 offset:20480
    v_cvt_pk_bf16_f32 v146, v148, v149
    v_mfma_f32_16x16x32_bf16 v[172:175], v[60:63], a[156:159], v[172:175]
    v_cvt_pk_bf16_f32 v147, v150, v151
    s_waitcnt lgkmcnt(3)
    v_mfma_f32_16x16x32_bf16 v[160:163], v[64:67], a[160:163], v[160:163]
    ds_read_b128 v[60:63], v12 offset:21504
    buffer_load_dwordx4 v1, s[4:7], s34 offen offset:1024 sc1 lds
    v_mfma_f32_16x16x32_bf16 v[164:167], v[64:67], a[164:167], v[164:167]
    v_mfma_f32_16x16x32_bf16 v[168:171], v[68:71], a[160:163], v[168:171]
    ds_read_b128 v[64:67], v12 offset:22528
    v_mfma_f32_16x16x32_bf16 v[172:175], v[68:71], a[164:167], v[172:175]
    s_add_u32 m0, s26, 131072
    s_add_u32 s34, s28, 49152
    buffer_load_dwordx4 v1, s[4:7], s34 offen sc1 lds
    s_waitcnt lgkmcnt(3)
    v_mfma_f32_16x16x32_bf16 v[160:163], v[48:51], a[168:171], v[160:163]
    ds_read_b128 v[68:71], v12 offset:23552
    v_mfma_f32_16x16x32_bf16 v[164:167], v[48:51], a[172:175], v[164:167]
    v_mfma_f32_16x16x32_bf16 v[168:171], v[52:55], a[168:171], v[168:171]
    ds_read_b128 v[48:51], v1 offset:16384
    buffer_load_dwordx4 v1, s[4:7], s34 offen offset:1024 sc1 lds
    v_mfma_f32_16x16x32_bf16 v[172:175], v[52:55], a[172:175], v[172:175]
    buffer_store_dwordx4 v[144:147], v1, s[4:7], s31 offen offset:0 sc1
    s_waitcnt lgkmcnt(3)
    v_mfma_f32_16x16x32_bf16 v[160:163], v[56:59], a[176:179], v[160:163]
    ds_read_b128 v[52:55], v1 offset:17408
    v_cvt_pk_bf16_f32 v152, v152, v153
    v_mfma_f32_16x16x32_bf16 v[164:167], v[56:59], a[180:183], v[164:167]
    v_cvt_pk_bf16_f32 v153, v154, v155
    v_cvt_pk_bf16_f32 v154, v156, v157
    v_mfma_f32_16x16x32_bf16 v[168:171], v[60:63], a[176:179], v[168:171]
    ds_read_b128 v[56:59], v1 offset:18432
    buffer_load_dwordx4 a[72:75], v1, s[4:7], s36 offen offset:1024 sc1
    v_mfma_f32_16x16x32_bf16 v[172:175], v[60:63], a[180:183], v[172:175]
    v_cvt_pk_bf16_f32 v155, v158, v159
    s_waitcnt lgkmcnt(3)
    v_mfma_f32_16x16x32_bf16 v[160:163], v[64:67], a[184:187], v[160:163]
    ds_read_b128 v[60:63], v1 offset:19456
    v_mfma_f32_16x16x32_bf16 v[164:167], v[64:67], a[188:191], v[164:167]
    buffer_load_dwordx4 a[76:79], v1, s[4:7], s37 offen offset:1024 sc1
    v_mfma_f32_16x16x32_bf16 v[168:171], v[68:71], a[184:187], v[168:171]
    ds_read_b128 v[64:67], v1 offset:20480
    v_mfma_f32_16x16x32_bf16 v[172:175], v[68:71], a[188:191], v[172:175]
    s_waitcnt lgkmcnt(3)
    v_mfma_f32_16x16x32_bf16 v[160:163], v[48:51], a[192:195], v[160:163]
    ds_read_b128 v[68:71], v1 offset:21504
    v_mfma_f32_16x16x32_bf16 v[164:167], v[48:51], a[196:199], v[164:167]
    v_mfma_f32_16x16x32_bf16 v[168:171], v[52:55], a[192:195], v[168:171]
    ds_read_b128 v[48:51], v1 offset:22528
    v_mfma_f32_16x16x32_bf16 v[172:175], v[52:55], a[196:199], v[172:175]
    s_waitcnt lgkmcnt(3)
    v_mfma_f32_16x16x32_bf16 v[160:163], v[56:59], a[200:203], v[160:163]
    ds_read_b128 v[52:55], v1 offset:23552
    buffer_store_dwordx4 v[152:155], v1, s[4:7], s31 offen offset:1024 sc1
    v_mfma_f32_16x16x32_bf16 v[164:167], v[56:59], a[204:207], v[164:167]
    v_mfma_f32_16x16x32_bf16 v[168:171], v[60:63], a[200:203], v[168:171]
    ds_read_b128 v[56:59], v11 offset:16384
    v_mfma_f32_16x16x32_bf16 v[172:175], v[60:63], a[204:207], v[172:175]
    s_waitcnt lgkmcnt(3)
    v_mfma_f32_16x16x32_bf16 v[160:163], v[64:67], a[208:211], v[160:163]
    ds_read_b128 v[60:63], v11 offset:17408
    v_mfma_f32_16x16x32_bf16 v[164:167], v[64:67], a[212:215], v[164:167]
    v_mfma_f32_16x16x32_bf16 v[168:171], v[68:71], a[208:211], v[168:171]
    ds_read_b128 v[64:67], v11 offset:18432
    v_mfma_f32_16x16x32_bf16 v[172:175], v[68:71], a[212:215], v[172:175]
    s_waitcnt lgkmcnt(3)
    v_mfma_f32_16x16x32_bf16 v[160:163], v[48:51], a[216:219], v[160:163]
    ds_read_b128 v[68:71], v11 offset:19456
    v_mfma_f32_16x16x32_bf16 v[164:167], v[48:51], a[220:223], v[164:167]
    v_mfma_f32_16x16x32_bf16 v[168:171], v[52:55], a[216:219], v[168:171]
    s_barrier
    ds_read_b128 v[48:51], v11 offset:20480
    v_mfma_f32_16x16x32_bf16 v[172:175], v[52:55], a[220:223], v[172:175]
    s_waitcnt lgkmcnt(3)
    v_mfma_f32_16x16x32_bf16 v[160:163], v[56:59], a[224:227], v[160:163]
    ds_read_b128 v[52:55], v11 offset:21504
    v_mfma_f32_16x16x32_bf16 v[164:167], v[56:59], a[228:231], v[164:167]
    v_mfma_f32_16x16x32_bf16 v[168:171], v[60:63], a[224:227], v[168:171]
    ds_read_b128 v[56:59], v11 offset:22528
    v_mfma_f32_16x16x32_bf16 v[172:175], v[60:63], a[228:231], v[172:175]
    s_waitcnt lgkmcnt(3)
    v_mfma_f32_16x16x32_bf16 v[160:163], v[64:67], a[232:235], v[160:163]
    ds_read_b128 v[60:63], v11 offset:23552
    v_mfma_f32_16x16x32_bf16 v[164:167], v[64:67], a[236:239], v[164:167]
    v_mfma_f32_16x16x32_bf16 v[168:171], v[68:71], a[232:235], v[168:171]
    ds_read_b128 v[64:67], v1 offset:0
    v_mfma_f32_16x16x32_bf16 v[172:175], v[68:71], a[236:239], v[172:175]
    s_waitcnt lgkmcnt(3)
    v_mfma_f32_16x16x32_bf16 v[160:163], v[48:51], a[240:243], v[160:163]
    ds_read_b128 v[68:71], v1 offset:1024
    v_mfma_f32_16x16x32_bf16 v[164:167], v[48:51], a[244:247], v[164:167]
    v_mfma_f32_16x16x32_bf16 v[168:171], v[52:55], a[240:243], v[168:171]
    ds_read_b128 v[48:51], v1 offset:2048
    v_mfma_f32_16x16x32_bf16 v[172:175], v[52:55], a[244:247], v[172:175]
    s_waitcnt lgkmcnt(3)
    v_mfma_f32_16x16x32_bf16 v[160:163], v[56:59], a[248:251], v[160:163]
    ds_read_b128 v[52:55], v1 offset:3072
    v_mfma_f32_16x16x32_bf16 v[164:167], v[56:59], a[252:255], v[164:167]
    v_mfma_f32_16x16x32_bf16 v[168:171], v[60:63], a[248:251], v[168:171]
    ds_read_b128 v[56:59], v1 offset:4096
    v_mfma_f32_16x16x32_bf16 v[172:175], v[60:63], a[252:255], v[172:175]
    s_waitcnt lgkmcnt(3)
    v_mfma_f32_16x16x32_bf16 v[160:163], v[64:67], v[16:19], v[160:163]
    ds_read_b128 v[60:63], v1 offset:5120
    v_mfma_f32_16x16x32_bf16 v[164:167], v[64:67], v[20:23], v[164:167]
    v_mfma_f32_16x16x32_bf16 v[168:171], v[68:71], v[16:19], v[168:171]
    ds_read_b128 v[64:67], v1 offset:6144
    v_mfma_f32_16x16x32_bf16 v[172:175], v[68:71], v[20:23], v[172:175]
    s_waitcnt lgkmcnt(3)
    v_mfma_f32_16x16x32_bf16 v[160:163], v[48:51], v[24:27], v[160:163]
    ds_read_b128 v[68:71], v1 offset:7168
    v_mfma_f32_16x16x32_bf16 v[164:167], v[48:51], v[28:31], v[164:167]
    v_mfma_f32_16x16x32_bf16 v[168:171], v[52:55], v[24:27], v[168:171]
    ds_read_b128 v[48:51], v1 offset:40960
    v_mfma_f32_16x16x32_bf16 v[172:175], v[52:55], v[28:31], v[172:175]
    s_waitcnt lgkmcnt(3)
    v_mfma_f32_16x16x32_bf16 v[160:163], v[56:59], v[32:35], v[160:163]
    ds_read_b128 v[52:55], v1 offset:41984
    v_mfma_f32_16x16x32_bf16 v[164:167], v[56:59], v[36:39], v[164:167]
    v_mfma_f32_16x16x32_bf16 v[168:171], v[60:63], v[32:35], v[168:171]
    ds_read_b128 v[56:59], v1 offset:43008
    v_mfma_f32_16x16x32_bf16 v[172:175], v[60:63], v[36:39], v[172:175]
    s_waitcnt lgkmcnt(3)
    v_mfma_f32_16x16x32_bf16 v[160:163], v[64:67], v[40:43], v[160:163]
    ds_read_b128 v[60:63], v1 offset:44032
    v_mfma_f32_16x16x32_bf16 v[164:167], v[64:67], v[44:47], v[164:167]
    v_mfma_f32_16x16x32_bf16 v[168:171], v[68:71], v[40:43], v[168:171]
    ds_read_b128 v[64:67], v1 offset:45056
    v_mfma_f32_16x16x32_bf16 v[172:175], v[68:71], v[44:47], v[172:175]
    s_waitcnt lgkmcnt(3)
    v_mfma_f32_16x16x32_bf16 v[112:115], v[48:51], v[96:99], 0
    ds_read_b128 v[68:71], v1 offset:46080
    v_mfma_f32_16x16x32_bf16 v[116:119], v[48:51], v[100:103], 0
    v_mfma_f32_16x16x32_bf16 v[120:123], v[52:55], v[96:99], 0
    ds_read_b128 v[48:51], v1 offset:47104
    v_mfma_f32_16x16x32_bf16 v[124:127], v[52:55], v[100:103], 0
    s_waitcnt lgkmcnt(3)
    v_mfma_f32_16x16x32_bf16 v[232:235], v[56:59], v[96:99], 0
    ds_read_b128 v[52:55], v1 offset:48128
    v_mfma_f32_16x16x32_bf16 v[236:239], v[56:59], v[100:103], 0
    v_mfma_f32_16x16x32_bf16 v[112:115], v[60:63], v[104:107], v[112:115]
    ds_read_b128 v[56:59], v11 offset:32768
    v_mfma_f32_16x16x32_bf16 v[116:119], v[60:63], v[108:111], v[116:119]
    s_waitcnt lgkmcnt(3)
    v_mfma_f32_16x16x32_bf16 v[120:123], v[64:67], v[104:107], v[120:123]
    ds_read_b128 v[60:63], v11 offset:33792
    v_mfma_f32_16x16x32_bf16 v[124:127], v[64:67], v[108:111], v[124:127]
    v_mfma_f32_16x16x32_bf16 v[232:235], v[68:71], v[104:107], v[232:235]
    ds_read_b128 v[64:67], v11 offset:34816
    v_mfma_f32_16x16x32_bf16 v[236:239], v[68:71], v[108:111], v[236:239]
    s_waitcnt lgkmcnt(3)
    v_mfma_f32_16x16x32_bf16 v[112:115], v[48:51], v[128:131], v[112:115]
    ds_read_b128 v[68:71], v11 offset:35840
    buffer_load_dwordx2 v[72:73], v2, s[8:11], s56 offen offset:0
    v_mfma_f32_16x16x32_bf16 v[116:119], v[48:51], v[132:135], v[116:119]
    v_mfma_f32_16x16x32_bf16 v[120:123], v[52:55], v[128:131], v[120:123]
    s_barrier
    ds_read_b128 v[48:51], v11 offset:36864
    v_mfma_f32_16x16x32_bf16 v[124:127], v[52:55], v[132:135], v[124:127]
    s_waitcnt lgkmcnt(3)
    v_mfma_f32_16x16x32_bf16 v[232:235], v[56:59], v[128:131], v[232:235]
    ds_read_b128 v[52:55], v11 offset:37888
    buffer_load_dwordx2 v[74:75], v2, s[8:11], s64 offen offset:0
    v_mfma_f32_16x16x32_bf16 v[236:239], v[56:59], v[132:135], v[236:239]
    v_mfma_f32_16x16x32_bf16 v[112:115], v[60:63], v[136:139], v[112:115]
    ds_read_b128 v[56:59], v11 offset:38912
    v_mfma_f32_16x16x32_bf16 v[116:119], v[60:63], v[140:143], v[116:119]
    s_waitcnt lgkmcnt(3)
    v_mfma_f32_16x16x32_bf16 v[120:123], v[64:67], v[136:139], v[120:123]
    ds_read_b128 v[60:63], v11 offset:39936
    buffer_load_dwordx2 v[76:77], v2, s[8:11], s56 offen offset:32
    v_mfma_f32_16x16x32_bf16 v[124:127], v[64:67], v[140:143], v[124:127]
    v_mfma_f32_16x16x32_bf16 v[232:235], v[68:71], v[136:139], v[232:235]
    ds_read_b128 v[64:67], v1 offset:24576
    v_mfma_f32_16x16x32_bf16 v[236:239], v[68:71], v[140:143], v[236:239]
    s_waitcnt lgkmcnt(3)
    v_mfma_f32_16x16x32_bf16 v[112:115], v[48:51], v[240:243], v[112:115]
    ds_read_b128 v[68:71], v1 offset:25600
    buffer_load_dwordx2 v[78:79], v2, s[8:11], s64 offen offset:32
    v_mfma_f32_16x16x32_bf16 v[116:119], v[48:51], v[244:247], v[116:119]
    v_mfma_f32_16x16x32_bf16 v[120:123], v[52:55], v[240:243], v[120:123]
    ds_read_b128 v[48:51], v1 offset:26624
    v_mfma_f32_16x16x32_bf16 v[124:127], v[52:55], v[244:247], v[124:127]
    s_waitcnt lgkmcnt(3)
    v_mfma_f32_16x16x32_bf16 v[232:235], v[56:59], v[240:243], v[232:235]
    ds_read_b128 v[52:55], v1 offset:27648
    buffer_load_dwordx2 v[80:81], v2, s[8:11], s46 offen offset:0
    v_mfma_f32_16x16x32_bf16 v[236:239], v[56:59], v[244:247], v[236:239]
    v_mfma_f32_16x16x32_bf16 v[112:115], v[60:63], v[248:251], v[112:115]
    ds_read_b128 v[56:59], v1 offset:28672
    v_mfma_f32_16x16x32_bf16 v[116:119], v[60:63], v[252:255], v[116:119]
    s_waitcnt lgkmcnt(3)
    v_mfma_f32_16x16x32_bf16 v[120:123], v[64:67], v[248:251], v[120:123]
    ds_read_b128 v[60:63], v1 offset:29696
    buffer_load_dwordx2 v[82:83], v2, s[8:11], s57 offen offset:0
    v_mfma_f32_16x16x32_bf16 v[124:127], v[64:67], v[252:255], v[124:127]
    v_mfma_f32_16x16x32_bf16 v[232:235], v[68:71], v[248:251], v[232:235]
    ds_read_b128 v[64:67], v1 offset:30720
    v_mfma_f32_16x16x32_bf16 v[236:239], v[68:71], v[252:255], v[236:239]
    s_waitcnt lgkmcnt(3)
    v_mfma_f32_16x16x32_bf16 v[112:115], v[48:51], v[176:179], v[112:115]
    ds_read_b128 v[68:71], v1 offset:31744
    v_lshlrev_b32 v15, 5, v0
    s_mov_b64 exec, s[76:77]
    buffer_load_dword v15, v15, s[4:7], s78 offen sc1
    s_mov_b64 exec, -1
    v_mfma_f32_16x16x32_bf16 v[116:119], v[48:51], v[180:183], v[116:119]
    v_mfma_f32_16x16x32_bf16 v[120:123], v[52:55], v[176:179], v[120:123]
    ds_read_b128 v[48:51], v11 offset:0
    v_mfma_f32_16x16x32_bf16 v[124:127], v[52:55], v[180:183], v[124:127]
    s_waitcnt lgkmcnt(3)
    v_mfma_f32_16x16x32_bf16 v[232:235], v[56:59], v[176:179], v[232:235]
    ds_read_b128 v[52:55], v11 offset:1024
    v_mfma_f32_16x16x32_bf16 v[236:239], v[56:59], v[180:183], v[236:239]
    v_mfma_f32_16x16x32_bf16 v[112:115], v[60:63], v[184:187], v[112:115]
    ds_read_b128 v[56:59], v11 offset:2048
    v_mfma_f32_16x16x32_bf16 v[116:119], v[60:63], v[188:191], v[116:119]
    s_waitcnt lgkmcnt(3)
    v_mfma_f32_16x16x32_bf16 v[120:123], v[64:67], v[184:187], v[120:123]
    ds_read_b128 v[60:63], v11 offset:3072
    v_mfma_f32_16x16x32_bf16 v[124:127], v[64:67], v[188:191], v[124:127]
    v_mfma_f32_16x16x32_bf16 v[232:235], v[68:71], v[184:187], v[232:235]
    ds_read_b128 v[64:67], v11 offset:4096
    v_mfma_f32_16x16x32_bf16 v[236:239], v[68:71], v[188:191], v[236:239]
    s_waitcnt lgkmcnt(3)
    v_mfma_f32_16x16x32_bf16 v[112:115], v[48:51], a[0:3], v[112:115]
    ds_read_b128 v[68:71], v11 offset:5120
    v_mfma_f32_16x16x32_bf16 v[116:119], v[48:51], a[4:7], v[116:119]
    v_mfma_f32_16x16x32_bf16 v[120:123], v[52:55], a[0:3], v[120:123]
    ds_read_b128 v[48:51], v11 offset:6144
    v_mfma_f32_16x16x32_bf16 v[124:127], v[52:55], a[4:7], v[124:127]
    s_waitcnt lgkmcnt(3)
    v_mfma_f32_16x16x32_bf16 v[232:235], v[56:59], a[0:3], v[232:235]
    ds_read_b128 v[52:55], v11 offset:7168
    v_mfma_f32_16x16x32_bf16 v[236:239], v[56:59], a[4:7], v[236:239]
    v_mfma_f32_16x16x32_bf16 v[112:115], v[60:63], a[8:11], v[112:115]
    ds_read_b128 v[56:59], v11 offset:24576
    v_mfma_f32_16x16x32_bf16 v[116:119], v[60:63], a[12:15], v[116:119]
    s_waitcnt lgkmcnt(3)
    v_mfma_f32_16x16x32_bf16 v[120:123], v[64:67], a[8:11], v[120:123]
    ds_read_b128 v[60:63], v11 offset:25600
    v_mfma_f32_16x16x32_bf16 v[124:127], v[64:67], a[12:15], v[124:127]
    v_mfma_f32_16x16x32_bf16 v[232:235], v[68:71], a[8:11], v[232:235]
    ds_read_b128 v[64:67], v11 offset:26624
    v_mfma_f32_16x16x32_bf16 v[236:239], v[68:71], a[12:15], v[236:239]
    s_waitcnt lgkmcnt(3)
    v_mfma_f32_16x16x32_bf16 v[112:115], v[48:51], a[16:19], v[112:115]
    ds_read_b128 v[68:71], v11 offset:27648
    s_waitcnt vmcnt(28)
    v_mfma_f32_16x16x32_bf16 v[116:119], v[48:51], a[20:23], v[116:119]
    v_mfma_f32_16x16x32_bf16 v[120:123], v[52:55], a[16:19], v[120:123]
    s_waitcnt vmcnt(11)
    s_barrier
    ds_read_b128 v[48:51], v11 offset:28672
    v_mfma_f32_16x16x32_bf16 v[124:127], v[52:55], a[20:23], v[124:127]
    s_waitcnt lgkmcnt(3)
    v_mfma_f32_16x16x32_bf16 v[232:235], v[56:59], a[16:19], v[232:235]
    ds_read_b128 v[52:55], v11 offset:29696
    v_mfma_f32_16x16x32_bf16 v[236:239], v[56:59], a[20:23], v[236:239]
    v_mfma_f32_16x16x32_bf16 v[112:115], v[60:63], a[24:27], v[112:115]
    ds_read_b128 v[56:59], v11 offset:30720
    v_mfma_f32_16x16x32_bf16 v[116:119], v[60:63], a[28:31], v[116:119]
    s_waitcnt lgkmcnt(3)
    v_mfma_f32_16x16x32_bf16 v[120:123], v[64:67], a[24:27], v[120:123]
    ds_read_b128 v[60:63], v11 offset:31744
    v_mfma_f32_16x16x32_bf16 v[124:127], v[64:67], a[28:31], v[124:127]
    v_mfma_f32_16x16x32_bf16 v[232:235], v[68:71], a[24:27], v[232:235]
    ds_read_b128 v[64:67], v11 offset:57344
    v_mfma_f32_16x16x32_bf16 v[236:239], v[68:71], a[28:31], v[236:239]
    s_waitcnt lgkmcnt(3)
    v_mfma_f32_16x16x32_bf16 v[112:115], v[48:51], a[32:35], v[112:115]
    ds_read_b128 v[68:71], v11 offset:58368
    v_mfma_f32_16x16x32_bf16 v[116:119], v[48:51], a[36:39], v[116:119]
    s_add_u32 s38, s67, 7
    s_waitcnt vmcnt(0)
    v_subrev_u32 v15, s38, v15
    v_cmp_gt_u32 vcc, 8, v15
    s_nop 1
    s_andn2_b64 vcc, s[76:77], vcc
    s_cbranch_scc1 Lsn_o_spin
Lsn_o_back:
    v_mfma_f32_16x16x32_bf16 v[120:123], v[52:55], a[32:35], v[120:123]
    ds_read_b128 v[48:51], v11 offset:59392
    buffer_load_dwordx4 v[200:203], v1, s[4:7], s41 offen offset:0 sc1
    v_mfma_f32_16x16x32_bf16 v[124:127], v[52:55], a[36:39], v[124:127]
    s_waitcnt lgkmcnt(3)
    v_mfma_f32_16x16x32_bf16 v[232:235], v[56:59], a[32:35], v[232:235]
    ds_read_b128 v[52:55], v11 offset:60416
    v_mfma_f32_16x16x32_bf16 v[236:239], v[56:59], a[36:39], v[236:239]
    v_mfma_f32_16x16x32_bf16 v[112:115], v[60:63], a[40:43], v[112:115]
    ds_read_b128 v[56:59], v11 offset:61440
    buffer_load_dwordx4 v[204:207], v1, s[4:7], s41 offen offset:1024 sc1
    v_mfma_f32_16x16x32_bf16 v[116:119], v[60:63], a[44:47], v[116:119]
    s_waitcnt lgkmcnt(3)
    v_mfma_f32_16x16x32_bf16 v[120:123], v[64:67], a[40:43], v[120:123]
    ds_read_b128 v[60:63], v11 offset:62464
    v_mfma_f32_16x16x32_bf16 v[124:127], v[64:67], a[44:47], v[124:127]
    v_mfma_f32_16x16x32_bf16 v[232:235], v[68:71], a[40:43], v[232:235]
    ds_read_b128 v[64:67], v11 offset:63488
    buffer_load_dwordx4 v[208:211], v1, s[4:7], s42 offen offset:0 sc1
    v_mfma_f32_16x16x32_bf16 v[236:239], v[68:71], a[44:47], v[236:239]
    s_waitcnt lgkmcnt(3)
    v_mfma_f32_16x16x32_bf16 v[112:115], v[48:51], a[48:51], v[112:115]
    ds_read_b128 v[68:71], v11 offset:64512
    v_mfma_f32_16x16x32_bf16 v[116:119], v[48:51], a[52:55], v[116:119]
    v_mfma_f32_16x16x32_bf16 v[120:123], v[52:55], a[48:51], v[120:123]
    ds_read_b128 v[48:51], v12 offset:0
    buffer_load_dwordx4 v[212:215], v1, s[4:7], s42 offen offset:1024 sc1
    v_mfma_f32_16x16x32_bf16 v[124:127], v[52:55], a[52:55], v[124:127]
    s_add_u32 s38, s22, 8192
    s_waitcnt lgkmcnt(3)
    v_mfma_f32_16x16x32_bf16 v[232:235], v[56:59], a[48:51], v[232:235]
    ds_read_b128 v[52:55], v12 offset:1024
    v_mfma_f32_16x16x32_bf16 v[236:239], v[56:59], a[52:55], v[236:239]
    v_mfma_f32_16x16x32_bf16 v[112:115], v[60:63], a[56:59], v[112:115]
    ds_read_b128 v[56:59], v12 offset:2048
    buffer_load_dwordx4 v[216:219], v4, s[4:7], s38 offen sc1
    v_mfma_f32_16x16x32_bf16 v[116:119], v[60:63], a[60:63], v[116:119]
    s_add_u32 s38, s22, 45056
    s_waitcnt lgkmcnt(3)
    v_mfma_f32_16x16x32_bf16 v[120:123], v[64:67], a[56:59], v[120:123]
    ds_read_b128 v[60:63], v12 offset:3072
    v_mfma_f32_16x16x32_bf16 v[124:127], v[64:67], a[60:63], v[124:127]
    v_mfma_f32_16x16x32_bf16 v[232:235], v[68:71], a[56:59], v[232:235]
    ds_read_b128 v[64:67], v12 offset:4096
    buffer_load_dwordx4 v[220:223], v4, s[4:7], s38 offen sc1
    v_mfma_f32_16x16x32_bf16 v[236:239], v[68:71], a[60:63], v[236:239]
    s_add_u32 s38, s22, 81920
    s_waitcnt lgkmcnt(3)
    v_mfma_f32_16x16x32_bf16 v[112:115], v[48:51], a[64:67], v[112:115]
    ds_read_b128 v[68:71], v12 offset:5120
    v_mfma_f32_16x16x32_bf16 v[116:119], v[48:51], a[68:71], v[116:119]
    v_mfma_f32_16x16x32_bf16 v[120:123], v[52:55], a[64:67], v[120:123]
    buffer_load_dwordx4 v[224:227], v4, s[4:7], s38 offen sc1
    v_mfma_f32_16x16x32_bf16 v[124:127], v[52:55], a[68:71], v[124:127]
    s_add_u32 s38, s22, 118784
    s_waitcnt lgkmcnt(2)
    v_mfma_f32_16x16x32_bf16 v[232:235], v[56:59], a[64:67], v[232:235]
    v_mfma_f32_16x16x32_bf16 v[236:239], v[56:59], a[68:71], v[236:239]
    v_mfma_f32_16x16x32_bf16 v[112:115], v[60:63], a[72:75], v[112:115]
    buffer_load_dwordx4 v[228:231], v4, s[4:7], s38 offen sc1
    v_mfma_f32_16x16x32_bf16 v[116:119], v[60:63], a[76:79], v[116:119]
    s_waitcnt lgkmcnt(0)
    v_mfma_f32_16x16x32_bf16 v[120:123], v[64:67], a[72:75], v[120:123]
    v_mfma_f32_16x16x32_bf16 v[124:127], v[64:67], a[76:79], v[124:127]
    v_mfma_f32_16x16x32_bf16 v[232:235], v[68:71], a[72:75], v[232:235]
    buffer_load_dwordx4 v[192:195], v1, s[4:7], s45 offen offset:0 sc1
    v_mfma_f32_16x16x32_bf16 v[236:239], v[68:71], a[76:79], v[236:239]
    buffer_load_dwordx4 v[196:199], v1, s[4:7], s45 offen offset:1024 sc1
    s_mov_b32 s39, 100000
Lchk_o:
    s_waitcnt vmcnt(0)
    v_max3_u32 v14, v192, v193, v194
    v_max3_u32 v15, v195, v196, v197
    v_max3_u32 v14, v14, v198, v199
    v_max_u32 v14, v14, v15
    v_cmp_eq_u32 vcc, -1, v14
    s_nop 4
    s_cbranch_vccz Lok_o
    s_sub_u32 s39, s39, 1
    s_cmp_eq_u32 s39, 0
    s_cbranch_scc1 Lok_o
    buffer_load_dwordx4 v[192:195], v1, s[4:7], s45 offen offset:0 sc1
    buffer_load_dwordx4 v[196:199], v1, s[4:7], s45 offen offset:1024 sc1
    s_branch Lchk_o
Lok_o:
    v_dot2_f32_bf16 v160, v192, s59, v160
    v_dot2_f32_bf16 v160, v200, s59, v160
    v_dot2_f32_bf16 v160, v208, s59, v160
    v_dot2_f32_bf16 v161, v192, s58, v161
    v_dot2_f32_bf16 v161, v200, s58, v161
    v_dot2_f32_bf16 v161, v208, s58, v161
    v_dot2_f32_bf16 v162, v193, s59, v162
    v_dot2_f32_bf16 v162, v201, s59, v162
    v_dot2_f32_bf16 v162, v209, s59, v162
    v_dot2_f32_bf16 v163, v193, s58, v163
    v_dot2_f32_bf16 v163, v201, s58, v163
    v_dot2_f32_bf16 v163, v209, s58, v163
    v_mul_f32 v240, s62, v160
    v_mul_f32 v241, s62, v161
    v_mul_f32 v242, s62, v162
    v_mul_f32 v243, s62, v163
    v_exp_f32 v240, v240
    v_exp_f32 v241, v241
    v_exp_f32 v242, v242
    v_exp_f32 v243, v243
    v_mul_f32 v160, v160, v112
    v_mul_f32 v161, v161, v113
    v_mul_f32 v162, v162, v114
    v_mul_f32 v163, v163, v115
    v_add_f32 v240, 1.0, v240
    v_add_f32 v241, 1.0, v241
    v_add_f32 v242, 1.0, v242
    v_add_f32 v243, 1.0, v243
    v_rcp_f32 v240, v240
    v_rcp_f32 v241, v241
    v_rcp_f32 v242, v242
    v_rcp_f32 v243, v243
    v_lshlrev_b32 v244, 16, v72
    v_and_b32 v245, 0xffff0000, v72
    v_lshlrev_b32 v246, 16, v73
    v_and_b32 v247, 0xffff0000, v73
    v_fma_f32 v160, v160, v240, v244
    v_fma_f32 v161, v161, v241, v245
    v_fma_f32 v162, v162, v242, v246
    v_fma_f32 v163, v163, v243, v247
    v_cvt_pk_bf16_f32 v252, v160, v161
    v_cvt_pk_bf16_f32 v253, v162, v163
    buffer_store_dwordx2 v[252:253], v2, s[12:15], s56 offen offset:0
    v_dot2_f32_bf16 v164, v194, s59, v164
    v_dot2_f32_bf16 v164, v202, s59, v164
    v_dot2_f32_bf16 v164, v210, s59, v164
    v_dot2_f32_bf16 v165, v194, s58, v165
    v_dot2_f32_bf16 v165, v202, s58, v165
    v_dot2_f32_bf16 v165, v210, s58, v165
    v_dot2_f32_bf16 v166, v195, s59, v166
    v_dot2_f32_bf16 v166, v203, s59, v166
    v_dot2_f32_bf16 v166, v211, s59, v166
    v_dot2_f32_bf16 v167, v195, s58, v167
    v_dot2_f32_bf16 v167, v203, s58, v167
    v_dot2_f32_bf16 v167, v211, s58, v167
    v_mul_f32 v96, s62, v164
    v_mul_f32 v97, s62, v165
    v_mul_f32 v98, s62, v166
    v_mul_f32 v99, s62, v167
    v_exp_f32 v96, v96
    v_exp_f32 v97, v97
    v_exp_f32 v98, v98
    v_exp_f32 v99, v99
    v_mul_f32 v164, v164, v116
    v_mul_f32 v165, v165, v117
    v_mul_f32 v166, v166, v118
    v_mul_f32 v167, v167, v119
    v_add_f32 v96, 1.0, v96
    v_add_f32 v97, 1.0, v97
    v_add_f32 v98, 1.0, v98
    v_add_f32 v99, 1.0, v99
    v_rcp_f32 v96, v96
    v_rcp_f32 v97, v97
    v_rcp_f32 v98, v98
    v_rcp_f32 v99, v99
    v_lshlrev_b32 v100, 16, v74
    v_and_b32 v101, 0xffff0000, v74
    v_lshlrev_b32 v102, 16, v75
    v_and_b32 v103, 0xffff0000, v75
    v_fma_f32 v164, v164, v96, v100
    v_fma_f32 v165, v165, v97, v101
    v_fma_f32 v166, v166, v98, v102
    v_fma_f32 v167, v167, v99, v103
    v_cvt_pk_bf16_f32 v108, v164, v165
    v_cvt_pk_bf16_f32 v109, v166, v167
    buffer_store_dwordx2 v[108:109], v2, s[12:15], s64 offen offset:0
    v_dot2_f32_bf16 v168, v196, s59, v168
    v_dot2_f32_bf16 v168, v204, s59, v168
    v_dot2_f32_bf16 v168, v212, s59, v168
    v_dot2_f32_bf16 v169, v196, s58, v169
    v_dot2_f32_bf16 v169, v204, s58, v169
    v_dot2_f32_bf16 v169, v212, s58, v169
    v_dot2_f32_bf16 v170, v197, s59, v170
    v_dot2_f32_bf16 v170, v205, s59, v170
    v_dot2_f32_bf16 v170, v213, s59, v170
    v_dot2_f32_bf16 v171, v197, s58, v171
    v_dot2_f32_bf16 v171, v205, s58, v171
    v_dot2_f32_bf16 v171, v213, s58, v171
    v_mul_f32 v128, s62, v168
    v_mul_f32 v129, s62, v169
    v_mul_f32 v130, s62, v170
    v_mul_f32 v131, s62, v171
    v_exp_f32 v128, v128
    v_exp_f32 v129, v129
    v_exp_f32 v130, v130
    v_exp_f32 v131, v131
    v_mul_f32 v168, v168, v120
    v_mul_f32 v169, v169, v121
    v_mul_f32 v170, v170, v122
    v_mul_f32 v171, v171, v123
    v_add_f32 v128, 1.0, v128
    v_add_f32 v129, 1.0, v129
    v_add_f32 v130, 1.0, v130
    v_add_f32 v131, 1.0, v131
    v_rcp_f32 v128, v128
    v_rcp_f32 v129, v129
    v_rcp_f32 v130, v130
    v_rcp_f32 v131, v131
    v_lshlrev_b32 v132, 16, v76
    v_and_b32 v133, 0xffff0000, v76
    v_lshlrev_b32 v134, 16, v77
    v_and_b32 v135, 0xffff0000, v77
    v_fma_f32 v168, v168, v128, v132
    v_fma_f32 v169, v169, v129, v133
    v_fma_f32 v170, v170, v130, v134
    v_fma_f32 v171, v171, v131, v135
    v_cvt_pk_bf16_f32 v140, v168, v169
    v_cvt_pk_bf16_f32 v141, v170, v171
    buffer_store_dwordx2 v[140:141], v2, s[12:15], s56 offen offset:32
    v_dot2_f32_bf16 v172, v198, s59, v172
    v_dot2_f32_bf16 v172, v206, s59, v172
    v_dot2_f32_bf16 v172, v214, s59, v172
    v_dot2_f32_bf16 v173, v198, s58, v173
    v_dot2_f32_bf16 v173, v206, s58, v173
    v_dot2_f32_bf16 v173, v214, s58, v173
    v_dot2_f32_bf16 v174, v199, s59, v174
    v_dot2_f32_bf16 v174, v207, s59, v174
    v_dot2_f32_bf16 v174, v215, s59, v174
    v_dot2_f32_bf16 v175, v199, s58, v175
    v_dot2_f32_bf16 v175, v207, s58, v175
    v_dot2_f32_bf16 v175, v215, s58, v175
    v_mul_f32 v176, s62, v172
    v_mul_f32 v177, s62, v173
    v_mul_f32 v178, s62, v174
    v_mul_f32 v179, s62, v175
    v_exp_f32 v176, v176
    v_exp_f32 v177, v177
    v_exp_f32 v178, v178
    v_exp_f32 v179, v179
    v_mul_f32 v172, v172, v124
    v_mul_f32 v173, v173, v125
    v_mul_f32 v174, v174, v126
    v_mul_f32 v175, v175, v127
    v_add_f32 v176, 1.0, v176
    v_add_f32 v177, 1.0, v177
    v_add_f32 v178, 1.0, v178
    v_add_f32 v179, 1.0, v179
    v_rcp_f32 v176, v176
    v_rcp_f32 v177, v177
    v_rcp_f32 v178, v178
    v_rcp_f32 v179, v179
    v_lshlrev_b32 v180, 16, v78
    v_and_b32 v181, 0xffff0000, v78
    v_lshlrev_b32 v182, 16, v79
    v_and_b32 v183, 0xffff0000, v79
    v_fma_f32 v172, v172, v176, v180
    v_fma_f32 v173, v173, v177, v181
    v_fma_f32 v174, v174, v178, v182
    v_fma_f32 v175, v175, v179, v183
    v_cvt_pk_bf16_f32 v188, v172, v173
    v_cvt_pk_bf16_f32 v189, v174, v175
    buffer_store_dwordx2 v[188:189], v2, s[12:15], s64 offen offset:32
    s_cmp_eq_u32 s3, s65
    s_cbranch_scc0 Ldone_o
    v_dot2_f32_bf16 v24, v216, s59, 0
    v_dot2_f32_bf16 v24, v220, s59, v24
    v_dot2_f32_bf16 v24, v224, s59, v24
    v_dot2_f32_bf16 v24, v228, s59, v24
    v_dot2_f32_bf16 v25, v216, s58, 0
    v_dot2_f32_bf16 v25, v220, s58, v25
    v_dot2_f32_bf16 v25, v224, s58, v25
    v_dot2_f32_bf16 v25, v228, s58, v25
    v_dot2_f32_bf16 v26, v217, s59, 0
    v_dot2_f32_bf16 v26, v221, s59, v26
    v_dot2_f32_bf16 v26, v225, s59, v26
    v_dot2_f32_bf16 v26, v229, s59, v26
    v_dot2_f32_bf16 v27, v217, s58, 0
    v_dot2_f32_bf16 v27, v221, s58, v27
    v_dot2_f32_bf16 v27, v225, s58, v27
    v_dot2_f32_bf16 v27, v229, s58, v27
    v_mul_f32 v16, s62, v24
    v_mul_f32 v17, s62, v25
    v_mul_f32 v18, s62, v26
    v_mul_f32 v19, s62, v27
    v_exp_f32 v16, v16
    v_exp_f32 v17, v17
    v_exp_f32 v18, v18
    v_exp_f32 v19, v19
    v_mul_f32 v24, v24, v232
    v_mul_f32 v25, v25, v233
    v_mul_f32 v26, v26, v234
    v_mul_f32 v27, v27, v235
    v_add_f32 v16, 1.0, v16
    v_add_f32 v17, 1.0, v17
    v_add_f32 v18, 1.0, v18
    v_add_f32 v19, 1.0, v19
    v_rcp_f32 v16, v16
    v_rcp_f32 v17, v17
    v_rcp_f32 v18, v18
    v_rcp_f32 v19, v19
    v_lshlrev_b32 v20, 16, v80
    v_and_b32 v21, 0xffff0000, v80
    v_lshlrev_b32 v22, 16, v81
    v_and_b32 v23, 0xffff0000, v81
    v_fma_f32 v24, v24, v16, v20
    v_fma_f32 v25, v25, v17, v21
    v_fma_f32 v26, v26, v18, v22
    v_fma_f32 v27, v27, v19, v23
    v_cvt_pk_bf16_f32 v28, v24, v25
    v_cvt_pk_bf16_f32 v29, v26, v27
    buffer_store_dwordx2 v[28:29], v2, s[12:15], s46 offen offset:0
    v_dot2_f32_bf16 v40, v218, s59, 0
    v_dot2_f32_bf16 v40, v222, s59, v40
    v_dot2_f32_bf16 v40, v226, s59, v40
    v_dot2_f32_bf16 v40, v230, s59, v40
    v_dot2_f32_bf16 v41, v218, s58, 0
    v_dot2_f32_bf16 v41, v222, s58, v41
    v_dot2_f32_bf16 v41, v226, s58, v41
    v_dot2_f32_bf16 v41, v230, s58, v41
    v_dot2_f32_bf16 v42, v219, s59, 0
    v_dot2_f32_bf16 v42, v223, s59, v42
    v_dot2_f32_bf16 v42, v227, s59, v42
    v_dot2_f32_bf16 v42, v231, s59, v42
    v_dot2_f32_bf16 v43, v219, s58, 0
    v_dot2_f32_bf16 v43, v223, s58, v43
    v_dot2_f32_bf16 v43, v227, s58, v43
    v_dot2_f32_bf16 v43, v231, s58, v43
    v_mul_f32 v32, s62, v40
    v_mul_f32 v33, s62, v41
    v_mul_f32 v34, s62, v42
    v_mul_f32 v35, s62, v43
    v_exp_f32 v32, v32
    v_exp_f32 v33, v33
    v_exp_f32 v34, v34
    v_exp_f32 v35, v35
    v_mul_f32 v40, v40, v236
    v_mul_f32 v41, v41, v237
    v_mul_f32 v42, v42, v238
    v_mul_f32 v43, v43, v239
    v_add_f32 v32, 1.0, v32
    v_add_f32 v33, 1.0, v33
    v_add_f32 v34, 1.0, v34
    v_add_f32 v35, 1.0, v35
    v_rcp_f32 v32, v32
    v_rcp_f32 v33, v33
    v_rcp_f32 v34, v34
    v_rcp_f32 v35, v35
    v_lshlrev_b32 v36, 16, v82
    v_and_b32 v37, 0xffff0000, v82
    v_lshlrev_b32 v38, 16, v83
    v_and_b32 v39, 0xffff0000, v83
    v_fma_f32 v40, v40, v32, v36
    v_fma_f32 v41, v41, v33, v37
    v_fma_f32 v42, v42, v34, v38
    v_fma_f32 v43, v43, v35, v39
    v_cvt_pk_bf16_f32 v44, v40, v41
    v_cvt_pk_bf16_f32 v45, v42, v43
    buffer_store_dwordx2 v[44:45], v2, s[12:15], s57 offen offset:0
Ldone_o:
    s_endpgm
Lwd_o_spin:
    s_mov_b32 s79, 200000
Lwd_o_spin2:
    s_sleep 1
    s_mul_i32 s35, s65, 36
    v_lshrrev_b32 v88, 2, v0
    v_add_u32 v89, s35, v88
    v_cmp_gt_u32 vcc, 18, v88
    s_nop 1
    v_cndmask_b32 v88, v89, v88, vcc
    v_and_b32 v89, 1, v88
    v_lshlrev_b32 v90, 9, v89
    v_bfe_u32 v89, v88, 3, 2
    v_lshl_add_u32 v90, v89, 7, v90
    v_bfe_u32 v89, v88, 1, 2
    v_lshl_add_u32 v90, v89, 3, v90
    v_lshrrev_b32 v89, 5, v88
    v_add_lshl_u32 v88, v89, v90, 7
    s_lshr_b32 s35, s66, 3
    s_lshl_b32 s35, s35, 12
    s_add_u32 s35, s35, 45842432
    s_mov_b64 exec, s[12:13]
    buffer_load_dword v88, v88, s[4:7], s35 offen sc1
    s_mov_b64 exec, -1
    s_waitcnt vmcnt(0)
    s_add_u32 s34, s67, 2
    v_subrev_u32 v88, s34, v88
    v_cmp_gt_u32 vcc, 8, v88
    s_nop 1
    s_andn2_b64 vcc, s[12:13], vcc
    s_cbranch_scc0 Lwd_o_back
    s_sub_u32 s79, s79, 1
    s_cmp_eq_u32 s79, 0
    s_cbranch_scc0 Lwd_o_spin2
    s_branch Lwd_o_back
Lkv_o_spin:
    s_mov_b32 s79, 200000
Lkv_o_spin2:
    s_sleep 1
    v_lshlrev_b32 v15, 5, v0
    s_mov_b64 exec, s[70:71]
    buffer_load_dword v15, v15, s[4:7], s58 offen sc1
    s_mov_b64 exec, -1
    s_waitcnt vmcnt(0)
    s_add_u32 s38, s67, 1
    v_subrev_u32 v15, s38, v15
    v_cmp_gt_u32 vcc, 8, v15
    s_nop 1
    s_andn2_b64 vcc, s[70:71], vcc
    s_cbranch_scc0 Lkv_o_back
    s_sub_u32 s79, s79, 1
    s_cmp_eq_u32 s79, 0
    s_cbranch_scc0 Lkv_o_spin2
    s_branch Lkv_o_back
Lsn_o_spin:
    s_mov_b32 s79, 200000
Lsn_o_spin2:
    s_sleep 1
    v_lshlrev_b32 v15, 5, v0
    s_mov_b64 exec, s[76:77]
    buffer_load_dword v15, v15, s[4:7], s78 offen sc1
    s_mov_b64 exec, -1
    s_waitcnt vmcnt(0)
    s_add_u32 s38, s67, 7
    v_subrev_u32 v15, s38, v15
    v_cmp_gt_u32 vcc, 8, v15
    s_nop 1
    s_andn2_b64 vcc, s[76:77], vcc
    s_cbranch_scc0 Lsn_o_back
    s_sub_u32 s79, s79, 1
    s_cmp_eq_u32 s79, 0
    s_cbranch_scc0 Lsn_o_spin2
    s_branch Lsn_o_back
L1_o_spin:
    s_mov_b32 s79, 200000
L1_o_spin2:
    s_sleep 1
    v_lshlrev_b32 v92, 5, v0
    s_mov_b64 exec, s[72:73]
    buffer_load_dword v92, v92, s[4:7], s23 offen sc1
    s_mov_b64 exec, -1
    s_waitcnt vmcnt(0)
    s_add_u32 s36, s67, 3
    v_subrev_u32 v92, s36, v92
    v_cmp_gt_u32 vcc, 8, v92
    s_nop 1
    s_andn2_b64 vcc, s[72:73], vcc
    s_cbranch_scc0 L1_o_back
    s_sub_u32 s79, s79, 1
    s_cmp_eq_u32 s79, 0
    s_cbranch_scc0 L1_o_spin2
    s_branch L1_o_back
L2_o_spin:
    s_mov_b32 s79, 200000
L2_o_spin2:
    s_sleep 1
    v_lshlrev_b32 v93, 5, v0
    s_mov_b64 exec, s[72:73]
    buffer_load_dword v93, v93, s[4:7], s23 offen sc1
    s_mov_b64 exec, -1
    s_waitcnt vmcnt(0)
    s_add_u32 s36, s67, 4
    v_subrev_u32 v93, s36, v93
    v_cmp_gt_u32 vcc, 8, v93
    s_nop 1
    s_andn2_b64 vcc, s[72:73], vcc
    s_cbranch_scc0 L2_o_back
    s_sub_u32 s79, s79, 1
    s_cmp_eq_u32 s79, 0
    s_cbranch_scc0 L2_o_spin2
    s_branch L2_o_back
L3_o_spin:
    s_mov_b32 s79, 200000
L3_o_spin2:
    s_sleep 1
    v_lshlrev_b32 v94, 5, v0
    s_mov_b64 exec, s[72:73]
    buffer_load_dword v94, v94, s[4:7], s23 offen sc1
    s_mov_b64 exec, -1
    s_waitcnt vmcnt(0)
    s_add_u32 s36, s67, 5
    v_subrev_u32 v94, s36, v94
    v_cmp_gt_u32 vcc, 8, v94
    s_nop 1
    s_andn2_b64 vcc, s[72:73], vcc
    s_cbranch_scc0 L3_o_back
    s_sub_u32 s79, s79, 1
    s_cmp_eq_u32 s79, 0
    s_cbranch_scc0 L3_o_spin2
    s_branch L3_o_back
L4_o_spin:
    s_mov_b32 s79, 200000
L4_o_spin2:
    s_sleep 1
    v_lshlrev_b32 v95, 5, v0
    s_mov_b64 exec, s[72:73]
    buffer_load_dword v95, v95, s[4:7], s23 offen sc1
    s_mov_b64 exec, -1
    s_waitcnt vmcnt(0)
    s_add_u32 s36, s67, 6
    v_subrev_u32 v95, s36, v95
    v_cmp_gt_u32 vcc, 8, v95
    s_nop 1
    s_andn2_b64 vcc, s[72:73], vcc
    s_cbranch_scc0 L4_o_back
    s_sub_u32 s79, s79, 1
    s_cmp_eq_u32 s79, 0
    s_cbranch_scc0 L4_o_spin2
    s_branch L4_o_back
Lo_o_spin:
    s_mov_b32 s79, 200000
Lo_o_spin2:
    s_sleep 1
    v_lshlrev_b32 v92, 5, v0
    s_mov_b64 exec, s[70:71]
    buffer_load_dword v92, v92, s[4:7], s23 offen sc1
    s_mov_b64 exec, -1
    s_waitcnt vmcnt(0)
    s_add_u32 s36, s67, 5
    v_subrev_u32 v92, s36, v92
    v_cmp_gt_u32 vcc, 8, v92
    s_nop 1
    s_andn2_b64 vcc, s[70:71], vcc
    s_cbranch_scc0 Lo_o_back
    s_sub_u32 s79, s79, 1
    s_cmp_eq_u32 s79, 0
    s_cbranch_scc0 Lo_o_spin2
    s_branch Lo_o_back
LM_end:
    s_endpgm
.p2align 6
.type L_postab,@object
L_postab:
.long 18432, 22528, 30720, 38912, 47104, 0, 16384, 0
.long 18944, 23552, 31744, 39936, 48128, 512, 16388, 0
.long 19456, 24576, 32768, 40960, 49152, 1024, 16392, 0
.long 19968, 25600, 33792, 41984, 50176, 1536, 16396, 0
.long 20480, 26624, 34816, 43008, 51200, 2048, 16640, 0
.long 20992, 27648, 35840, 44032, 52224, 2560, 16644, 0
.long 21504, 28672, 36864, 45056, 53248, 3072, 16648, 0
.long 22016, 29696, 37888, 46080, 54272, 3584, 16652, 0
.long 55296, 59392, 67584, 75776, 83968, 4096, 16896, 0
.long 55808, 60416, 68608, 76800, 84992, 4608, 16900, 0
.long 56320, 61440, 69632, 77824, 86016, 5120, 16904, 0
.long 56832, 62464, 70656, 78848, 87040, 5632, 16908, 0
.long 57344, 63488, 71680, 79872, 88064, 6144, 17152, 0
.long 57856, 64512, 72704, 80896, 89088, 6656, 17156, 0
.long 58368, 65536, 73728, 81920, 90112, 7168, 17160, 0
.long 58880, 66560, 74752, 82944, 91136, 7680, 17164, 0
.long 92160, 96256, 104448, 112640, 120832, 8192, 17408, 0
.long 92672, 97280, 105472, 113664, 121856, 8704, 17412, 0
.long 93184, 98304, 106496, 114688, 122880, 9216, 17416, 0
.long 93696, 99328, 107520, 115712, 123904, 9728, 17420, 0
.long 94208, 100352, 108544, 116736, 124928, 10240, 17664, 0
.long 94720, 101376, 109568, 117760, 125952, 10752, 17668, 0
.long 95232, 102400, 110592, 118784, 126976, 11264, 17672, 0
.long 95744, 103424, 111616, 119808, 128000, 11776, 17676, 0
.long 129024, 133120, 141312, 149504, 157696, 12288, 17920, 0
.long 129536, 134144, 142336, 150528, 158720, 12800, 17924, 0
.long 130048, 135168, 143360, 151552, 159744, 13312, 17928, 0
.long 130560, 136192, 144384, 152576, 160768, 13824, 17932, 0
.long 131072, 137216, 145408, 153600, 161792, 14336, 18176, 0
.long 131584, 138240, 146432, 154624, 162816, 14848, 18180, 0
.long 132096, 139264, 147456, 155648, 163840, 15360, 18184, 0
.long 132608, 140288, 148480, 156672, 164864, 15872, 18188, 0
.type L_kkhtab,@object
L_kkhtab:
.long 128, 129, 130, 131, 0, 4, 8, 12, 16, 20, 24, 28, 1, 5, 9, 13, 17, 21, 25, 29, 2, 6, 10, 14, 18, 22, 26, 30, 3, 7, 11, 15, 19, 23, 27, 31, 132, 133, 134, 135, 32, 36, 40, 44, 48, 52, 56, 60, 33, 37, 41, 45, 49, 53, 57, 61, 34, 38, 42, 46, 50, 54, 58, 62, 35, 39, 43, 47, 51, 55, 59, 63, 136, 137, 138, 139, 64, 68, 72, 76, 80, 84, 88, 92, 65, 69, 73, 77, 81, 85, 89, 93, 66, 70, 74, 78, 82, 86, 90, 94, 67, 71, 75, 79, 83, 87, 91, 95, 140, 141, 142, 143, 96, 100, 104, 108, 112, 116, 120, 124, 97, 101, 105, 109, 113, 117, 121, 125, 98, 102, 106, 110, 114, 118, 122, 126, 99, 103, 107, 111, 115, 119, 123, 127
.p2align 8
L_code_end:
.fill 64, 4, 0xBF800000
.section .rodata,"a"
.p2align 6
.amdhsa_kernel recurrent_scan__linear_kernel_hedgehog__swiglu_ffn__prompt_kernel
  .amdhsa_next_free_vgpr 512
  .amdhsa_next_free_sgpr 102
  .amdhsa_accum_offset 256
  .amdhsa_group_segment_fixed_size 0
  .amdhsa_kernarg_size 88
  .amdhsa_user_sgpr_count 2
  .amdhsa_user_sgpr_kernarg_segment_ptr 1
  .amdhsa_system_sgpr_workgroup_id_x 1
  .amdhsa_float_denorm_mode_32 3
  .amdhsa_float_denorm_mode_16_64 3
.end_amdhsa_kernel
```
